```python
import torch

def _softmax(x, axis=-1):
    return torch.softmax(x, dim=axis)
def _gelu(x):
    return torch.nn.functional.gelu(x, approximate="tanh")
def _silu(x):
    return torch.nn.functional.silu(x)
def _sigmoid(x):
    return torch.sigmoid(x)
def _layernorm(x, axis=-1, eps=1e-5):
    m = x.mean(dim=axis, keepdim=True)
    v = x.var(dim=axis, keepdim=True, unbiased=False)
    return (x - m) / torch.sqrt(v + eps)
def _scatter_add(tgt, idx, src, axis=0):
    return tgt.clone().index_add_(axis, idx, src)
def _segment_sum(src, seg, n):
    out = torch.zeros((n,) + src.shape[1:], dtype=src.dtype)
    return out.index_add_(0, seg, src)
def _pad(x, pw):
    flat = tuple(v for pair in reversed(pw) for v in pair)
    return torch.nn.functional.pad(x, flat)

kernel_name = 'standalone__mha_block_cached__near_ridge'

def setup_inputs():

    _w = (lambda a: (lambda t: t.to(torch.bfloat16) if t.is_floating_point() else t)(torch.as_tensor(a)))
    B, Sq, D = 8, 224, 448
    H, Sk, Dh = 16, 1024, 256
    return {
        "x": _w((lambda *s: torch.randn(*s, dtype=torch.bfloat16) * 0.8)(B, Sq, D)),
        "k_cache": _w((lambda *s: torch.randn(*s, dtype=torch.bfloat16) * 0.8)(B, H, Sk, Dh)),
        "v_cache": _w((lambda *s: torch.randn(*s, dtype=torch.bfloat16) * 0.05)(B, H, Sk, Dh)),
        "wq": _w((lambda *s: torch.randn(*s, dtype=torch.bfloat16) * 0.8)(D, H * Dh) * (D ** -0.5)),
        "wo": _w((lambda *s: torch.randn(*s, dtype=torch.bfloat16) * 0.05)(H * Dh, D) * ((H * Dh) ** -0.5)),
    }

def reference(x, k_cache, v_cache, wq, wo):
    B, Sq, D = x.shape
    H, Dh = 16, 256
    q = (lambda x, *d: x.permute(*d))((x @ wq).reshape(B, Sq, H, Dh), 0, 2, 1, 3)
    scores = torch.einsum("bhqd,bhkd->bhqk", q, k_cache) * (Dh ** -0.5)
    p = _softmax(scores, axis=-1)
    o = torch.einsum("bhqk,bhkd->bhqd", p, v_cache)
    return (lambda x, *d: x.permute(*d))(o, 0, 2, 1, 3).reshape(B, Sq, H * Dh) @ wo
```

```asm
; @launch grid=(256,1,1) block=(512,1,1) lds=163840
.amdgcn_target "amdgcn-amd-amdhsa--gfx950"
.text
.globl standalone__mha_block_cached__near_ridge_kernel
.p2align 8
.type standalone__mha_block_cached__near_ridge_kernel,@function
standalone__mha_block_cached__near_ridge_kernel:
    s_cmp_ge_u32 s2, 256
    s_cbranch_scc1 LA_end
    s_load_dwordx16 s[4:19], s[0:1], 0
    v_lshrrev_b32 v1, 6, v0
    v_and_b32 v0, 63, v0
    v_readfirstlane_b32 s44, v1
    s_getpc_b64 s[68:69]
LA_pc:
    s_cmp_ge_u32 s44, 4
    s_cbranch_scc1 LA_nopf
    s_lshr_b32 s50, s2, 3
    s_mul_i32 s50, s50, 12
    s_add_u32 s50, s50, s44
    s_lshl_b32 s50, s50, 7
    s_add_u32 s50, s50, 60-(LA_pc-standalone__mha_block_cached__near_ridge_kernel)
    s_min_u32 s50, s50, LA_endoftext-LA_pc-1032
    s_load_dwordx2 s[88:89], s[68:69], s50
    s_add_u32 s50, s50, 512
    s_load_dwordx2 s[88:89], s[68:69], s50
    s_add_u32 s50, s50, 512
    s_load_dwordx2 s[88:89], s[68:69], s50
LA_nopf:
    s_and_b32 s50, s2, 7
    s_lshr_b32 s51, s2, 3
    s_and_b32 s47, s51, 1
    s_lshr_b32 s51, s51, 1
    s_lshr_b32 s52, s51, 2
    s_and_b32 s53, s51, 3
    s_lshr_b32 s45, s50, 2
    s_lshl_b32 s45, s45, 2
    s_add_u32 s45, s45, s52
    s_and_b32 s46, s50, 3
    s_lshl_b32 s46, s46, 2
    s_add_u32 s46, s46, s53
    s_lshl_b32 s67, s52, 1
    s_add_u32 s67, s67, s47
    s_lshl_b32 s96, s45, 1
    s_add_u32 s96, s96, s47
    s_add_u32 s50, s53, s67
    s_and_b32 s50, s50, 1
    s_mov_b32 s48, 0x6543210
    s_cmp_eq_u32 s50, 1
    s_cselect_b32 s48, 0x6452301, s48
    s_cmp_eq_u32 s67, 7
    s_cselect_b32 s67, 0, s67
    s_mov_b32 s97, 0
    s_cmp_lt_u32 s44, 4
    s_cbranch_scc1 LA_compute
    s_sub_u32 s44, s44, 4
LA_hrestart:
    v_lshrrev_b32 v8, 3, v0
    v_mul_u32_u24 v4, 14336, v8
    v_and_b32 v9, 7, v0
    v_lshl_add_u32 v4, v9, 4, v4
    v_cmp_eq_u32 vcc, 7, v8
    v_mov_b32 v10, 0x70000000
    v_lshrrev_b32 v6, 5, v0
    v_cndmask_b32 v4, v4, v10, vcc
    v_and_b32 v7, 31, v0
    v_lshlrev_b32 v7, 4, v7
    v_lshl_add_u32 v3, v6, 15, v7
    s_mul_i32 s61, s44, 4224
    s_lshl_b32 s63, s46, 9
    s_lshl_b32 s50, s44, 16
    s_add_u32 s63, s63, s50
    s_mul_i32 s64, s96, 112
    s_lshl_b32 s50, s44, 2
    s_add_u32 s64, s64, s50
    s_mul_i32 s64, s64, 896
    s_add_u32 s72, s61, 11776
    s_add_u32 s73, s61, 62464
    s_mov_b32 s74, 0
    s_mov_b32 s75, s48
    s_movk_i32 s76, 1056
    s_movk_i32 s77, 896
    s_movk_i32 s78, 0x2000
    s_mov_b32 s22, 1605632
    s_mov_b32 s23, 0x20000
    s_mov_b32 s34, 3670016
    s_mov_b32 s35, 0x20000
    s_waitcnt lgkmcnt(0)
    s_mov_b64 s[20:21], s[4:5]
    s_mov_b64 s[32:33], s[10:11]
LA_hq:
    s_mov_b32 m0, s72
    s_and_b32 s59, s75, 7
    s_lshl_b32 s51, s59, 7
    s_add_u32 s51, s51, s64
    buffer_load_dwordx4 v4, s[20:23], s51 offen lds
    s_add_u32 m0, m0, s76
    s_add_u32 s51, s51, s77
    buffer_load_dwordx4 v4, s[20:23], s51 offen lds
    s_add_u32 m0, m0, s76
    s_add_u32 s51, s51, s77
    buffer_load_dwordx4 v4, s[20:23], s51 offen lds
    s_add_u32 m0, m0, s76
    s_add_u32 s51, s51, s77
    buffer_load_dwordx4 v4, s[20:23], s51 offen lds
    s_cmp_eq_u32 s74, 1
    s_cbranch_scc0 LA_hq1
    s_waitcnt vmcnt(8)
    s_barrier
LA_hq1:
    s_mov_b32 m0, s73
    s_lshl_b32 s52, s59, 19
    s_add_u32 s52, s52, s63
    buffer_load_dwordx4 v3, s[32:35], s52 offen lds
    s_add_u32 m0, m0, s76
    s_add_u32 s52, s52, s78
    buffer_load_dwordx4 v3, s[32:35], s52 offen lds
    s_add_u32 m0, m0, s76
    s_add_u32 s52, s52, s78
    buffer_load_dwordx4 v3, s[32:35], s52 offen lds
    s_add_u32 m0, m0, s76
    s_add_u32 s52, s52, s78
    buffer_load_dwordx4 v3, s[32:35], s52 offen lds
    s_cmp_eq_u32 s74, 0
    s_cbranch_scc1 LA_hq2
    s_waitcnt vmcnt(8)
    s_barrier
LA_hq2:
    s_add_u32 m0, s73, 16896
    s_add_u32 s52, s52, 237568
    buffer_load_dwordx4 v3, s[32:35], s52 offen lds
    s_add_u32 m0, m0, s76
    s_add_u32 s52, s52, s78
    buffer_load_dwordx4 v3, s[32:35], s52 offen lds
    s_add_u32 m0, m0, s76
    s_add_u32 s52, s52, s78
    buffer_load_dwordx4 v3, s[32:35], s52 offen lds
    s_add_u32 m0, m0, s76
    s_add_u32 s52, s52, s78
    buffer_load_dwordx4 v3, s[32:35], s52 offen lds
    s_lshr_b32 s75, s75, 4
    s_add_u32 s74, s74, 1
    s_bitcmp1_b32 0x48, s74
    s_cselect_b32 s50, -2, 1
    s_mul_i32 s51, s50, 16896
    s_add_u32 s72, s72, s51
    s_lshl_b32 s51, s51, 1
    s_add_u32 s73, s73, s51
    s_cmp_lt_u32 s74, 7
    s_cbranch_scc1 LA_hq
    s_mov_b32 s24, s6
    s_mov_b32 s25, s7
    s_mov_b32 s26, 67108864
    s_mov_b32 s27, 0x20000
    s_mov_b32 s28, s8
    s_mov_b32 s29, s9
    s_mov_b32 s30, 67108864
    s_mov_b32 s31, 0x20000
    s_mov_b32 s36, s12
    s_mov_b32 s37, s13
    s_mov_b32 s38, 3670016
    s_mov_b32 s39, 0x20000
    s_mov_b32 s40, s18
    s_mov_b32 s41, s19
    s_mov_b32 s42, 268435456
    s_mov_b32 s43, 0x20000
    s_mov_b32 s92, s14
    s_mov_b32 s93, s15
    s_mov_b32 s94, 1605632
    s_mov_b32 s95, 0x20000
    v_lshl_add_u32 v2, v6, 14, v7
    v_mul_u32_u24 v5, 896, v8
    v_bfe_u32 v8, v0, 4, 2
    v_lshlrev_b32 v8, 1, v8
    v_xor_b32 v8, v8, v9
    v_lshl_add_u32 v5, v8, 4, v5
    s_lshl_b32 s62, s44, 13
    s_lshl_b32 s65, s45, 4
    s_add_u32 s65, s65, s46
    s_lshl_b32 s65, s65, 19
    s_lshl_b32 s50, s44, 11
    s_add_u32 s65, s65, s50
    s_lshl_b32 s66, s46, 8
    s_lshl_b32 s50, s44, 6
    s_add_u32 s66, s66, s50
    s_mul_i32 s66, s66, 896
    v_lshl_add_u32 v23, v0, 4, s61
    s_add_u32 m0, s61, 96256
    s_add_u32 s50, s65, 0
    buffer_load_dwordx4 v2, s[24:27], s50 offen nt lds
    s_add_u32 m0, s61, 97296
    s_add_u32 s50, s65, 512
    buffer_load_dwordx4 v2, s[24:27], s50 offen nt lds
    s_add_u32 m0, s61, 98368
    s_add_u32 s50, s65, 1024
    buffer_load_dwordx4 v2, s[24:27], s50 offen nt lds
    s_add_u32 m0, s61, 99408
    s_add_u32 s50, s65, 1536
    buffer_load_dwordx4 v2, s[24:27], s50 offen nt lds
    s_add_u32 m0, s61, 28672
    s_add_u32 s50, s65, 32768
    buffer_load_dwordx4 v2, s[24:27], s50 offen nt lds
    s_add_u32 m0, s61, 29712
    s_add_u32 s50, s65, 33280
    buffer_load_dwordx4 v2, s[24:27], s50 offen nt lds
    s_add_u32 m0, s61, 30784
    s_add_u32 s50, s65, 33792
    buffer_load_dwordx4 v2, s[24:27], s50 offen nt lds
    s_add_u32 m0, s61, 31824
    s_add_u32 s50, s65, 34304
    buffer_load_dwordx4 v2, s[24:27], s50 offen nt lds
    s_waitcnt vmcnt(8)
    s_barrier
    s_add_u32 m0, s61, 130048
    s_add_u32 s50, s65, 8192
    buffer_load_dwordx4 v2, s[24:27], s50 offen nt lds
    s_add_u32 m0, s61, 131088
    s_add_u32 s50, s65, 8704
    buffer_load_dwordx4 v2, s[24:27], s50 offen nt lds
    s_add_u32 m0, s61, 132160
    s_add_u32 s50, s65, 9216
    buffer_load_dwordx4 v2, s[24:27], s50 offen nt lds
    s_add_u32 m0, s61, 133200
    s_add_u32 s50, s65, 9728
    buffer_load_dwordx4 v2, s[24:27], s50 offen nt lds
    s_add_u32 m0, s61, 146944
    s_add_u32 s50, s65, 0
    buffer_load_dwordx4 v2, s[28:31], s50 offen nt lds
    s_add_u32 m0, s61, 148000
    s_add_u32 s50, s65, 512
    buffer_load_dwordx4 v2, s[28:31], s50 offen nt lds
    s_add_u32 m0, s61, 149056
    s_add_u32 s50, s65, 1024
    buffer_load_dwordx4 v2, s[28:31], s50 offen nt lds
    s_add_u32 m0, s61, 150112
    s_add_u32 s50, s65, 1536
    buffer_load_dwordx4 v2, s[28:31], s50 offen nt lds
    s_add_u32 m0, s61, 45568
    s_add_u32 s50, s65, 8192
    buffer_load_dwordx4 v2, s[28:31], s50 offen nt lds
    s_add_u32 m0, s61, 46624
    s_add_u32 s50, s65, 8704
    buffer_load_dwordx4 v2, s[28:31], s50 offen nt lds
    s_add_u32 m0, s61, 47680
    s_add_u32 s50, s65, 9216
    buffer_load_dwordx4 v2, s[28:31], s50 offen nt lds
    s_add_u32 m0, s61, 48736
    s_add_u32 s50, s65, 9728
    buffer_load_dwordx4 v2, s[28:31], s50 offen nt lds
    s_waitcnt vmcnt(16)
    s_barrier
    s_add_u32 m0, s61, 62464
    s_add_u32 s50, s65, 40960
    buffer_load_dwordx4 v2, s[24:27], s50 offen nt lds
    s_add_u32 m0, s61, 63504
    s_add_u32 s50, s65, 41472
    buffer_load_dwordx4 v2, s[24:27], s50 offen nt lds
    s_add_u32 m0, s61, 64576
    s_add_u32 s50, s65, 41984
    buffer_load_dwordx4 v2, s[24:27], s50 offen nt lds
    s_add_u32 m0, s61, 65616
    s_add_u32 s50, s65, 42496
    buffer_load_dwordx4 v2, s[24:27], s50 offen nt lds
    s_add_u32 m0, s61, 79360
    s_add_u32 s50, s65, 32768
    buffer_load_dwordx4 v2, s[28:31], s50 offen nt lds
    s_add_u32 m0, s61, 80416
    s_add_u32 s50, s65, 33280
    buffer_load_dwordx4 v2, s[28:31], s50 offen nt lds
    s_add_u32 m0, s61, 81472
    s_add_u32 s50, s65, 33792
    buffer_load_dwordx4 v2, s[28:31], s50 offen nt lds
    s_add_u32 m0, s61, 82528
    s_add_u32 s50, s65, 34304
    buffer_load_dwordx4 v2, s[28:31], s50 offen nt lds
    s_mov_b32 s54, 7
    s_sub_u32 s3, 0, s18
    s_and_b32 s3, s3, 0x1fffff
    s_lshl_b32 s50, s96, 22
    s_add_u32 s3, s3, s50
    s_and_b32 s75, s46, 7
    s_xor_b32 s50, s44, 2
    s_or_b32 s75, s75, s50
    s_or_b32 s75, s75, s97
    s_lshl_b32 s74, s46, 18
    s_add_u32 s74, s74, s3
    s_add_u32 s74, s74, 245760
    s_add_u32 s50, s74, 16320
    s_load_dword s80, s[18:19], s50
    s_mov_b32 s72, 0
    s_mov_b32 s73, 0
    s_waitcnt vmcnt(12)
LA_hloop:
    s_waitcnt vmcnt(16)
    s_barrier
    s_cmp_eq_u32 s75, 0
    s_cbranch_scc1 LA_me8
LA_mr8:
    s_add_u32 m0, s61, 96256
    s_add_u32 s50, s65, 65536
    buffer_load_dwordx4 v2, s[24:27], s50 offen nt lds
    s_add_u32 m0, s61, 97296
    s_add_u32 s50, s65, 66048
    buffer_load_dwordx4 v2, s[24:27], s50 offen nt lds
    s_add_u32 m0, s61, 98368
    s_add_u32 s50, s65, 66560
    buffer_load_dwordx4 v2, s[24:27], s50 offen nt lds
    s_add_u32 m0, s61, 99408
    s_add_u32 s50, s65, 67072
    buffer_load_dwordx4 v2, s[24:27], s50 offen nt lds
    s_add_u32 m0, s61, 113152
    s_add_u32 s50, s65, 40960
    buffer_load_dwordx4 v2, s[28:31], s50 offen nt lds
    s_add_u32 m0, s61, 114208
    s_add_u32 s50, s65, 41472
    buffer_load_dwordx4 v2, s[28:31], s50 offen nt lds
    s_add_u32 m0, s61, 115264
    s_add_u32 s50, s65, 41984
    buffer_load_dwordx4 v2, s[28:31], s50 offen nt lds
    s_add_u32 m0, s61, 116320
    s_add_u32 s50, s65, 42496
    buffer_load_dwordx4 v2, s[28:31], s50 offen nt lds
    s_cmp_eq_u32 s54, 7
    s_cbranch_scc1 LA_sl8_0
LA_sr8:
    s_waitcnt vmcnt(16)
    s_barrier
    s_cmp_eq_u32 s75, 0
    s_cbranch_scc1 LA_me9
LA_mr9:
    s_add_u32 m0, s61, 130048
    s_add_u32 s50, s65, 73728
    buffer_load_dwordx4 v2, s[24:27], s50 offen nt lds
    s_add_u32 m0, s61, 131088
    s_add_u32 s50, s65, 74240
    buffer_load_dwordx4 v2, s[24:27], s50 offen nt lds
    s_add_u32 m0, s61, 132160
    s_add_u32 s50, s65, 74752
    buffer_load_dwordx4 v2, s[24:27], s50 offen nt lds
    s_add_u32 m0, s61, 133200
    s_add_u32 s50, s65, 75264
    buffer_load_dwordx4 v2, s[24:27], s50 offen nt lds
    s_add_u32 m0, s61, 146944
    s_add_u32 s50, s65, 65536
    buffer_load_dwordx4 v2, s[28:31], s50 offen nt lds
    s_add_u32 m0, s61, 148000
    s_add_u32 s50, s65, 66048
    buffer_load_dwordx4 v2, s[28:31], s50 offen nt lds
    s_add_u32 m0, s61, 149056
    s_add_u32 s50, s65, 66560
    buffer_load_dwordx4 v2, s[28:31], s50 offen nt lds
    s_add_u32 m0, s61, 150112
    s_add_u32 s50, s65, 67072
    buffer_load_dwordx4 v2, s[28:31], s50 offen nt lds
    s_cmp_eq_u32 s54, 6
    s_cbranch_scc1 LA_sl9_1
LA_sr9:
    s_waitcnt vmcnt(16)
    s_barrier
    s_cmp_eq_u32 s75, 0
    s_cbranch_scc1 LA_me10
LA_mr10:
    s_add_u32 m0, s61, 28672
    s_add_u32 s50, s65, 98304
    buffer_load_dwordx4 v2, s[24:27], s50 offen nt lds
    s_add_u32 m0, s61, 29712
    s_add_u32 s50, s65, 98816
    buffer_load_dwordx4 v2, s[24:27], s50 offen nt lds
    s_add_u32 m0, s61, 30784
    s_add_u32 s50, s65, 99328
    buffer_load_dwordx4 v2, s[24:27], s50 offen nt lds
    s_add_u32 m0, s61, 31824
    s_add_u32 s50, s65, 99840
    buffer_load_dwordx4 v2, s[24:27], s50 offen nt lds
    s_add_u32 m0, s61, 45568
    s_add_u32 s50, s65, 73728
    buffer_load_dwordx4 v2, s[28:31], s50 offen nt lds
    s_add_u32 m0, s61, 46624
    s_add_u32 s50, s65, 74240
    buffer_load_dwordx4 v2, s[28:31], s50 offen nt lds
    s_add_u32 m0, s61, 47680
    s_add_u32 s50, s65, 74752
    buffer_load_dwordx4 v2, s[28:31], s50 offen nt lds
    s_add_u32 m0, s61, 48736
    s_add_u32 s50, s65, 75264
    buffer_load_dwordx4 v2, s[28:31], s50 offen nt lds
    s_cmp_eq_u32 s54, 5
    s_cbranch_scc1 LA_sl10_2
LA_sr10:
    s_waitcnt vmcnt(16)
    s_barrier
    s_cmp_eq_u32 s75, 0
    s_cbranch_scc1 LA_me11
LA_mr11:
    s_add_u32 m0, s61, 62464
    s_add_u32 s50, s65, 106496
    buffer_load_dwordx4 v2, s[24:27], s50 offen nt lds
    s_add_u32 m0, s61, 63504
    s_add_u32 s50, s65, 107008
    buffer_load_dwordx4 v2, s[24:27], s50 offen nt lds
    s_add_u32 m0, s61, 64576
    s_add_u32 s50, s65, 107520
    buffer_load_dwordx4 v2, s[24:27], s50 offen nt lds
    s_add_u32 m0, s61, 65616
    s_add_u32 s50, s65, 108032
    buffer_load_dwordx4 v2, s[24:27], s50 offen nt lds
    s_add_u32 m0, s61, 79360
    s_add_u32 s50, s65, 98304
    buffer_load_dwordx4 v2, s[28:31], s50 offen nt lds
    s_add_u32 m0, s61, 80416
    s_add_u32 s50, s65, 98816
    buffer_load_dwordx4 v2, s[28:31], s50 offen nt lds
    s_add_u32 m0, s61, 81472
    s_add_u32 s50, s65, 99328
    buffer_load_dwordx4 v2, s[28:31], s50 offen nt lds
    s_add_u32 m0, s61, 82528
    s_add_u32 s50, s65, 99840
    buffer_load_dwordx4 v2, s[28:31], s50 offen nt lds
    s_cmp_eq_u32 s54, 4
    s_cbranch_scc1 LA_sl11_3
LA_sr11:
    s_add_u32 s65, s65, 65536
    s_sub_u32 s54, s54, 1
    s_cmp_lg_u32 s54, 2
    s_cbranch_scc1 LA_hloop
    s_waitcnt vmcnt(16)
    s_barrier
    s_add_u32 m0, s61, 96256
    s_add_u32 s50, s65, 65536
    buffer_load_dwordx4 v2, s[24:27], s50 offen nt lds
    s_add_u32 m0, s61, 97296
    s_add_u32 s50, s65, 66048
    buffer_load_dwordx4 v2, s[24:27], s50 offen nt lds
    s_add_u32 m0, s61, 98368
    s_add_u32 s50, s65, 66560
    buffer_load_dwordx4 v2, s[24:27], s50 offen nt lds
    s_add_u32 m0, s61, 99408
    s_add_u32 s50, s65, 67072
    buffer_load_dwordx4 v2, s[24:27], s50 offen nt lds
    s_add_u32 m0, s61, 113152
    s_add_u32 s50, s65, 40960
    buffer_load_dwordx4 v2, s[28:31], s50 offen nt lds
    s_add_u32 m0, s61, 114208
    s_add_u32 s50, s65, 41472
    buffer_load_dwordx4 v2, s[28:31], s50 offen nt lds
    s_add_u32 m0, s61, 115264
    s_add_u32 s50, s65, 41984
    buffer_load_dwordx4 v2, s[28:31], s50 offen nt lds
    s_add_u32 m0, s61, 116320
    s_add_u32 s50, s65, 42496
    buffer_load_dwordx4 v2, s[28:31], s50 offen nt lds
    s_waitcnt vmcnt(16)
    s_barrier
    s_add_u32 m0, s61, 130048
    s_add_u32 s50, s65, 73728
    buffer_load_dwordx4 v2, s[24:27], s50 offen nt lds
    s_add_u32 m0, s61, 131088
    s_add_u32 s50, s65, 74240
    buffer_load_dwordx4 v2, s[24:27], s50 offen nt lds
    s_add_u32 m0, s61, 132160
    s_add_u32 s50, s65, 74752
    buffer_load_dwordx4 v2, s[24:27], s50 offen nt lds
    s_add_u32 m0, s61, 133200
    s_add_u32 s50, s65, 75264
    buffer_load_dwordx4 v2, s[24:27], s50 offen nt lds
    s_add_u32 m0, s61, 146944
    s_add_u32 s50, s65, 65536
    buffer_load_dwordx4 v2, s[28:31], s50 offen nt lds
    s_add_u32 m0, s61, 148000
    s_add_u32 s50, s65, 66048
    buffer_load_dwordx4 v2, s[28:31], s50 offen nt lds
    s_add_u32 m0, s61, 149056
    s_add_u32 s50, s65, 66560
    buffer_load_dwordx4 v2, s[28:31], s50 offen nt lds
    s_add_u32 m0, s61, 150112
    s_add_u32 s50, s65, 67072
    buffer_load_dwordx4 v2, s[28:31], s50 offen nt lds
    s_waitcnt vmcnt(16)
    s_barrier
    s_add_u32 m0, s61, 28672
    s_add_u32 s50, s65, 98304
    buffer_load_dwordx4 v2, s[24:27], s50 offen nt lds
    s_add_u32 m0, s61, 29712
    s_add_u32 s50, s65, 98816
    buffer_load_dwordx4 v2, s[24:27], s50 offen nt lds
    s_add_u32 m0, s61, 30784
    s_add_u32 s50, s65, 99328
    buffer_load_dwordx4 v2, s[24:27], s50 offen nt lds
    s_add_u32 m0, s61, 31824
    s_add_u32 s50, s65, 99840
    buffer_load_dwordx4 v2, s[24:27], s50 offen nt lds
    s_add_u32 m0, s61, 45568
    s_add_u32 s50, s65, 73728
    buffer_load_dwordx4 v2, s[28:31], s50 offen nt lds
    s_add_u32 m0, s61, 46624
    s_add_u32 s50, s65, 74240
    buffer_load_dwordx4 v2, s[28:31], s50 offen nt lds
    s_add_u32 m0, s61, 47680
    s_add_u32 s50, s65, 74752
    buffer_load_dwordx4 v2, s[28:31], s50 offen nt lds
    s_add_u32 m0, s61, 48736
    s_add_u32 s50, s65, 75264
    buffer_load_dwordx4 v2, s[28:31], s50 offen nt lds
    s_waitcnt vmcnt(16)
    s_barrier
    s_add_u32 m0, s61, 62464
    s_add_u32 s50, s65, 106496
    buffer_load_dwordx4 v2, s[24:27], s50 offen nt lds
    s_add_u32 m0, s61, 63504
    s_add_u32 s50, s65, 107008
    buffer_load_dwordx4 v2, s[24:27], s50 offen nt lds
    s_add_u32 m0, s61, 64576
    s_add_u32 s50, s65, 107520
    buffer_load_dwordx4 v2, s[24:27], s50 offen nt lds
    s_add_u32 m0, s61, 65616
    s_add_u32 s50, s65, 108032
    buffer_load_dwordx4 v2, s[24:27], s50 offen nt lds
    s_add_u32 m0, s61, 79360
    s_add_u32 s50, s65, 98304
    buffer_load_dwordx4 v2, s[28:31], s50 offen nt lds
    s_add_u32 m0, s61, 80416
    s_add_u32 s50, s65, 98816
    buffer_load_dwordx4 v2, s[28:31], s50 offen nt lds
    s_add_u32 m0, s61, 81472
    s_add_u32 s50, s65, 99328
    buffer_load_dwordx4 v2, s[28:31], s50 offen nt lds
    s_add_u32 m0, s61, 82528
    s_add_u32 s50, s65, 99840
    buffer_load_dwordx4 v2, s[28:31], s50 offen nt lds
    s_waitcnt vmcnt(16)
    s_barrier
    v_add_u32 v24, 96256, v23
    s_add_u32 m0, s61, 113152
    s_add_u32 s50, s65, 106496
    buffer_load_dwordx4 v2, s[28:31], s50 offen nt lds
    s_add_u32 m0, s61, 114208
    s_add_u32 s50, s65, 107008
    buffer_load_dwordx4 v2, s[28:31], s50 offen nt lds
    s_add_u32 m0, s61, 115264
    s_add_u32 s50, s65, 107520
    buffer_load_dwordx4 v2, s[28:31], s50 offen nt lds
    s_add_u32 m0, s61, 116320
    s_add_u32 s50, s65, 108032
    buffer_load_dwordx4 v2, s[28:31], s50 offen nt lds
    ds_write_b128 v24, v[96:99] offset:0
    ds_write_b128 v24, v[100:103] offset:1040
    s_waitcnt vmcnt(12)
    s_barrier
    s_add_u32 m0, s61, 130048
    s_add_u32 s50, s65, 139264
    buffer_load_dwordx4 v2, s[24:27], s50 offen nt lds
    s_add_u32 m0, s61, 131088
    s_add_u32 s50, s65, 139776
    buffer_load_dwordx4 v2, s[24:27], s50 offen nt lds
    s_add_u32 m0, s61, 132160
    s_add_u32 s50, s65, 140288
    buffer_load_dwordx4 v2, s[24:27], s50 offen nt lds
    s_add_u32 m0, s61, 133200
    s_add_u32 s50, s65, 140800
    buffer_load_dwordx4 v2, s[24:27], s50 offen nt lds
    s_add_u32 m0, s61, 146944
    s_add_u32 s50, s65, 131072
    buffer_load_dwordx4 v2, s[28:31], s50 offen nt lds
    s_add_u32 m0, s61, 148000
    s_add_u32 s50, s65, 131584
    buffer_load_dwordx4 v2, s[28:31], s50 offen nt lds
    s_add_u32 m0, s61, 149056
    s_add_u32 s50, s65, 132096
    buffer_load_dwordx4 v2, s[28:31], s50 offen nt lds
    s_add_u32 m0, s61, 150112
    s_add_u32 s50, s65, 132608
    buffer_load_dwordx4 v2, s[28:31], s50 offen nt lds
    ds_write_b128 v24, v[104:107] offset:2112
    ds_write_b128 v24, v[108:111] offset:3152
    s_waitcnt vmcnt(12)
    s_barrier
    s_add_u32 m0, s61, 28672
    s_add_u32 s50, s65, 163840
    buffer_load_dwordx4 v2, s[24:27], s50 offen nt lds
    s_add_u32 m0, s61, 29712
    s_add_u32 s50, s65, 164352
    buffer_load_dwordx4 v2, s[24:27], s50 offen nt lds
    s_add_u32 m0, s61, 30784
    s_add_u32 s50, s65, 164864
    buffer_load_dwordx4 v2, s[24:27], s50 offen nt lds
    s_add_u32 m0, s61, 31824
    s_add_u32 s50, s65, 165376
    buffer_load_dwordx4 v2, s[24:27], s50 offen nt lds
    s_add_u32 m0, s61, 45568
    s_add_u32 s50, s65, 139264
    buffer_load_dwordx4 v2, s[28:31], s50 offen nt lds
    s_add_u32 m0, s61, 46624
    s_add_u32 s50, s65, 139776
    buffer_load_dwordx4 v2, s[28:31], s50 offen nt lds
    s_add_u32 m0, s61, 47680
    s_add_u32 s50, s65, 140288
    buffer_load_dwordx4 v2, s[28:31], s50 offen nt lds
    s_add_u32 m0, s61, 48736
    s_add_u32 s50, s65, 140800
    buffer_load_dwordx4 v2, s[28:31], s50 offen nt lds
    s_waitcnt lgkmcnt(0)
    s_waitcnt vmcnt(16)
    s_barrier
    s_add_u32 m0, s61, 62464
    s_add_u32 s50, s65, 172032
    buffer_load_dwordx4 v2, s[24:27], s50 offen nt lds
    s_add_u32 m0, s61, 63504
    s_add_u32 s50, s65, 172544
    buffer_load_dwordx4 v2, s[24:27], s50 offen nt lds
    s_add_u32 m0, s61, 64576
    s_add_u32 s50, s65, 173056
    buffer_load_dwordx4 v2, s[24:27], s50 offen nt lds
    s_add_u32 m0, s61, 65616
    s_add_u32 s50, s65, 173568
    buffer_load_dwordx4 v2, s[24:27], s50 offen nt lds
    s_add_u32 m0, s61, 79360
    s_add_u32 s50, s65, 163840
    buffer_load_dwordx4 v2, s[28:31], s50 offen nt lds
    s_add_u32 m0, s61, 80416
    s_add_u32 s50, s65, 164352
    buffer_load_dwordx4 v2, s[28:31], s50 offen nt lds
    s_add_u32 m0, s61, 81472
    s_add_u32 s50, s65, 164864
    buffer_load_dwordx4 v2, s[28:31], s50 offen nt lds
    s_add_u32 m0, s61, 82528
    s_add_u32 s50, s65, 165376
    buffer_load_dwordx4 v2, s[28:31], s50 offen nt lds
    s_waitcnt lgkmcnt(0)
    s_add_u32 s65, s65, 131072
    s_mov_b32 s59, s67
    s_lshl_b32 s50, s96, 4
    s_load_dwordx4 s[84:87], s[16:17], s50
    s_waitcnt vmcnt(16)
    s_barrier
    s_add_u32 m0, s61, 113152
    s_add_u32 s50, s65, 40960
    buffer_load_dwordx4 v2, s[28:31], s50 offen nt lds
    s_add_u32 m0, s61, 114208
    s_add_u32 s50, s65, 41472
    buffer_load_dwordx4 v2, s[28:31], s50 offen nt lds
    s_add_u32 m0, s61, 115264
    s_add_u32 s50, s65, 41984
    buffer_load_dwordx4 v2, s[28:31], s50 offen nt lds
    s_add_u32 m0, s61, 116320
    s_add_u32 s50, s65, 42496
    buffer_load_dwordx4 v2, s[28:31], s50 offen nt lds
    s_waitcnt vmcnt(12)
    s_barrier
    s_lshl_b32 s51, s59, 7
    s_add_u32 s51, s51, s66
    s_add_u32 m0, s62, 130048
    s_add_u32 s50, s51, 0
    buffer_load_dwordx4 v5, s[36:39], s50 offen lds
    s_add_u32 m0, s62, 131072
    s_add_u32 s50, s51, 7168
    buffer_load_dwordx4 v5, s[36:39], s50 offen lds
    s_add_u32 m0, s62, 132096
    s_add_u32 s50, s51, 14336
    buffer_load_dwordx4 v5, s[36:39], s50 offen lds
    s_add_u32 m0, s62, 133120
    s_add_u32 s50, s51, 21504
    buffer_load_dwordx4 v5, s[36:39], s50 offen lds
    s_add_u32 m0, s62, 134144
    s_add_u32 s50, s51, 28672
    buffer_load_dwordx4 v5, s[36:39], s50 offen lds
    s_add_u32 m0, s62, 135168
    s_add_u32 s50, s51, 35840
    buffer_load_dwordx4 v5, s[36:39], s50 offen lds
    s_add_u32 m0, s62, 136192
    s_add_u32 s50, s51, 43008
    buffer_load_dwordx4 v5, s[36:39], s50 offen lds
    s_add_u32 m0, s62, 137216
    s_add_u32 s50, s51, 50176
    buffer_load_dwordx4 v5, s[36:39], s50 offen lds
    s_add_u32 s59, s59, 1
    s_cmp_eq_u32 s59, 7
    s_cselect_b32 s59, 0, s59
    s_waitcnt vmcnt(12)
    s_barrier
    s_waitcnt lgkmcnt(0)
    s_min_u32 s50, s84, s85
    s_min_u32 s50, s50, s86
    s_cmp_eq_u32 s50, 0
    s_cbranch_scc1 LA_hn
LA_hnret:
    s_and_b32 s88, s85, 0x2000
    s_and_b32 s89, s86, 0x2000
    v_mov_b32 v14, s88
    v_mov_b32 v15, s89
    v_mov_b32 v12, 64
    ds_write_b64 v12, v[14:15]
    s_lshl_b32 s51, s59, 7
    s_add_u32 s51, s51, s66
    s_add_u32 m0, s62, 29696
    s_add_u32 s50, s51, 0
    buffer_load_dwordx4 v5, s[36:39], s50 offen lds
    s_add_u32 m0, s62, 30720
    s_add_u32 s50, s51, 7168
    buffer_load_dwordx4 v5, s[36:39], s50 offen lds
    s_add_u32 m0, s62, 31744
    s_add_u32 s50, s51, 14336
    buffer_load_dwordx4 v5, s[36:39], s50 offen lds
    s_add_u32 m0, s62, 32768
    s_add_u32 s50, s51, 21504
    buffer_load_dwordx4 v5, s[36:39], s50 offen lds
    s_add_u32 m0, s62, 33792
    s_add_u32 s50, s51, 28672
    buffer_load_dwordx4 v5, s[36:39], s50 offen lds
    s_add_u32 m0, s62, 34816
    s_add_u32 s50, s51, 35840
    buffer_load_dwordx4 v5, s[36:39], s50 offen lds
    s_add_u32 m0, s62, 35840
    s_add_u32 s50, s51, 43008
    buffer_load_dwordx4 v5, s[36:39], s50 offen lds
    s_add_u32 m0, s62, 36864
    s_add_u32 s50, s51, 50176
    buffer_load_dwordx4 v5, s[36:39], s50 offen lds
    s_add_u32 s59, s59, 1
    s_cmp_eq_u32 s59, 7
    s_cselect_b32 s59, 0, s59
    s_waitcnt lgkmcnt(0)
    s_waitcnt vmcnt(16)
    s_barrier
    s_lshl_b32 s51, s59, 7
    s_add_u32 s51, s51, s66
    s_add_u32 m0, s62, 62464
    s_add_u32 s50, s51, 0
    buffer_load_dwordx4 v5, s[36:39], s50 offen lds
    s_add_u32 m0, s62, 63488
    s_add_u32 s50, s51, 7168
    buffer_load_dwordx4 v5, s[36:39], s50 offen lds
    s_add_u32 m0, s62, 64512
    s_add_u32 s50, s51, 14336
    buffer_load_dwordx4 v5, s[36:39], s50 offen lds
    s_add_u32 m0, s62, 65536
    s_add_u32 s50, s51, 21504
    buffer_load_dwordx4 v5, s[36:39], s50 offen lds
    s_add_u32 m0, s62, 66560
    s_add_u32 s50, s51, 28672
    buffer_load_dwordx4 v5, s[36:39], s50 offen lds
    s_add_u32 m0, s62, 67584
    s_add_u32 s50, s51, 35840
    buffer_load_dwordx4 v5, s[36:39], s50 offen lds
    s_add_u32 m0, s62, 68608
    s_add_u32 s50, s51, 43008
    buffer_load_dwordx4 v5, s[36:39], s50 offen lds
    s_add_u32 m0, s62, 69632
    s_add_u32 s50, s51, 50176
    buffer_load_dwordx4 v5, s[36:39], s50 offen lds
    s_add_u32 s59, s59, 1
    s_cmp_eq_u32 s59, 7
    s_cselect_b32 s59, 0, s59
    s_waitcnt vmcnt(16)
    s_barrier
    s_lshl_b32 s51, s59, 7
    s_add_u32 s51, s51, s66
    s_add_u32 m0, s62, 97280
    s_add_u32 s50, s51, 0
    buffer_load_dwordx4 v5, s[36:39], s50 offen lds
    s_add_u32 m0, s62, 98304
    s_add_u32 s50, s51, 7168
    buffer_load_dwordx4 v5, s[36:39], s50 offen lds
    s_add_u32 m0, s62, 99328
    s_add_u32 s50, s51, 14336
    buffer_load_dwordx4 v5, s[36:39], s50 offen lds
    s_add_u32 m0, s62, 100352
    s_add_u32 s50, s51, 21504
    buffer_load_dwordx4 v5, s[36:39], s50 offen lds
    s_add_u32 m0, s62, 101376
    s_add_u32 s50, s51, 28672
    buffer_load_dwordx4 v5, s[36:39], s50 offen lds
    s_add_u32 m0, s62, 102400
    s_add_u32 s50, s51, 35840
    buffer_load_dwordx4 v5, s[36:39], s50 offen lds
    s_add_u32 m0, s62, 103424
    s_add_u32 s50, s51, 43008
    buffer_load_dwordx4 v5, s[36:39], s50 offen lds
    s_add_u32 m0, s62, 104448
    s_add_u32 s50, s51, 50176
    buffer_load_dwordx4 v5, s[36:39], s50 offen lds
    s_add_u32 s59, s59, 1
    s_cmp_eq_u32 s59, 7
    s_cselect_b32 s59, 0, s59
    s_waitcnt vmcnt(16)
    s_barrier
    v_mov_b32 v12, 0
    ds_read_b128 v[16:19], v12
    s_lshl_b32 s50, s44, 2
    s_add_u32 s50, s50, 32
    v_mov_b32 v13, s50
    v_mov_b32 v14, 0
    ds_write_b32 v13, v14
    s_lshl_b32 s51, s59, 7
    s_add_u32 s51, s51, s66
    s_add_u32 m0, s62, 130048
    s_add_u32 s50, s51, 0
    buffer_load_dwordx4 v5, s[36:39], s50 offen lds
    s_add_u32 m0, s62, 131072
    s_add_u32 s50, s51, 7168
    buffer_load_dwordx4 v5, s[36:39], s50 offen lds
    s_add_u32 m0, s62, 132096
    s_add_u32 s50, s51, 14336
    buffer_load_dwordx4 v5, s[36:39], s50 offen lds
    s_add_u32 m0, s62, 133120
    s_add_u32 s50, s51, 21504
    buffer_load_dwordx4 v5, s[36:39], s50 offen lds
    s_add_u32 m0, s62, 134144
    s_add_u32 s50, s51, 28672
    buffer_load_dwordx4 v5, s[36:39], s50 offen lds
    s_add_u32 m0, s62, 135168
    s_add_u32 s50, s51, 35840
    buffer_load_dwordx4 v5, s[36:39], s50 offen lds
    s_add_u32 m0, s62, 136192
    s_add_u32 s50, s51, 43008
    buffer_load_dwordx4 v5, s[36:39], s50 offen lds
    s_add_u32 m0, s62, 137216
    s_add_u32 s50, s51, 50176
    buffer_load_dwordx4 v5, s[36:39], s50 offen lds
    s_add_u32 s59, s59, 1
    s_cmp_eq_u32 s59, 7
    s_cselect_b32 s59, 0, s59
    s_waitcnt lgkmcnt(0)
    v_or3_b32 v16, v16, v17, v18
    v_or_b32 v16, v16, v19
    v_cmp_ne_u32 vcc, 0, v16
    s_cbranch_vccnz LA_hredo
    s_waitcnt vmcnt(16)
    s_barrier
    s_lshl_b32 s51, s59, 7
    s_add_u32 s51, s51, s66
    s_add_u32 m0, s62, 29696
    s_add_u32 s50, s51, 0
    buffer_load_dwordx4 v5, s[36:39], s50 offen lds
    s_add_u32 m0, s62, 30720
    s_add_u32 s50, s51, 7168
    buffer_load_dwordx4 v5, s[36:39], s50 offen lds
    s_add_u32 m0, s62, 31744
    s_add_u32 s50, s51, 14336
    buffer_load_dwordx4 v5, s[36:39], s50 offen lds
    s_add_u32 m0, s62, 32768
    s_add_u32 s50, s51, 21504
    buffer_load_dwordx4 v5, s[36:39], s50 offen lds
    s_add_u32 m0, s62, 33792
    s_add_u32 s50, s51, 28672
    buffer_load_dwordx4 v5, s[36:39], s50 offen lds
    s_add_u32 m0, s62, 34816
    s_add_u32 s50, s51, 35840
    buffer_load_dwordx4 v5, s[36:39], s50 offen lds
    s_add_u32 m0, s62, 35840
    s_add_u32 s50, s51, 43008
    buffer_load_dwordx4 v5, s[36:39], s50 offen lds
    s_add_u32 m0, s62, 36864
    s_add_u32 s50, s51, 50176
    buffer_load_dwordx4 v5, s[36:39], s50 offen lds
    s_add_u32 s59, s59, 1
    s_cmp_eq_u32 s59, 7
    s_cselect_b32 s59, 0, s59
    s_waitcnt vmcnt(16)
    s_barrier
    s_lshl_b32 s51, s59, 7
    s_add_u32 s51, s51, s66
    s_add_u32 m0, s62, 62464
    s_add_u32 s50, s51, 0
    buffer_load_dwordx4 v5, s[36:39], s50 offen lds
    s_add_u32 m0, s62, 63488
    s_add_u32 s50, s51, 7168
    buffer_load_dwordx4 v5, s[36:39], s50 offen lds
    s_add_u32 m0, s62, 64512
    s_add_u32 s50, s51, 14336
    buffer_load_dwordx4 v5, s[36:39], s50 offen lds
    s_add_u32 m0, s62, 65536
    s_add_u32 s50, s51, 21504
    buffer_load_dwordx4 v5, s[36:39], s50 offen lds
    s_add_u32 m0, s62, 66560
    s_add_u32 s50, s51, 28672
    buffer_load_dwordx4 v5, s[36:39], s50 offen lds
    s_add_u32 m0, s62, 67584
    s_add_u32 s50, s51, 35840
    buffer_load_dwordx4 v5, s[36:39], s50 offen lds
    s_add_u32 m0, s62, 68608
    s_add_u32 s50, s51, 43008
    buffer_load_dwordx4 v5, s[36:39], s50 offen lds
    s_add_u32 m0, s62, 69632
    s_add_u32 s50, s51, 50176
    buffer_load_dwordx4 v5, s[36:39], s50 offen lds
    s_add_u32 s59, s59, 1
    s_cmp_eq_u32 s59, 7
    s_cselect_b32 s59, 0, s59
    s_waitcnt vmcnt(8)
    s_barrier
    v_mov_b32 v14, 1
    s_waitcnt vmcnt(0)
    ds_write_b32 v13, v14
    s_add_u32 s51, s3, s88
    s_add_u32 s51, s51, 236544
    v_mov_b32 v4, 0
    v_mov_b32 v84, 1
    s_mov_b64 exec, 1
    buffer_atomic_add v84, v4, s[40:43], s51 offen sc0 sc1
    s_mov_b64 exec, -1
    s_waitcnt vmcnt(0)
    v_readfirstlane_b32 s54, v84
    s_nop 3
    s_cmp_ge_u32 s54, 42
    s_cbranch_scc1 LA_end
    s_add_u32 s44, s44, 4
LA_rsetup:
    s_add_u32 s63, s3, s88
    s_add_u32 s63, s63, 229376
    v_mov_b32 v4, 0
    v_lshrrev_b32 v8, 3, v0
    v_and_b32 v9, 7, v0
    v_lshlrev_b32 v2, 8, v8
    v_lshl_add_u32 v2, v9, 4, v2
    v_mul_u32_u24 v3, 896, v9
    v_lshrrev_b32 v10, 5, v0
    v_lshl_add_u32 v3, v10, 6, v3
    v_and_b32 v8, 3, v8
    v_lshl_add_u32 v3, v8, 3, v3
    s_lshl_b32 s50, s44, 10
    s_add_u32 s50, s50, 2304
    v_lshlrev_b32 v5, 7, v9
    v_lshl_add_u32 v5, v10, 6, v5
    v_lshl_add_u32 v5, v8, 3, v5
    v_add_u32 v5, s50, v5
    v_lshl_add_u32 v6, v0, 4, s50
    v_lshrrev_b32 v8, 3, v0
    v_mul_u32_u24 v3, 896, v8
    v_lshl_add_u32 v3, v9, 4, v3
LA_rnext:
    s_sub_u32 s50, 139, s54
    s_cmp_ge_u32 s54, 42
    s_cselect_b32 s54, s50, s54
LA_rloop:
    s_mul_i32 s59, s54, 4682
    s_lshr_b32 s59, s59, 16
    s_mul_i32 s50, s59, 14
    s_sub_u32 s56, s54, s50
    s_add_u32 s59, s67, s59
    s_sub_u32 s50, s59, 7
    s_cmp_ge_u32 s59, 7
    s_cselect_b32 s59, s50, s59
    s_lshr_b32 s52, s56, 2
    s_lshl_b32 s51, s59, 2
    s_add_u32 s51, s51, s52
    s_mul_i32 s51, s51, 256
    s_add_u32 s51, s51, s63
    s_lshr_b32 s64, s52, 1
    s_lshl_b32 s64, s64, 14
    s_and_b32 s50, s52, 1
    s_lshl_b32 s50, s50, 12
    s_add_u32 s64, s64, s50
    s_add_u32 s64, s64, s3
    s_bfe_u32 s50, s56, 0x10001
    s_lshl_b32 s50, s50, 11
    s_add_u32 s64, s64, s50
    s_and_b32 s50, s56, 1
    s_lshl_b32 s50, s50, 7
    s_add_u32 s64, s64, s50
    s_mul_i32 s66, s96, 112
    s_lshl_b32 s50, s56, 3
    s_add_u32 s66, s66, s50
    s_mul_i32 s66, s66, 896
    s_mov_b32 s55, 30000
    s_lshl_b32 s50, s59, 15
    s_add_u32 s64, s50, s64
    s_add_u32 s65, s64, s89
    s_add_u32 s64, s64, s88
    s_mov_b32 s57, 0x04040404
LA_poll:
    s_mov_b64 exec, 1
    v_mov_b32 v84, 0
    s_sub_u32 s55, s55, 1
    buffer_atomic_add v84, v4, s[40:43], s51 offen sc0 sc1
    s_mov_b64 exec, -1
    s_waitcnt vmcnt(0)
LA_chk:
    v_readfirstlane_b32 s58, v84
    s_cmp_eq_u32 s55, 0
    s_cselect_b32 s58, -1, s58
    s_and_b32 s58, s58, s57
    s_cbranch_scc1 LA_go
    s_sleep 4
    s_branch LA_poll
LA_go:
    s_bitcmp1_b32 s58, 2
    s_cbranch_scc0 LA_l0
    s_add_u32 s50, s64, 0
    buffer_load_dwordx4 v[16:19], v2, s[40:43], s50 offen sc0 sc1
    s_add_u32 s50, s64, 262144
    buffer_load_dwordx4 v[20:23], v2, s[40:43], s50 offen sc0 sc1
    s_add_u32 s50, s64, 524288
    buffer_load_dwordx4 v[24:27], v2, s[40:43], s50 offen sc0 sc1
    s_add_u32 s50, s64, 786432
    buffer_load_dwordx4 v[28:31], v2, s[40:43], s50 offen sc0 sc1
LA_l0:
    s_bitcmp1_b32 s58, 10
    s_cbranch_scc0 LA_l1
    s_add_u32 s50, s64, 1048576
    buffer_load_dwordx4 v[32:35], v2, s[40:43], s50 offen sc0 sc1
    s_add_u32 s50, s64, 1310720
    buffer_load_dwordx4 v[36:39], v2, s[40:43], s50 offen sc0 sc1
    s_add_u32 s50, s64, 1572864
    buffer_load_dwordx4 v[40:43], v2, s[40:43], s50 offen sc0 sc1
    s_add_u32 s50, s64, 1835008
    buffer_load_dwordx4 v[44:47], v2, s[40:43], s50 offen sc0 sc1
LA_l1:
    s_bitcmp1_b32 s58, 18
    s_cbranch_scc0 LA_l2
    s_add_u32 s50, s65, 2097152
    buffer_load_dwordx4 v[48:51], v2, s[40:43], s50 offen sc0 sc1
    s_add_u32 s50, s65, 2359296
    buffer_load_dwordx4 v[52:55], v2, s[40:43], s50 offen sc0 sc1
    s_add_u32 s50, s65, 2621440
    buffer_load_dwordx4 v[56:59], v2, s[40:43], s50 offen sc0 sc1
    s_add_u32 s50, s65, 2883584
    buffer_load_dwordx4 v[60:63], v2, s[40:43], s50 offen sc0 sc1
LA_l2:
    s_bitcmp1_b32 s58, 26
    s_cbranch_scc0 LA_l3
    s_add_u32 s50, s65, 3145728
    buffer_load_dwordx4 v[64:67], v2, s[40:43], s50 offen sc0 sc1
    s_add_u32 s50, s65, 3407872
    buffer_load_dwordx4 v[68:71], v2, s[40:43], s50 offen sc0 sc1
    s_add_u32 s50, s65, 3670016
    buffer_load_dwordx4 v[72:75], v2, s[40:43], s50 offen sc0 sc1
    s_add_u32 s50, s65, 3932160
    buffer_load_dwordx4 v[76:79], v2, s[40:43], s50 offen sc0 sc1
LA_l3:
    s_waitcnt vmcnt(0)
    s_cmp_eq_u32 s58, s57
    s_cbranch_scc1 LA_np
    s_mov_b64 exec, 1
    v_mov_b32 v84, 0
    buffer_atomic_add v84, v4, s[40:43], s51 offen sc0 sc1
    s_mov_b64 exec, -1
LA_np:
    s_bitcmp1_b32 s58, 2
    s_cbranch_scc0 LA_a0
    v_lshlrev_b32 v96, 16, v16
    v_and_b32 v97, 0xffff0000, v16
    v_lshlrev_b32 v98, 16, v17
    v_and_b32 v99, 0xffff0000, v17
    v_lshlrev_b32 v100, 16, v18
    v_and_b32 v101, 0xffff0000, v18
    v_lshlrev_b32 v102, 16, v19
    v_and_b32 v103, 0xffff0000, v19
    v_lshlrev_b32 v86, 16, v20
    v_and_b32 v87, 0xffff0000, v20
    v_pk_add_f32 v[96:97], v[96:97], v[86:87]
    v_lshlrev_b32 v88, 16, v21
    v_and_b32 v89, 0xffff0000, v21
    v_pk_add_f32 v[98:99], v[98:99], v[88:89]
    v_lshlrev_b32 v86, 16, v22
    v_and_b32 v87, 0xffff0000, v22
    v_pk_add_f32 v[100:101], v[100:101], v[86:87]
    v_lshlrev_b32 v88, 16, v23
    v_and_b32 v89, 0xffff0000, v23
    v_pk_add_f32 v[102:103], v[102:103], v[88:89]
    v_lshlrev_b32 v86, 16, v24
    v_and_b32 v87, 0xffff0000, v24
    v_pk_add_f32 v[96:97], v[96:97], v[86:87]
    v_lshlrev_b32 v88, 16, v25
    v_and_b32 v89, 0xffff0000, v25
    v_pk_add_f32 v[98:99], v[98:99], v[88:89]
    v_lshlrev_b32 v86, 16, v26
    v_and_b32 v87, 0xffff0000, v26
    v_pk_add_f32 v[100:101], v[100:101], v[86:87]
    v_lshlrev_b32 v88, 16, v27
    v_and_b32 v89, 0xffff0000, v27
    v_pk_add_f32 v[102:103], v[102:103], v[88:89]
    v_lshlrev_b32 v86, 16, v28
    v_and_b32 v87, 0xffff0000, v28
    v_pk_add_f32 v[96:97], v[96:97], v[86:87]
    v_lshlrev_b32 v88, 16, v29
    v_and_b32 v89, 0xffff0000, v29
    v_pk_add_f32 v[98:99], v[98:99], v[88:89]
    v_lshlrev_b32 v86, 16, v30
    v_and_b32 v87, 0xffff0000, v30
    v_pk_add_f32 v[100:101], v[100:101], v[86:87]
    v_lshlrev_b32 v88, 16, v31
    v_and_b32 v89, 0xffff0000, v31
    v_pk_add_f32 v[102:103], v[102:103], v[88:89]
LA_a0:
    s_bitcmp1_b32 s58, 10
    s_cbranch_scc0 LA_a1
    v_lshlrev_b32 v104, 16, v32
    v_and_b32 v105, 0xffff0000, v32
    v_lshlrev_b32 v106, 16, v33
    v_and_b32 v107, 0xffff0000, v33
    v_lshlrev_b32 v108, 16, v34
    v_and_b32 v109, 0xffff0000, v34
    v_lshlrev_b32 v110, 16, v35
    v_and_b32 v111, 0xffff0000, v35
    v_lshlrev_b32 v86, 16, v36
    v_and_b32 v87, 0xffff0000, v36
    v_pk_add_f32 v[104:105], v[104:105], v[86:87]
    v_lshlrev_b32 v88, 16, v37
    v_and_b32 v89, 0xffff0000, v37
    v_pk_add_f32 v[106:107], v[106:107], v[88:89]
    v_lshlrev_b32 v86, 16, v38
    v_and_b32 v87, 0xffff0000, v38
    v_pk_add_f32 v[108:109], v[108:109], v[86:87]
    v_lshlrev_b32 v88, 16, v39
    v_and_b32 v89, 0xffff0000, v39
    v_pk_add_f32 v[110:111], v[110:111], v[88:89]
    v_lshlrev_b32 v86, 16, v40
    v_and_b32 v87, 0xffff0000, v40
    v_pk_add_f32 v[104:105], v[104:105], v[86:87]
    v_lshlrev_b32 v88, 16, v41
    v_and_b32 v89, 0xffff0000, v41
    v_pk_add_f32 v[106:107], v[106:107], v[88:89]
    v_lshlrev_b32 v86, 16, v42
    v_and_b32 v87, 0xffff0000, v42
    v_pk_add_f32 v[108:109], v[108:109], v[86:87]
    v_lshlrev_b32 v88, 16, v43
    v_and_b32 v89, 0xffff0000, v43
    v_pk_add_f32 v[110:111], v[110:111], v[88:89]
    v_lshlrev_b32 v86, 16, v44
    v_and_b32 v87, 0xffff0000, v44
    v_pk_add_f32 v[104:105], v[104:105], v[86:87]
    v_lshlrev_b32 v88, 16, v45
    v_and_b32 v89, 0xffff0000, v45
    v_pk_add_f32 v[106:107], v[106:107], v[88:89]
    v_lshlrev_b32 v86, 16, v46
    v_and_b32 v87, 0xffff0000, v46
    v_pk_add_f32 v[108:109], v[108:109], v[86:87]
    v_lshlrev_b32 v88, 16, v47
    v_and_b32 v89, 0xffff0000, v47
    v_pk_add_f32 v[110:111], v[110:111], v[88:89]
LA_a1:
    s_bitcmp1_b32 s58, 18
    s_cbranch_scc0 LA_a2
    v_lshlrev_b32 v112, 16, v48
    v_and_b32 v113, 0xffff0000, v48
    v_lshlrev_b32 v114, 16, v49
    v_and_b32 v115, 0xffff0000, v49
    v_lshlrev_b32 v116, 16, v50
    v_and_b32 v117, 0xffff0000, v50
    v_lshlrev_b32 v118, 16, v51
    v_and_b32 v119, 0xffff0000, v51
    v_lshlrev_b32 v86, 16, v52
    v_and_b32 v87, 0xffff0000, v52
    v_pk_add_f32 v[112:113], v[112:113], v[86:87]
    v_lshlrev_b32 v88, 16, v53
    v_and_b32 v89, 0xffff0000, v53
    v_pk_add_f32 v[114:115], v[114:115], v[88:89]
    v_lshlrev_b32 v86, 16, v54
    v_and_b32 v87, 0xffff0000, v54
    v_pk_add_f32 v[116:117], v[116:117], v[86:87]
    v_lshlrev_b32 v88, 16, v55
    v_and_b32 v89, 0xffff0000, v55
    v_pk_add_f32 v[118:119], v[118:119], v[88:89]
    v_lshlrev_b32 v86, 16, v56
    v_and_b32 v87, 0xffff0000, v56
    v_pk_add_f32 v[112:113], v[112:113], v[86:87]
    v_lshlrev_b32 v88, 16, v57
    v_and_b32 v89, 0xffff0000, v57
    v_pk_add_f32 v[114:115], v[114:115], v[88:89]
    v_lshlrev_b32 v86, 16, v58
    v_and_b32 v87, 0xffff0000, v58
    v_pk_add_f32 v[116:117], v[116:117], v[86:87]
    v_lshlrev_b32 v88, 16, v59
    v_and_b32 v89, 0xffff0000, v59
    v_pk_add_f32 v[118:119], v[118:119], v[88:89]
    v_lshlrev_b32 v86, 16, v60
    v_and_b32 v87, 0xffff0000, v60
    v_pk_add_f32 v[112:113], v[112:113], v[86:87]
    v_lshlrev_b32 v88, 16, v61
    v_and_b32 v89, 0xffff0000, v61
    v_pk_add_f32 v[114:115], v[114:115], v[88:89]
    v_lshlrev_b32 v86, 16, v62
    v_and_b32 v87, 0xffff0000, v62
    v_pk_add_f32 v[116:117], v[116:117], v[86:87]
    v_lshlrev_b32 v88, 16, v63
    v_and_b32 v89, 0xffff0000, v63
    v_pk_add_f32 v[118:119], v[118:119], v[88:89]
LA_a2:
    s_bitcmp1_b32 s58, 26
    s_cbranch_scc0 LA_a3
    v_lshlrev_b32 v120, 16, v64
    v_and_b32 v121, 0xffff0000, v64
    v_lshlrev_b32 v122, 16, v65
    v_and_b32 v123, 0xffff0000, v65
    v_lshlrev_b32 v124, 16, v66
    v_and_b32 v125, 0xffff0000, v66
    v_lshlrev_b32 v126, 16, v67
    v_and_b32 v127, 0xffff0000, v67
    v_lshlrev_b32 v86, 16, v68
    v_and_b32 v87, 0xffff0000, v68
    v_pk_add_f32 v[120:121], v[120:121], v[86:87]
    v_lshlrev_b32 v88, 16, v69
    v_and_b32 v89, 0xffff0000, v69
    v_pk_add_f32 v[122:123], v[122:123], v[88:89]
    v_lshlrev_b32 v86, 16, v70
    v_and_b32 v87, 0xffff0000, v70
    v_pk_add_f32 v[124:125], v[124:125], v[86:87]
    v_lshlrev_b32 v88, 16, v71
    v_and_b32 v89, 0xffff0000, v71
    v_pk_add_f32 v[126:127], v[126:127], v[88:89]
    v_lshlrev_b32 v86, 16, v72
    v_and_b32 v87, 0xffff0000, v72
    v_pk_add_f32 v[120:121], v[120:121], v[86:87]
    v_lshlrev_b32 v88, 16, v73
    v_and_b32 v89, 0xffff0000, v73
    v_pk_add_f32 v[122:123], v[122:123], v[88:89]
    v_lshlrev_b32 v86, 16, v74
    v_and_b32 v87, 0xffff0000, v74
    v_pk_add_f32 v[124:125], v[124:125], v[86:87]
    v_lshlrev_b32 v88, 16, v75
    v_and_b32 v89, 0xffff0000, v75
    v_pk_add_f32 v[126:127], v[126:127], v[88:89]
    v_lshlrev_b32 v86, 16, v76
    v_and_b32 v87, 0xffff0000, v76
    v_pk_add_f32 v[120:121], v[120:121], v[86:87]
    v_lshlrev_b32 v88, 16, v77
    v_and_b32 v89, 0xffff0000, v77
    v_pk_add_f32 v[122:123], v[122:123], v[88:89]
    v_lshlrev_b32 v86, 16, v78
    v_and_b32 v87, 0xffff0000, v78
    v_pk_add_f32 v[124:125], v[124:125], v[86:87]
    v_lshlrev_b32 v88, 16, v79
    v_and_b32 v89, 0xffff0000, v79
    v_pk_add_f32 v[126:127], v[126:127], v[88:89]
LA_a3:
    s_andn2_b32 s57, s57, s58
    s_cbranch_scc0 LA_fin
    s_waitcnt vmcnt(0)
    s_branch LA_chk
LA_fin:
    v_pk_add_f32 v[8:9], v[96:97], v[104:105]
    v_pk_add_f32 v[10:11], v[98:99], v[106:107]
    v_pk_add_f32 v[12:13], v[100:101], v[108:109]
    v_pk_add_f32 v[14:15], v[102:103], v[110:111]
    v_pk_add_f32 v[112:113], v[112:113], v[120:121]
    v_pk_add_f32 v[114:115], v[114:115], v[122:123]
    v_pk_add_f32 v[116:117], v[116:117], v[124:125]
    v_pk_add_f32 v[118:119], v[118:119], v[126:127]
    v_pk_add_f32 v[8:9], v[8:9], v[112:113]
    v_pk_add_f32 v[10:11], v[10:11], v[114:115]
    v_pk_add_f32 v[12:13], v[12:13], v[116:117]
    v_pk_add_f32 v[14:15], v[14:15], v[118:119]
    v_cvt_pk_bf16_f32 v80, v8, v9
    v_cvt_pk_bf16_f32 v81, v10, v11
    v_cvt_pk_bf16_f32 v82, v12, v13
    v_cvt_pk_bf16_f32 v83, v14, v15
    s_lshl_b32 s50, s59, 7
    s_add_u32 s50, s50, s66
    ds_write_b64 v5, v[80:81]
    ds_write_b64 v5, v[82:83] offset:32
    s_waitcnt lgkmcnt(0)
    ds_read_b128 v[80:83], v6
    s_waitcnt lgkmcnt(0)
    buffer_store_dwordx4 v[80:83], v3, s[92:95], s50 offen sc0 sc1
LA_end:
    s_endpgm
LA_hredo:
    s_waitcnt vmcnt(0)
    s_barrier
    s_mov_b32 s97, 1
    s_branch LA_hrestart
LA_hn:
    s_lshl_b32 s50, s96, 4
    v_mov_b32 v12, s50
    s_mov_b32 s51, 30000
LA_hn1:
    global_load_dwordx4 v[16:19], v12, s[16:17] sc0 sc1
    s_sub_u32 s51, s51, 1
    s_waitcnt vmcnt(0)
    v_readfirstlane_b32 s85, v17
    v_readfirstlane_b32 s86, v18
    v_min3_u32 v16, v16, v17, v18
    v_cmp_eq_u32 vcc, 0, v16
    s_cbranch_vccz LA_hnret
    s_cmp_lg_u32 s51, 0
    s_cbranch_scc1 LA_hn1
    s_branch LA_hnret
LA_me8:
    s_add_u32 s50, s74, 0
    s_memtime s[76:77]
    s_load_dword s80, s[18:19], s50
    s_waitcnt lgkmcnt(0)
    s_memtime s[78:79]
    s_waitcnt lgkmcnt(0)
    s_sub_u32 s78, s78, s76
    s_min_u32 s78, s78, 3000
    s_add_u32 s72, s72, s78
    s_branch LA_mr8
LA_sl8_0:
    s_add_u32 s50, s65, 458752
    buffer_load_dwordx4 v[96:99], v2, s[24:27], s50 offen nt
    s_branch LA_sr8
LA_me9:
    s_add_u32 s50, s74, 8192
    s_memtime s[76:77]
    s_load_dword s80, s[18:19], s50
    s_waitcnt lgkmcnt(0)
    s_memtime s[78:79]
    s_waitcnt lgkmcnt(0)
    s_sub_u32 s78, s78, s76
    s_min_u32 s78, s78, 3000
    s_add_u32 s73, s73, s78
    s_add_u32 s74, s74, 1344
    s_branch LA_mr9
LA_sl9_1:
    s_add_u32 s50, s65, 393728
    buffer_load_dwordx4 v[100:103], v2, s[24:27], s50 offen nt
    s_branch LA_sr9
LA_me10:
    s_add_u32 s50, s74, 8192
    s_memtime s[76:77]
    s_load_dword s80, s[18:19], s50
    s_waitcnt lgkmcnt(0)
    s_memtime s[78:79]
    s_waitcnt lgkmcnt(0)
    s_sub_u32 s78, s78, s76
    s_min_u32 s78, s78, 3000
    s_add_u32 s73, s73, s78
    s_branch LA_mr10
LA_sl10_2:
    s_add_u32 s50, s65, 328704
    buffer_load_dwordx4 v[104:107], v2, s[24:27], s50 offen nt
    s_branch LA_sr10
LA_me11:
    s_add_u32 s50, s74, 0
    s_memtime s[76:77]
    s_load_dword s80, s[18:19], s50
    s_waitcnt lgkmcnt(0)
    s_memtime s[78:79]
    s_waitcnt lgkmcnt(0)
    s_sub_u32 s78, s78, s76
    s_min_u32 s78, s78, 3000
    s_add_u32 s72, s72, s78
    s_add_u32 s74, s74, 1344
    s_cmp_lg_u32 s54, 5
    s_cbranch_scc1 LA_mr11
    s_cmp_lt_u32 s73, s72
    s_cselect_b32 s50, 3, 1
    s_lshl_b32 s50, s50, 12
    s_lshr_b32 s51, s46, 1
    s_lshl_b32 s52, s96, 4
    s_add_u32 s51, s51, s52
    v_mov_b32 v12, s51
    v_mov_b32 v13, s50
    s_mov_b64 exec, 1
    global_store_dword v12, v13, s[16:17] offset:4 sc0 sc1
    s_mov_b64 exec, -1
    s_mov_b32 s75, 1
    s_branch LA_mr11
LA_sl11_3:
    s_add_u32 s50, s65, 263680
    buffer_load_dwordx4 v[108:111], v2, s[24:27], s50 offen nt
    s_branch LA_sr11
    .p2align 6
LA_compute:
    s_setprio 3
LA_crestart:
    v_mbcnt_lo_u32_b32 v255, -1, 0
    v_mbcnt_hi_u32_b32 v255, -1, v255
    s_mov_b32 s68, 0x3db8aa3b
    v_lshrrev_b32 v192, 4, v255
    v_and_b32 v193, 15, v255
    v_lshrrev_b32 v194, 2, v255
    v_and_b32 v195, 3, v255
    v_mul_u32_u24 v252, 1056, v194
    v_lshl_add_u32 v252, v195, 3, v252
    v_add_u32 v249, 62464, v252
    v_mul_u32_u24 v248, 1056, v193
    v_lshl_add_u32 v248, v192, 4, v248
    s_lshl_b32 s50, s44, 8
    s_add_u32 s50, s50, 11776
    v_add_u32 v248, s50, v248
    v_lshrrev_b32 v196, 1, v193
    v_and_b32 v197, 1, v255
    v_lshl_add_u32 v196, v196, 2, v197
    v_bfe_u32 v197, v255, 4, 1
    v_lshl_add_u32 v196, v197, 1, v196
    v_lshrrev_b32 v197, 5, v255
    v_add_u32 v196, v196, v197
    v_lshlrev_b32 v253, 10, v193
    v_lshl_add_u32 v253, v196, 4, v253
    s_waitcnt lgkmcnt(0)
    s_mov_b32 s40, s18
    s_mov_b32 s41, s19
    s_mov_b32 s42, 268435456
    s_mov_b32 s43, 0x20000
    s_mov_b32 s92, s14
    s_mov_b32 s93, s15
    s_mov_b32 s94, 1605632
    s_mov_b32 s95, 0x20000
    s_sub_u32 s3, 0, s18
    s_and_b32 s3, s3, 0x1fffff
    s_lshl_b32 s50, s96, 22
    s_add_u32 s3, s3, s50
    s_or_b32 s50, s44, s46
    s_or_b32 s50, s50, s97
    s_cmp_lg_u32 s50, 0
    s_cbranch_scc1 LA_noinit
    s_add_u32 s50, s3, 229376
    v_lshlrev_b32 v128, 8, v255
    v_mov_b32 v129, 0
    buffer_store_dword v129, v128, s[40:43], s50 offen sc0 sc1
    s_mov_b64 exec, -1
LA_noinit:
    v_mov_b64 v[0:1], 0
    v_mov_b64 v[2:3], 0
    v_mov_b64 v[4:5], 0
    v_mov_b64 v[6:7], 0
    v_mov_b64 v[8:9], 0
    v_mov_b64 v[10:11], 0
    v_mov_b64 v[12:13], 0
    v_mov_b64 v[14:15], 0
    v_mov_b64 v[16:17], 0
    v_mov_b64 v[18:19], 0
    v_mov_b64 v[20:21], 0
    v_mov_b64 v[22:23], 0
    v_mov_b64 v[24:25], 0
    v_mov_b64 v[26:27], 0
    v_mov_b64 v[28:29], 0
    v_mov_b64 v[30:31], 0
    v_mov_b64 v[32:33], 0
    v_mov_b64 v[34:35], 0
    v_mov_b64 v[36:37], 0
    v_mov_b64 v[38:39], 0
    v_mov_b64 v[40:41], 0
    v_mov_b64 v[42:43], 0
    v_mov_b64 v[44:45], 0
    v_mov_b64 v[46:47], 0
    v_mov_b64 v[48:49], 0
    v_mov_b64 v[50:51], 0
    v_mov_b64 v[52:53], 0
    v_mov_b64 v[54:55], 0
    v_mov_b64 v[56:57], 0
    v_mov_b64 v[58:59], 0
    v_mov_b64 v[60:61], 0
    v_mov_b64 v[62:63], 0
    v_mov_b64 v[64:65], 0
    v_mov_b64 v[66:67], 0
    v_mov_b64 v[68:69], 0
    v_mov_b64 v[70:71], 0
    v_mov_b64 v[72:73], 0
    v_mov_b64 v[74:75], 0
    v_mov_b64 v[76:77], 0
    v_mov_b64 v[78:79], 0
    v_mov_b64 v[80:81], 0
    v_mov_b64 v[82:83], 0
    v_mov_b64 v[84:85], 0
    v_mov_b64 v[86:87], 0
    v_mov_b64 v[88:89], 0
    v_mov_b64 v[90:91], 0
    v_mov_b64 v[92:93], 0
    v_mov_b64 v[94:95], 0
    v_mov_b64 v[96:97], 0
    v_mov_b64 v[98:99], 0
    v_mov_b64 v[100:101], 0
    v_mov_b64 v[102:103], 0
    v_mov_b64 v[104:105], 0
    v_mov_b64 v[106:107], 0
    v_mov_b64 v[108:109], 0
    v_mov_b64 v[110:111], 0
    v_mov_b64 v[112:113], 0
    v_mov_b64 v[114:115], 0
    v_mov_b64 v[116:117], 0
    v_mov_b64 v[118:119], 0
    v_mov_b64 v[120:121], 0
    v_mov_b64 v[122:123], 0
    v_mov_b64 v[124:125], 0
    v_mov_b64 v[126:127], 0
    v_mov_b64 v[250:251], 0
    s_mov_b32 s54, 6
    s_mov_b32 s56, 0
    s_cmp_eq_u32 s44, 3
    s_cbranch_scc1 LA_c1
    s_branch LA_b02
LA_hb2:
    s_barrier
    s_branch LA_nh2
LA_b02:
    s_barrier
    ds_read_b128 v[208:211], v248 offset:0
    ds_read_b128 v[212:215], v248 offset:128
    ds_read_b64_tr_b16 v[224:225], v249 offset:0
    ds_read_b64_tr_b16 v[226:227], v249 offset:512
    ds_read_b64_tr_b16 v[228:229], v249 offset:32
    ds_read_b64_tr_b16 v[230:231], v249 offset:544
    ds_read_b64_tr_b16 v[232:233], v249 offset:64
    ds_read_b64_tr_b16 v[234:235], v249 offset:576
    ds_read_b64_tr_b16 v[236:237], v249 offset:96
    ds_read_b64_tr_b16 v[238:239], v249 offset:608
    ds_read_b64_tr_b16 v[240:241], v249 offset:128
    ds_read_b64_tr_b16 v[242:243], v249 offset:640
    ds_read_b64_tr_b16 v[244:245], v249 offset:160
    ds_read_b64_tr_b16 v[246:247], v249 offset:672
    s_waitcnt lgkmcnt(10)
    .p2align 3
LA_qp2:
    v_mfma_f32_16x16x32_bf16 v[0:3], v[224:227], v[208:211], v[0:3]
    v_mfma_f32_16x16x32_bf16 v[64:67], v[224:227], v[212:215], v[64:67]
    s_waitcnt lgkmcnt(8)
    ds_read_b64_tr_b16 v[192:193], v249 offset:192
    v_mfma_f32_16x16x32_bf16 v[4:7], v[228:231], v[208:211], v[4:7]
    ds_read_b64_tr_b16 v[194:195], v249 offset:704
    v_mfma_f32_16x16x32_bf16 v[68:71], v[228:231], v[212:215], v[68:71]
    s_waitcnt lgkmcnt(8)
    ds_read_b64_tr_b16 v[196:197], v249 offset:224
    v_mfma_f32_16x16x32_bf16 v[8:11], v[232:235], v[208:211], v[8:11]
    ds_read_b64_tr_b16 v[198:199], v249 offset:736
    v_mfma_f32_16x16x32_bf16 v[72:75], v[232:235], v[212:215], v[72:75]
    s_waitcnt lgkmcnt(8)
    ds_read_b64_tr_b16 v[224:225], v249 offset:256
    v_mfma_f32_16x16x32_bf16 v[12:15], v[236:239], v[208:211], v[12:15]
    ds_read_b128 v[216:219], v248 offset:64
    ds_read_b64_tr_b16 v[226:227], v249 offset:768
    v_mfma_f32_16x16x32_bf16 v[76:79], v[236:239], v[212:215], v[76:79]
    s_waitcnt lgkmcnt(9)
    ds_read_b64_tr_b16 v[228:229], v249 offset:288
    v_mfma_f32_16x16x32_bf16 v[16:19], v[240:243], v[208:211], v[16:19]
    ds_read_b64_tr_b16 v[230:231], v249 offset:800
    v_mfma_f32_16x16x32_bf16 v[80:83], v[240:243], v[212:215], v[80:83]
    s_waitcnt lgkmcnt(9)
    ds_read_b64_tr_b16 v[232:233], v249 offset:320
    v_mfma_f32_16x16x32_bf16 v[20:23], v[244:247], v[208:211], v[20:23]
    ds_read_b128 v[220:223], v248 offset:192
    ds_read_b64_tr_b16 v[234:235], v249 offset:832
    v_mfma_f32_16x16x32_bf16 v[84:87], v[244:247], v[212:215], v[84:87]
    s_waitcnt lgkmcnt(10)
    ds_read_b64_tr_b16 v[236:237], v249 offset:352
    v_mfma_f32_16x16x32_bf16 v[24:27], v[192:195], v[208:211], v[24:27]
    ds_read_b64_tr_b16 v[238:239], v249 offset:864
    v_mfma_f32_16x16x32_bf16 v[88:91], v[192:195], v[212:215], v[88:91]
    s_waitcnt lgkmcnt(10)
    ds_read_b64_tr_b16 v[240:241], v249 offset:384
    v_mfma_f32_16x16x32_bf16 v[28:31], v[196:199], v[208:211], v[28:31]
    ds_read_b64_tr_b16 v[242:243], v249 offset:896
    v_mfma_f32_16x16x32_bf16 v[92:95], v[196:199], v[212:215], v[92:95]
    s_waitcnt lgkmcnt(9)
    ds_read_b64_tr_b16 v[244:245], v249 offset:416
    v_mfma_f32_16x16x32_bf16 v[32:35], v[224:227], v[208:211], v[32:35]
    s_cmp_eq_u32 s54, 6
    ds_read_b64_tr_b16 v[246:247], v249 offset:928
    v_mfma_f32_16x16x32_bf16 v[96:99], v[224:227], v[212:215], v[96:99]
    s_waitcnt lgkmcnt(9)
    ds_read_b64_tr_b16 v[192:193], v249 offset:448
    v_mfma_f32_16x16x32_bf16 v[36:39], v[228:231], v[208:211], v[36:39]
    s_cbranch_scc1 LA_hb2
LA_nh2:
    ds_read_b64_tr_b16 v[194:195], v249 offset:960
    v_mfma_f32_16x16x32_bf16 v[100:103], v[228:231], v[212:215], v[100:103]
    s_waitcnt lgkmcnt(8)
    ds_read_b64_tr_b16 v[196:197], v249 offset:480
    v_mfma_f32_16x16x32_bf16 v[40:43], v[232:235], v[208:211], v[40:43]
    s_add_u32 s56, s56, 1
    ds_read_b64_tr_b16 v[198:199], v249 offset:992
    v_mfma_f32_16x16x32_bf16 v[104:107], v[232:235], v[212:215], v[104:107]
    s_waitcnt lgkmcnt(8)
    ds_read_b64_tr_b16 v[224:225], v249 offset:16896
    v_mfma_f32_16x16x32_bf16 v[44:47], v[236:239], v[208:211], v[44:47]
    s_cmp_eq_u32 s56, 3
    ds_read_b64_tr_b16 v[226:227], v249 offset:17408
    v_mfma_f32_16x16x32_bf16 v[108:111], v[236:239], v[212:215], v[108:111]
    s_waitcnt lgkmcnt(8)
    ds_read_b64_tr_b16 v[228:229], v249 offset:16928
    v_mfma_f32_16x16x32_bf16 v[48:51], v[240:243], v[208:211], v[48:51]
    s_cselect_b32 s56, 0, s56
    ds_read_b64_tr_b16 v[230:231], v249 offset:17440
    v_mfma_f32_16x16x32_bf16 v[112:115], v[240:243], v[212:215], v[112:115]
    s_waitcnt lgkmcnt(8)
    ds_read_b64_tr_b16 v[232:233], v249 offset:16960
    v_mfma_f32_16x16x32_bf16 v[52:55], v[244:247], v[208:211], v[52:55]
    s_cselect_b32 s55, -2, 1
    ds_read_b64_tr_b16 v[234:235], v249 offset:17472
    v_mfma_f32_16x16x32_bf16 v[116:119], v[244:247], v[212:215], v[116:119]
    s_waitcnt lgkmcnt(8)
    ds_read_b64_tr_b16 v[236:237], v249 offset:16992
    v_mfma_f32_16x16x32_bf16 v[56:59], v[192:195], v[208:211], v[56:59]
    s_mul_i32 s57, s55, 16896
    ds_read_b64_tr_b16 v[238:239], v249 offset:17504
    v_mfma_f32_16x16x32_bf16 v[120:123], v[192:195], v[212:215], v[120:123]
    s_waitcnt lgkmcnt(8)
    ds_read_b64_tr_b16 v[240:241], v249 offset:17024
    v_mfma_f32_16x16x32_bf16 v[60:63], v[196:199], v[208:211], v[60:63]
    s_mul_i32 s55, s55, 33792
    ds_read_b64_tr_b16 v[242:243], v249 offset:17536
    v_mfma_f32_16x16x32_bf16 v[124:127], v[196:199], v[212:215], v[124:127]
    s_waitcnt lgkmcnt(8)
    ds_read_b64_tr_b16 v[244:245], v249 offset:17056
    v_mfma_f32_16x16x32_bf16 v[0:3], v[224:227], v[216:219], v[0:3]
    s_sub_u32 s54, s54, 1
    ds_read_b64_tr_b16 v[246:247], v249 offset:17568
    v_mfma_f32_16x16x32_bf16 v[64:67], v[224:227], v[220:223], v[64:67]
    s_waitcnt lgkmcnt(8)
    ds_read_b64_tr_b16 v[192:193], v249 offset:17088
    v_mfma_f32_16x16x32_bf16 v[4:7], v[228:231], v[216:219], v[4:7]
    s_cmp_lg_u32 s54, 0
    ds_read_b64_tr_b16 v[194:195], v249 offset:17600
    v_mfma_f32_16x16x32_bf16 v[68:71], v[228:231], v[220:223], v[68:71]
    s_waitcnt lgkmcnt(8)
    ds_read_b64_tr_b16 v[196:197], v249 offset:17120
    v_mfma_f32_16x16x32_bf16 v[8:11], v[232:235], v[216:219], v[8:11]
    ds_read_b64_tr_b16 v[198:199], v249 offset:17632
    v_mfma_f32_16x16x32_bf16 v[72:75], v[232:235], v[220:223], v[72:75]
    s_waitcnt lgkmcnt(8)
    ds_read_b64_tr_b16 v[224:225], v249 offset:17152
    ds_read_b64_tr_b16 v[226:227], v249 offset:17664
    v_mfma_f32_16x16x32_bf16 v[12:15], v[236:239], v[216:219], v[12:15]
    ds_read_b64_tr_b16 v[228:229], v249 offset:17184
    v_mfma_f32_16x16x32_bf16 v[76:79], v[236:239], v[220:223], v[76:79]
    s_waitcnt lgkmcnt(9)
    ds_read_b64_tr_b16 v[230:231], v249 offset:17696
    ds_read_b64_tr_b16 v[232:233], v249 offset:17216
    v_mfma_f32_16x16x32_bf16 v[16:19], v[240:243], v[216:219], v[16:19]
    ds_read_b64_tr_b16 v[234:235], v249 offset:17728
    v_mfma_f32_16x16x32_bf16 v[80:83], v[240:243], v[220:223], v[80:83]
    s_waitcnt lgkmcnt(10)
    ds_read_b64_tr_b16 v[236:237], v249 offset:17248
    ds_read_b64_tr_b16 v[238:239], v249 offset:17760
    v_mfma_f32_16x16x32_bf16 v[20:23], v[244:247], v[216:219], v[20:23]
    ds_read_b64_tr_b16 v[240:241], v249 offset:17280
    v_mfma_f32_16x16x32_bf16 v[84:87], v[244:247], v[220:223], v[84:87]
    s_waitcnt lgkmcnt(11)
    ds_read_b64_tr_b16 v[242:243], v249 offset:17792
    ds_read_b64_tr_b16 v[244:245], v249 offset:17312
    v_mfma_f32_16x16x32_bf16 v[24:27], v[192:195], v[216:219], v[24:27]
    ds_read_b64_tr_b16 v[246:247], v249 offset:17824
    v_mfma_f32_16x16x32_bf16 v[88:91], v[192:195], v[220:223], v[88:91]
    s_waitcnt lgkmcnt(12)
    ds_read_b64_tr_b16 v[192:193], v249 offset:17344
    ds_read_b64_tr_b16 v[194:195], v249 offset:17856
    v_mfma_f32_16x16x32_bf16 v[28:31], v[196:199], v[216:219], v[28:31]
    v_mfma_f32_16x16x32_bf16 v[92:95], v[196:199], v[220:223], v[92:95]
    s_waitcnt lgkmcnt(12)
    ds_read_b64_tr_b16 v[196:197], v249 offset:17376
    ds_read_b64_tr_b16 v[198:199], v249 offset:17888
    v_mfma_f32_16x16x32_bf16 v[32:35], v[224:227], v[216:219], v[32:35]
    v_mfma_f32_16x16x32_bf16 v[96:99], v[224:227], v[220:223], v[96:99]
    s_waitcnt lgkmcnt(12)
    v_add_u32 v249, s55, v249
    v_add_u32 v248, s57, v248
    v_mfma_f32_16x16x32_bf16 v[36:39], v[228:231], v[216:219], v[36:39]
    v_mfma_f32_16x16x32_bf16 v[100:103], v[228:231], v[220:223], v[100:103]
    s_waitcnt lgkmcnt(10)
    s_waitcnt lgkmcnt(0)
    s_barrier
    v_mfma_f32_16x16x32_bf16 v[40:43], v[232:235], v[216:219], v[40:43]
    ds_read_b128 v[208:211], v248 offset:0
    ds_read_b128 v[212:215], v248 offset:128
    v_mfma_f32_16x16x32_bf16 v[104:107], v[232:235], v[220:223], v[104:107]
    ds_read_b64_tr_b16 v[224:225], v249 offset:0
    ds_read_b64_tr_b16 v[226:227], v249 offset:512
    v_mfma_f32_16x16x32_bf16 v[44:47], v[236:239], v[216:219], v[44:47]
    ds_read_b64_tr_b16 v[228:229], v249 offset:32
    v_mfma_f32_16x16x32_bf16 v[108:111], v[236:239], v[220:223], v[108:111]
    ds_read_b64_tr_b16 v[230:231], v249 offset:544
    v_mfma_f32_16x16x32_bf16 v[48:51], v[240:243], v[216:219], v[48:51]
    ds_read_b64_tr_b16 v[232:233], v249 offset:64
    v_mfma_f32_16x16x32_bf16 v[112:115], v[240:243], v[220:223], v[112:115]
    ds_read_b64_tr_b16 v[234:235], v249 offset:576
    v_mfma_f32_16x16x32_bf16 v[52:55], v[244:247], v[216:219], v[52:55]
    ds_read_b64_tr_b16 v[236:237], v249 offset:96
    v_mfma_f32_16x16x32_bf16 v[116:119], v[244:247], v[220:223], v[116:119]
    ds_read_b64_tr_b16 v[238:239], v249 offset:608
    v_mfma_f32_16x16x32_bf16 v[56:59], v[192:195], v[216:219], v[56:59]
    ds_read_b64_tr_b16 v[240:241], v249 offset:128
    v_mfma_f32_16x16x32_bf16 v[120:123], v[192:195], v[220:223], v[120:123]
    ds_read_b64_tr_b16 v[242:243], v249 offset:640
    v_mfma_f32_16x16x32_bf16 v[60:63], v[196:199], v[216:219], v[60:63]
    ds_read_b64_tr_b16 v[244:245], v249 offset:160
    v_mfma_f32_16x16x32_bf16 v[124:127], v[196:199], v[220:223], v[124:127]
    s_waitcnt lgkmcnt(9)
    ds_read_b64_tr_b16 v[246:247], v249 offset:672
    s_cbranch_scc1 LA_qp2
    v_mfma_f32_16x16x32_bf16 v[0:3], v[224:227], v[208:211], v[0:3]
    v_mfma_f32_16x16x32_bf16 v[64:67], v[224:227], v[212:215], v[64:67]
    s_waitcnt lgkmcnt(8)
    ds_read_b64_tr_b16 v[192:193], v249 offset:16896
    v_mfma_f32_16x16x32_bf16 v[4:7], v[228:231], v[208:211], v[4:7]
    ds_read_b128 v[216:219], v248 offset:64
    ds_read_b64_tr_b16 v[194:195], v249 offset:17408
    v_mfma_f32_16x16x32_bf16 v[68:71], v[228:231], v[212:215], v[68:71]
    s_waitcnt lgkmcnt(9)
    ds_read_b64_tr_b16 v[196:197], v249 offset:192
    v_mfma_f32_16x16x32_bf16 v[8:11], v[232:235], v[208:211], v[8:11]
    ds_read_b128 v[220:223], v248 offset:192
    ds_read_b64_tr_b16 v[198:199], v249 offset:704
    v_mfma_f32_16x16x32_bf16 v[72:75], v[232:235], v[212:215], v[72:75]
    s_waitcnt lgkmcnt(10)
    ds_read_b64_tr_b16 v[224:225], v249 offset:16928
    v_mfma_f32_16x16x32_bf16 v[12:15], v[236:239], v[208:211], v[12:15]
    ds_read_b64_tr_b16 v[226:227], v249 offset:17440
    v_mfma_f32_16x16x32_bf16 v[76:79], v[236:239], v[212:215], v[76:79]
    s_waitcnt lgkmcnt(10)
    ds_read_b64_tr_b16 v[228:229], v249 offset:224
    v_mfma_f32_16x16x32_bf16 v[16:19], v[240:243], v[208:211], v[16:19]
    ds_read_b64_tr_b16 v[230:231], v249 offset:736
    v_mfma_f32_16x16x32_bf16 v[80:83], v[240:243], v[212:215], v[80:83]
    s_waitcnt lgkmcnt(10)
    ds_read_b64_tr_b16 v[232:233], v249 offset:16960
    v_mfma_f32_16x16x32_bf16 v[20:23], v[244:247], v[208:211], v[20:23]
    ds_read_b64_tr_b16 v[234:235], v249 offset:17472
    v_mfma_f32_16x16x32_bf16 v[84:87], v[244:247], v[212:215], v[84:87]
    s_waitcnt lgkmcnt(7)
    ds_read_b64_tr_b16 v[236:237], v249 offset:256
    v_mfma_f32_16x16x32_bf16 v[0:3], v[192:195], v[216:219], v[0:3]
    ds_read_b64_tr_b16 v[238:239], v249 offset:768
    v_mfma_f32_16x16x32_bf16 v[64:67], v[192:195], v[220:223], v[64:67]
    s_waitcnt lgkmcnt(8)
    ds_read_b64_tr_b16 v[240:241], v249 offset:16992
    v_mfma_f32_16x16x32_bf16 v[24:27], v[196:199], v[208:211], v[24:27]
    ds_read_b64_tr_b16 v[242:243], v249 offset:17504
    v_mfma_f32_16x16x32_bf16 v[88:91], v[196:199], v[212:215], v[88:91]
    s_waitcnt lgkmcnt(8)
    ds_read_b64_tr_b16 v[244:245], v249 offset:288
    v_mfma_f32_16x16x32_bf16 v[4:7], v[224:227], v[216:219], v[4:7]
    ds_read_b64_tr_b16 v[246:247], v249 offset:800
    v_mfma_f32_16x16x32_bf16 v[68:71], v[224:227], v[220:223], v[68:71]
    s_waitcnt lgkmcnt(8)
    ds_read_b64_tr_b16 v[192:193], v249 offset:17024
    v_mfma_f32_16x16x32_bf16 v[28:31], v[228:231], v[208:211], v[28:31]
    ds_read_b64_tr_b16 v[194:195], v249 offset:17536
    v_mfma_f32_16x16x32_bf16 v[92:95], v[228:231], v[212:215], v[92:95]
    s_waitcnt lgkmcnt(8)
    ds_read_b64_tr_b16 v[196:197], v249 offset:320
    v_mfma_f32_16x16x32_bf16 v[8:11], v[232:235], v[216:219], v[8:11]
    ds_read_b64_tr_b16 v[198:199], v249 offset:832
    v_mfma_f32_16x16x32_bf16 v[72:75], v[232:235], v[220:223], v[72:75]
    s_waitcnt lgkmcnt(8)
    ds_read_b64_tr_b16 v[224:225], v249 offset:17056
    v_mfma_f32_16x16x32_bf16 v[32:35], v[236:239], v[208:211], v[32:35]
    ds_read_b64_tr_b16 v[226:227], v249 offset:17568
    v_mul_f32 v0, s68, v0
    v_mfma_f32_16x16x32_bf16 v[96:99], v[236:239], v[212:215], v[96:99]
    s_waitcnt lgkmcnt(8)
    ds_read_b64_tr_b16 v[228:229], v249 offset:352
    v_mul_f32 v1, s68, v1
    v_mfma_f32_16x16x32_bf16 v[12:15], v[240:243], v[216:219], v[12:15]
    ds_read_b64_tr_b16 v[230:231], v249 offset:864
    v_mul_f32 v2, s68, v2
    v_mfma_f32_16x16x32_bf16 v[76:79], v[240:243], v[220:223], v[76:79]
    s_waitcnt lgkmcnt(8)
    ds_read_b64_tr_b16 v[232:233], v249 offset:17088
    v_mul_f32 v3, s68, v3
    v_mfma_f32_16x16x32_bf16 v[36:39], v[244:247], v[208:211], v[36:39]
    ds_read_b64_tr_b16 v[234:235], v249 offset:17600
    v_mul_f32 v4, s68, v4
    v_mfma_f32_16x16x32_bf16 v[100:103], v[244:247], v[212:215], v[100:103]
    s_waitcnt lgkmcnt(8)
    ds_read_b64_tr_b16 v[236:237], v249 offset:384
    v_mul_f32 v5, s68, v5
    v_mfma_f32_16x16x32_bf16 v[16:19], v[192:195], v[216:219], v[16:19]
    ds_read_b64_tr_b16 v[238:239], v249 offset:896
    v_mul_f32 v6, s68, v6
    v_mfma_f32_16x16x32_bf16 v[80:83], v[192:195], v[220:223], v[80:83]
    s_waitcnt lgkmcnt(8)
    ds_read_b64_tr_b16 v[240:241], v249 offset:17120
    v_mul_f32 v7, s68, v7
    v_mfma_f32_16x16x32_bf16 v[40:43], v[196:199], v[208:211], v[40:43]
    ds_read_b64_tr_b16 v[242:243], v249 offset:17632
    v_cvt_pk_bf16_f32 v128, v0, v1
    v_mfma_f32_16x16x32_bf16 v[104:107], v[196:199], v[212:215], v[104:107]
    s_waitcnt lgkmcnt(8)
    ds_read_b64_tr_b16 v[244:245], v249 offset:416
    v_cvt_pk_bf16_f32 v129, v2, v3
    v_mfma_f32_16x16x32_bf16 v[20:23], v[224:227], v[216:219], v[20:23]
    ds_read_b64_tr_b16 v[246:247], v249 offset:928
    v_cvt_pk_bf16_f32 v130, v4, v5
    v_mfma_f32_16x16x32_bf16 v[84:87], v[224:227], v[220:223], v[84:87]
    s_waitcnt lgkmcnt(8)
    ds_read_b64_tr_b16 v[192:193], v249 offset:17152
    v_cvt_pk_bf16_f32 v131, v6, v7
    v_mfma_f32_16x16x32_bf16 v[44:47], v[228:231], v[208:211], v[44:47]
    ds_read_b64_tr_b16 v[194:195], v249 offset:17664
    v_mul_f32 v64, s68, v64
    v_mfma_f32_16x16x32_bf16 v[108:111], v[228:231], v[212:215], v[108:111]
    s_waitcnt lgkmcnt(8)
    ds_read_b64_tr_b16 v[196:197], v249 offset:448
    v_mul_f32 v65, s68, v65
    v_mfma_f32_16x16x32_bf16 v[24:27], v[232:235], v[216:219], v[24:27]
    ds_read_b64_tr_b16 v[198:199], v249 offset:960
    v_mul_f32 v66, s68, v66
    v_mfma_f32_16x16x32_bf16 v[88:91], v[232:235], v[220:223], v[88:91]
    s_waitcnt lgkmcnt(8)
    ds_read_b64_tr_b16 v[224:225], v249 offset:17184
    ds_read_b64_tr_b16 v[226:227], v249 offset:17696
    v_mfma_f32_16x16x32_bf16 v[48:51], v[236:239], v[208:211], v[48:51]
    ds_read_b64_tr_b16 v[228:229], v249 offset:480
    v_mul_f32 v67, s68, v67
    v_mfma_f32_16x16x32_bf16 v[112:115], v[236:239], v[212:215], v[112:115]
    s_waitcnt lgkmcnt(9)
    ds_read_b64_tr_b16 v[230:231], v249 offset:992
    ds_read_b64_tr_b16 v[232:233], v249 offset:17216
    v_mfma_f32_16x16x32_bf16 v[28:31], v[240:243], v[216:219], v[28:31]
    ds_read_b64_tr_b16 v[234:235], v249 offset:17728
    v_mul_f32 v68, s68, v68
    v_mfma_f32_16x16x32_bf16 v[92:95], v[240:243], v[220:223], v[92:95]
    s_waitcnt lgkmcnt(10)
    ds_read_b64_tr_b16 v[236:237], v249 offset:17248
    ds_read_b64_tr_b16 v[238:239], v249 offset:17760
    v_mfma_f32_16x16x32_bf16 v[52:55], v[244:247], v[208:211], v[52:55]
    ds_read_b64_tr_b16 v[240:241], v249 offset:17280
    v_mul_f32 v69, s68, v69
    v_mfma_f32_16x16x32_bf16 v[116:119], v[244:247], v[212:215], v[116:119]
    s_waitcnt lgkmcnt(11)
    ds_read_b64_tr_b16 v[242:243], v249 offset:17792
    ds_read_b64_tr_b16 v[244:245], v249 offset:17312
    v_mfma_f32_16x16x32_bf16 v[32:35], v[192:195], v[216:219], v[32:35]
    ds_read_b64_tr_b16 v[246:247], v249 offset:17824
    v_mul_f32 v70, s68, v70
    v_mfma_f32_16x16x32_bf16 v[96:99], v[192:195], v[220:223], v[96:99]
    s_waitcnt lgkmcnt(12)
    ds_read_b64_tr_b16 v[192:193], v249 offset:17344
    ds_read_b64_tr_b16 v[194:195], v249 offset:17856
    v_mfma_f32_16x16x32_bf16 v[56:59], v[196:199], v[208:211], v[56:59]
    v_mul_f32 v71, s68, v71
    v_cvt_pk_bf16_f32 v160, v64, v65
    v_mfma_f32_16x16x32_bf16 v[120:123], v[196:199], v[212:215], v[120:123]
    s_waitcnt lgkmcnt(12)
    ds_read_b64_tr_b16 v[196:197], v249 offset:17376
    ds_read_b64_tr_b16 v[198:199], v249 offset:17888
    v_mfma_f32_16x16x32_bf16 v[36:39], v[224:227], v[216:219], v[36:39]
    v_cvt_pk_bf16_f32 v161, v66, v67
    v_cvt_pk_bf16_f32 v162, v68, v69
    v_mfma_f32_16x16x32_bf16 v[100:103], v[224:227], v[220:223], v[100:103]
    s_waitcnt lgkmcnt(12)
    v_add_u32 v248, 96256, v253
    v_add_u32 v249, 96256, v252
    v_mfma_f32_16x16x32_bf16 v[60:63], v[228:231], v[208:211], v[60:63]
    v_cvt_pk_bf16_f32 v163, v70, v71
    v_mul_f32 v8, s68, v8
    v_mfma_f32_16x16x32_bf16 v[124:127], v[228:231], v[212:215], v[124:127]
    s_waitcnt lgkmcnt(10)
    v_mul_f32 v9, s68, v9
    v_mul_f32 v10, s68, v10
    s_waitcnt lgkmcnt(0)
    s_barrier
    v_mfma_f32_16x16x32_bf16 v[40:43], v[232:235], v[216:219], v[40:43]
    ds_read_b128 v[224:227], v248 offset:0
    v_mul_f32 v11, s68, v11
    v_mfma_f32_16x16x32_bf16 v[104:107], v[232:235], v[220:223], v[104:107]
    ds_read_b128 v[228:231], v248 offset:512
    v_mul_f32 v12, s68, v12
    v_mfma_f32_16x16x32_bf16 v[44:47], v[236:239], v[216:219], v[44:47]
    ds_read_b128 v[232:235], v248 offset:64
    v_mul_f32 v13, s68, v13
    v_mfma_f32_16x16x32_bf16 v[108:111], v[236:239], v[220:223], v[108:111]
    ds_read_b128 v[236:239], v248 offset:576
    v_mul_f32 v14, s68, v14
    v_mfma_f32_16x16x32_bf16 v[48:51], v[240:243], v[216:219], v[48:51]
    v_mul_f32 v15, s68, v15
    v_cvt_pk_bf16_f32 v132, v8, v9
    v_mfma_f32_16x16x32_bf16 v[112:115], v[240:243], v[220:223], v[112:115]
    ds_read_b128 v[240:243], v248 offset:128
    v_cvt_pk_bf16_f32 v133, v10, v11
    v_mfma_f32_16x16x32_bf16 v[52:55], v[244:247], v[216:219], v[52:55]
    v_cvt_pk_bf16_f32 v134, v12, v13
    v_cvt_pk_bf16_f32 v135, v14, v15
    v_mfma_f32_16x16x32_bf16 v[116:119], v[244:247], v[220:223], v[116:119]
    v_mul_f32 v72, s68, v72
    v_mul_f32 v73, s68, v73
    v_mfma_f32_16x16x32_bf16 v[56:59], v[192:195], v[216:219], v[56:59]
    v_mul_f32 v74, s68, v74
    v_mul_f32 v75, s68, v75
    v_mfma_f32_16x16x32_bf16 v[120:123], v[192:195], v[220:223], v[120:123]
    v_mul_f32 v76, s68, v76
    v_mul_f32 v77, s68, v77
    v_mfma_f32_16x16x32_bf16 v[60:63], v[196:199], v[216:219], v[60:63]
    v_mul_f32 v78, s68, v78
    v_mul_f32 v79, s68, v79
    v_mfma_f32_16x16x32_bf16 v[124:127], v[196:199], v[220:223], v[124:127]
    s_waitcnt lgkmcnt(4)
    v_cvt_pk_bf16_f32 v164, v72, v73
    v_cvt_pk_bf16_f32 v165, v74, v75
    s_or_b32 s50, s44, s46
    s_cmp_lg_u32 s50, 0
    s_cbranch_scc1 LA_noinit2
    s_lshl_b32 s50, s96, 4
    v_mov_b32 v254, s50
    v_mov_b32 v255, 1
    s_mov_b64 exec, 1
    s_waitcnt vmcnt(0)
    global_store_dword v254, v255, s[16:17] sc0 sc1
    s_mov_b64 exec, -1
LA_noinit2:
    v_cvt_pk_bf16_f32 v166, v76, v77
    v_cvt_pk_bf16_f32 v167, v78, v79
    v_permlane16_swap_b32 v128, v130
    v_permlane16_swap_b32 v129, v131
    v_permlane16_swap_b32 v160, v162
    v_permlane16_swap_b32 v161, v163
    v_pk_mul_f32 v[16:17], v[16:17], s[68:69] op_sel_hi:[1,0]
    v_pk_mul_f32 v[18:19], v[18:19], s[68:69] op_sel_hi:[1,0]
    v_pk_mul_f32 v[20:21], v[20:21], s[68:69] op_sel_hi:[1,0]
    v_pk_mul_f32 v[22:23], v[22:23], s[68:69] op_sel_hi:[1,0]
    v_cvt_pk_bf16_f32 v136, v16, v17
    v_cvt_pk_bf16_f32 v137, v18, v19
    v_cvt_pk_bf16_f32 v138, v20, v21
    v_cvt_pk_bf16_f32 v139, v22, v23
    v_pk_mul_f32 v[80:81], v[80:81], s[68:69] op_sel_hi:[1,0]
    v_pk_mul_f32 v[82:83], v[82:83], s[68:69] op_sel_hi:[1,0]
    v_pk_mul_f32 v[84:85], v[84:85], s[68:69] op_sel_hi:[1,0]
    v_pk_mul_f32 v[86:87], v[86:87], s[68:69] op_sel_hi:[1,0]
    v_cvt_pk_bf16_f32 v168, v80, v81
    v_cvt_pk_bf16_f32 v169, v82, v83
    v_cvt_pk_bf16_f32 v170, v84, v85
    v_cvt_pk_bf16_f32 v171, v86, v87
    v_permlane16_swap_b32 v132, v134
    v_permlane16_swap_b32 v133, v135
    v_permlane16_swap_b32 v164, v166
    v_permlane16_swap_b32 v165, v167
    v_pk_mul_f32 v[24:25], v[24:25], s[68:69] op_sel_hi:[1,0]
    v_pk_mul_f32 v[26:27], v[26:27], s[68:69] op_sel_hi:[1,0]
    v_pk_mul_f32 v[28:29], v[28:29], s[68:69] op_sel_hi:[1,0]
    v_pk_mul_f32 v[30:31], v[30:31], s[68:69] op_sel_hi:[1,0]
    v_cvt_pk_bf16_f32 v140, v24, v25
    v_cvt_pk_bf16_f32 v141, v26, v27
    v_cvt_pk_bf16_f32 v142, v28, v29
    v_cvt_pk_bf16_f32 v143, v30, v31
    v_pk_mul_f32 v[88:89], v[88:89], s[68:69] op_sel_hi:[1,0]
    v_pk_mul_f32 v[90:91], v[90:91], s[68:69] op_sel_hi:[1,0]
    v_pk_mul_f32 v[92:93], v[92:93], s[68:69] op_sel_hi:[1,0]
    v_pk_mul_f32 v[94:95], v[94:95], s[68:69] op_sel_hi:[1,0]
    v_cvt_pk_bf16_f32 v172, v88, v89
    v_cvt_pk_bf16_f32 v173, v90, v91
    v_cvt_pk_bf16_f32 v174, v92, v93
    v_cvt_pk_bf16_f32 v175, v94, v95
    v_permlane16_swap_b32 v136, v138
    v_permlane16_swap_b32 v137, v139
    v_permlane16_swap_b32 v168, v170
    v_permlane16_swap_b32 v169, v171
    v_pk_mul_f32 v[32:33], v[32:33], s[68:69] op_sel_hi:[1,0]
    v_pk_mul_f32 v[34:35], v[34:35], s[68:69] op_sel_hi:[1,0]
    v_pk_mul_f32 v[36:37], v[36:37], s[68:69] op_sel_hi:[1,0]
    v_pk_mul_f32 v[38:39], v[38:39], s[68:69] op_sel_hi:[1,0]
    v_cvt_pk_bf16_f32 v144, v32, v33
    v_cvt_pk_bf16_f32 v145, v34, v35
    v_cvt_pk_bf16_f32 v146, v36, v37
    v_cvt_pk_bf16_f32 v147, v38, v39
    v_pk_mul_f32 v[96:97], v[96:97], s[68:69] op_sel_hi:[1,0]
    v_pk_mul_f32 v[98:99], v[98:99], s[68:69] op_sel_hi:[1,0]
    v_pk_mul_f32 v[100:101], v[100:101], s[68:69] op_sel_hi:[1,0]
    v_pk_mul_f32 v[102:103], v[102:103], s[68:69] op_sel_hi:[1,0]
    v_cvt_pk_bf16_f32 v176, v96, v97
    v_cvt_pk_bf16_f32 v177, v98, v99
    v_cvt_pk_bf16_f32 v178, v100, v101
    v_cvt_pk_bf16_f32 v179, v102, v103
    v_permlane16_swap_b32 v140, v142
    v_permlane16_swap_b32 v141, v143
    v_permlane16_swap_b32 v172, v174
    v_permlane16_swap_b32 v173, v175
    v_pk_mul_f32 v[40:41], v[40:41], s[68:69] op_sel_hi:[1,0]
    v_pk_mul_f32 v[42:43], v[42:43], s[68:69] op_sel_hi:[1,0]
    v_pk_mul_f32 v[44:45], v[44:45], s[68:69] op_sel_hi:[1,0]
    v_pk_mul_f32 v[46:47], v[46:47], s[68:69] op_sel_hi:[1,0]
    v_pk_mul_f32 v[104:105], v[104:105], s[68:69] op_sel_hi:[1,0]
    v_pk_mul_f32 v[106:107], v[106:107], s[68:69] op_sel_hi:[1,0]
    v_pk_mul_f32 v[108:109], v[108:109], s[68:69] op_sel_hi:[1,0]
    v_pk_mul_f32 v[110:111], v[110:111], s[68:69] op_sel_hi:[1,0]
    v_permlane16_swap_b32 v144, v146
    v_permlane16_swap_b32 v145, v147
    v_permlane16_swap_b32 v176, v178
    v_permlane16_swap_b32 v177, v179
    v_pk_mul_f32 v[48:49], v[48:49], s[68:69] op_sel_hi:[1,0]
    v_pk_mul_f32 v[50:51], v[50:51], s[68:69] op_sel_hi:[1,0]
    v_pk_mul_f32 v[52:53], v[52:53], s[68:69] op_sel_hi:[1,0]
    v_pk_mul_f32 v[54:55], v[54:55], s[68:69] op_sel_hi:[1,0]
    v_pk_mul_f32 v[112:113], v[112:113], s[68:69] op_sel_hi:[1,0]
    v_pk_mul_f32 v[114:115], v[114:115], s[68:69] op_sel_hi:[1,0]
    v_pk_mul_f32 v[116:117], v[116:117], s[68:69] op_sel_hi:[1,0]
    v_pk_mul_f32 v[118:119], v[118:119], s[68:69] op_sel_hi:[1,0]
    v_pk_mul_f32 v[56:57], v[56:57], s[68:69] op_sel_hi:[1,0]
    v_pk_mul_f32 v[58:59], v[58:59], s[68:69] op_sel_hi:[1,0]
    v_pk_mul_f32 v[60:61], v[60:61], s[68:69] op_sel_hi:[1,0]
    v_pk_mul_f32 v[62:63], v[62:63], s[68:69] op_sel_hi:[1,0]
    v_pk_mul_f32 v[120:121], v[120:121], s[68:69] op_sel_hi:[1,0]
    v_pk_mul_f32 v[122:123], v[122:123], s[68:69] op_sel_hi:[1,0]
    v_pk_mul_f32 v[124:125], v[124:125], s[68:69] op_sel_hi:[1,0]
    v_pk_mul_f32 v[126:127], v[126:127], s[68:69] op_sel_hi:[1,0]
    s_nop 1
    v_mfma_f32_16x16x32_bf16 v[192:195], v[224:227], v[128:131], 0
    v_cvt_pk_bf16_f32 v148, v40, v41
    v_cvt_pk_bf16_f32 v149, v42, v43
    v_mfma_f32_16x16x32_bf16 v[200:203], v[224:227], v[160:163], 0
    s_waitcnt lgkmcnt(3)
    ds_read_b128 v[224:227], v248 offset:640
    v_cvt_pk_bf16_f32 v150, v44, v45
    v_mfma_f32_16x16x32_bf16 v[196:199], v[228:231], v[128:131], 0
    v_cvt_pk_bf16_f32 v151, v46, v47
    v_cvt_pk_bf16_f32 v180, v104, v105
    v_mfma_f32_16x16x32_bf16 v[204:207], v[228:231], v[160:163], 0
    s_waitcnt lgkmcnt(3)
    ds_read_b128 v[228:231], v248 offset:192
    v_cvt_pk_bf16_f32 v181, v106, v107
    v_mfma_f32_16x16x32_bf16 v[192:195], v[232:235], v[132:135], v[192:195]
    v_cvt_pk_bf16_f32 v182, v108, v109
    v_cvt_pk_bf16_f32 v183, v110, v111
    v_mfma_f32_16x16x32_bf16 v[200:203], v[232:235], v[164:167], v[200:203]
    s_waitcnt lgkmcnt(3)
    ds_read_b128 v[232:235], v248 offset:704
    s_nop 0
    v_mfma_f32_16x16x32_bf16 v[196:199], v[236:239], v[132:135], v[196:199]
    v_permlane16_swap_b32 v148, v150
    v_permlane16_swap_b32 v149, v151
    v_mfma_f32_16x16x32_bf16 v[204:207], v[236:239], v[164:167], v[204:207]
    s_waitcnt lgkmcnt(3)
    ds_read_b128 v[236:239], v248 offset:256
    v_permlane16_swap_b32 v180, v182
    v_mfma_f32_16x16x32_bf16 v[192:195], v[240:243], v[136:139], v[192:195]
    v_permlane16_swap_b32 v181, v183
    v_cvt_pk_bf16_f32 v152, v48, v49
    v_mfma_f32_16x16x32_bf16 v[200:203], v[240:243], v[168:171], v[200:203]
    s_waitcnt lgkmcnt(3)
    ds_read_b128 v[240:243], v248 offset:768
    v_cvt_pk_bf16_f32 v153, v50, v51
    v_mfma_f32_16x16x32_bf16 v[196:199], v[224:227], v[136:139], v[196:199]
    v_cvt_pk_bf16_f32 v154, v52, v53
    v_cvt_pk_bf16_f32 v155, v54, v55
    v_mfma_f32_16x16x32_bf16 v[204:207], v[224:227], v[168:171], v[204:207]
    s_waitcnt lgkmcnt(3)
    ds_read_b128 v[224:227], v248 offset:320
    v_cvt_pk_bf16_f32 v184, v112, v113
    v_mfma_f32_16x16x32_bf16 v[192:195], v[228:231], v[140:143], v[192:195]
    v_cvt_pk_bf16_f32 v185, v114, v115
    v_cvt_pk_bf16_f32 v186, v116, v117
    v_mfma_f32_16x16x32_bf16 v[200:203], v[228:231], v[172:175], v[200:203]
    s_waitcnt lgkmcnt(3)
    ds_read_b128 v[228:231], v248 offset:832
    v_cvt_pk_bf16_f32 v187, v118, v119
    v_mfma_f32_16x16x32_bf16 v[196:199], v[232:235], v[140:143], v[196:199]
    s_nop 0
    v_permlane16_swap_b32 v152, v154
    v_mfma_f32_16x16x32_bf16 v[204:207], v[232:235], v[172:175], v[204:207]
    s_waitcnt lgkmcnt(3)
    ds_read_b128 v[232:235], v248 offset:384
    v_permlane16_swap_b32 v153, v155
    v_mfma_f32_16x16x32_bf16 v[192:195], v[236:239], v[144:147], v[192:195]
    v_permlane16_swap_b32 v184, v186
    v_permlane16_swap_b32 v185, v187
    v_mfma_f32_16x16x32_bf16 v[200:203], v[236:239], v[176:179], v[200:203]
    s_waitcnt lgkmcnt(3)
    ds_read_b128 v[236:239], v248 offset:896
    v_cvt_pk_bf16_f32 v156, v56, v57
    v_mfma_f32_16x16x32_bf16 v[196:199], v[240:243], v[144:147], v[196:199]
    v_cvt_pk_bf16_f32 v157, v58, v59
    v_cvt_pk_bf16_f32 v158, v60, v61
    v_mfma_f32_16x16x32_bf16 v[204:207], v[240:243], v[176:179], v[204:207]
    s_waitcnt lgkmcnt(3)
    ds_read_b128 v[240:243], v248 offset:448
    ds_read_b128 v[244:247], v248 offset:960
    v_mfma_f32_16x16x32_bf16 v[192:195], v[224:227], v[148:151], v[192:195]
    v_cvt_pk_bf16_f32 v159, v62, v63
    v_cvt_pk_bf16_f32 v188, v120, v121
    v_mfma_f32_16x16x32_bf16 v[200:203], v[224:227], v[180:183], v[200:203]
    s_waitcnt lgkmcnt(4)
    v_cvt_pk_bf16_f32 v189, v122, v123
    v_cvt_pk_bf16_f32 v190, v124, v125
    v_mfma_f32_16x16x32_bf16 v[196:199], v[228:231], v[148:151], v[196:199]
    v_cvt_pk_bf16_f32 v191, v126, v127
    s_nop 0
    v_mfma_f32_16x16x32_bf16 v[204:207], v[228:231], v[180:183], v[204:207]
    s_waitcnt lgkmcnt(3)
    v_permlane16_swap_b32 v156, v158
    v_permlane16_swap_b32 v157, v159
    s_waitcnt lgkmcnt(0)
    s_barrier
    v_mfma_f32_16x16x32_bf16 v[192:195], v[232:235], v[152:155], v[192:195]
    ds_read_b128 v[224:227], v248 offset:33792
    v_permlane16_swap_b32 v188, v190
    v_mfma_f32_16x16x32_bf16 v[200:203], v[232:235], v[184:187], v[200:203]
    ds_read_b128 v[228:231], v248 offset:33856
    v_permlane16_swap_b32 v189, v191
    v_mfma_f32_16x16x32_bf16 v[196:199], v[236:239], v[152:155], v[196:199]
    ds_read_b128 v[232:235], v248 offset:33920
    v_mfma_f32_16x16x32_bf16 v[204:207], v[236:239], v[184:187], v[204:207]
    ds_read_b128 v[236:239], v248 offset:33984
    v_mfma_f32_16x16x32_bf16 v[192:195], v[240:243], v[156:159], v[192:195]
    v_mfma_f32_16x16x32_bf16 v[200:203], v[240:243], v[188:191], v[200:203]
    ds_read_b128 v[240:243], v248 offset:34048
    v_mfma_f32_16x16x32_bf16 v[196:199], v[244:247], v[156:159], v[196:199]
    v_mfma_f32_16x16x32_bf16 v[204:207], v[244:247], v[188:191], v[204:207]
    s_waitcnt lgkmcnt(4)
    s_cmp_lg_u32 s97, 0
    s_cbranch_scc1 LA_gen2
    v_mfma_f32_16x16x32_bf16 v[208:211], v[224:227], v[128:131], 0
    v_mbcnt_lo_u32_b32 v255, -1, 0
    v_mbcnt_hi_u32_b32 v255, -1, v255
    v_mfma_f32_16x16x32_bf16 v[216:219], v[224:227], v[160:163], 0
    s_waitcnt lgkmcnt(3)
    ds_read_b128 v[224:227], v248 offset:34112
    v_lshrrev_b32 v252, 2, v255
    v_mfma_f32_16x16x32_bf16 v[208:211], v[228:231], v[132:135], v[208:211]
    v_lshlrev_b32 v252, 7, v252
    v_bfe_u32 v253, v255, 3, 2
    v_mfma_f32_16x16x32_bf16 v[216:219], v[228:231], v[164:167], v[216:219]
    s_waitcnt lgkmcnt(3)
    ds_read_b128 v[228:231], v248 offset:34176
    v_lshl_add_u32 v252, v253, 5, v252
    v_mfma_f32_16x16x32_bf16 v[208:211], v[232:235], v[136:139], v[208:211]
    v_exp_f32 v192, v192
    v_exp_f32 v193, v193
    v_mfma_f32_16x16x32_bf16 v[216:219], v[232:235], v[168:171], v[216:219]
    s_waitcnt lgkmcnt(3)
    ds_read_b128 v[232:235], v248 offset:34240
    v_add_f32 v250, v250, v192
    v_exp_f32 v194, v194
    v_mfma_f32_16x16x32_bf16 v[208:211], v[236:239], v[140:143], v[208:211]
    v_add_f32 v250, v250, v193
    v_cvt_pk_bf16_f32 v192, v192, v193
    v_mfma_f32_16x16x32_bf16 v[216:219], v[236:239], v[172:175], v[216:219]
    s_waitcnt lgkmcnt(3)
    ds_read_b128 v[236:239], v248 offset:34304
    v_exp_f32 v195, v195
    v_add_f32 v250, v250, v194
    v_mfma_f32_16x16x32_bf16 v[208:211], v[240:243], v[144:147], v[208:211]
    v_exp_f32 v200, v200
    v_add_f32 v250, v250, v195
    v_mfma_f32_16x16x32_bf16 v[216:219], v[240:243], v[176:179], v[216:219]
    s_waitcnt lgkmcnt(3)
    ds_read_b128 v[240:243], v248 offset:34368
    v_cvt_pk_bf16_f32 v193, v194, v195
    v_exp_f32 v201, v201
    v_mfma_f32_16x16x32_bf16 v[208:211], v[224:227], v[148:151], v[208:211]
    v_add_f32 v251, v251, v200
    v_exp_f32 v202, v202
    v_mfma_f32_16x16x32_bf16 v[216:219], v[224:227], v[180:183], v[216:219]
    s_waitcnt lgkmcnt(3)
    ds_read_b128 v[224:227], v248 offset:34432
    v_add_f32 v251, v251, v201
    v_cvt_pk_bf16_f32 v200, v200, v201
    v_mfma_f32_16x16x32_bf16 v[208:211], v[228:231], v[152:155], v[208:211]
    v_exp_f32 v203, v203
    v_add_f32 v251, v251, v202
    v_mfma_f32_16x16x32_bf16 v[216:219], v[228:231], v[184:187], v[216:219]
    s_waitcnt lgkmcnt(3)
    ds_read_b128 v[228:231], v248 offset:34496
    v_exp_f32 v196, v196
    v_add_f32 v251, v251, v203
    v_mfma_f32_16x16x32_bf16 v[208:211], v[232:235], v[156:159], v[208:211]
    v_cvt_pk_bf16_f32 v201, v202, v203
    v_exp_f32 v197, v197
    v_mfma_f32_16x16x32_bf16 v[216:219], v[232:235], v[188:191], v[216:219]
    s_waitcnt lgkmcnt(3)
    ds_read_b128 v[232:235], v248 offset:34560
    v_add_f32 v250, v250, v196
    v_exp_f32 v198, v198
    v_mfma_f32_16x16x32_bf16 v[212:215], v[236:239], v[128:131], 0
    v_add_f32 v250, v250, v197
    v_cvt_pk_bf16_f32 v194, v196, v197
    v_mfma_f32_16x16x32_bf16 v[220:223], v[236:239], v[160:163], 0
    s_waitcnt lgkmcnt(3)
    ds_read_b128 v[236:239], v248 offset:34624
    ds_read_b64_tr_b16 v[244:245], v249 offset:50976
    v_exp_f32 v199, v199
    v_add_f32 v250, v250, v198
    v_mfma_f32_16x16x32_bf16 v[212:215], v[240:243], v[132:135], v[212:215]
    v_exp_f32 v204, v204
    v_add_f32 v250, v250, v199
    v_mfma_f32_16x16x32_bf16 v[220:223], v[240:243], v[164:167], v[220:223]
    s_waitcnt lgkmcnt(4)
    ds_read_b128 v[240:243], v248 offset:34688
    ds_read_b64_tr_b16 v[246:247], v249 offset:51488
    v_cvt_pk_bf16_f32 v195, v198, v199
    v_exp_f32 v205, v205
    v_mfma_f32_16x16x32_bf16 v[212:215], v[224:227], v[136:139], v[212:215]
    v_add_f32 v251, v251, v204
    v_exp_f32 v206, v206
    v_mfma_f32_16x16x32_bf16 v[220:223], v[224:227], v[168:171], v[220:223]
    s_waitcnt lgkmcnt(5)
    ds_read_b128 v[224:227], v248 offset:34752
    v_add_f32 v251, v251, v205
    v_cvt_pk_bf16_f32 v202, v204, v205
    v_mfma_f32_16x16x32_bf16 v[212:215], v[228:231], v[140:143], v[212:215]
    v_exp_f32 v207, v207
    v_add_f32 v251, v251, v206
    v_mfma_f32_16x16x32_bf16 v[220:223], v[228:231], v[172:175], v[220:223]
    s_waitcnt lgkmcnt(5)
    ds_read_b64_tr_b16 v[228:229], v249 offset:50688
    ds_read_b64_tr_b16 v[230:231], v249 offset:51200
    v_add_f32 v251, v251, v207
    v_cvt_pk_bf16_f32 v203, v206, v207
    v_mfma_f32_16x16x32_bf16 v[212:215], v[232:235], v[144:147], v[212:215]
    v_and_b32 v253, 3, v255
    v_lshl_add_u32 v252, v253, 3, v252
    v_mfma_f32_16x16x32_bf16 v[220:223], v[232:235], v[176:179], v[220:223]
    s_waitcnt lgkmcnt(6)
    ds_read_b64_tr_b16 v[232:233], v249 offset:50720
    ds_read_b64_tr_b16 v[234:235], v249 offset:51232
    v_mfma_f32_16x16x32_bf16 v[212:215], v[236:239], v[148:151], v[212:215]
    v_add_u32 v252, 97280, v252
    v_xor_b32 v253, 32, v252
    v_mfma_f32_16x16x32_bf16 v[220:223], v[236:239], v[180:183], v[220:223]
    s_waitcnt lgkmcnt(6)
    ds_read_b64_tr_b16 v[236:237], v249 offset:50752
    ds_read_b64_tr_b16 v[238:239], v249 offset:51264
    v_mfma_f32_16x16x32_bf16 v[212:215], v[240:243], v[152:155], v[212:215]
    v_exp_f32 v208, v208
    v_mfma_f32_16x16x32_bf16 v[220:223], v[240:243], v[184:187], v[220:223]
    s_waitcnt lgkmcnt(6)
    ds_read_b64_tr_b16 v[240:241], v249 offset:50784
    ds_read_b64_tr_b16 v[242:243], v249 offset:51296
    v_mfma_f32_16x16x32_bf16 v[212:215], v[224:227], v[156:159], v[212:215]
    v_add_f32 v250, v250, v208
    v_xor_b32 v254, 64, v252
    v_mfma_f32_16x16x32_bf16 v[220:223], v[224:227], v[188:191], v[220:223]
    s_waitcnt lgkmcnt(6)
    ds_read_b64_tr_b16 v[224:225], v249 offset:50816
    ds_read_b64_tr_b16 v[226:227], v249 offset:51328
    v_mfma_f32_16x16x32_bf16 v[0:3], v[228:231], v[192:195], 0
    v_exp_f32 v209, v209
    v_mfma_f32_16x16x32_bf16 v[64:67], v[228:231], v[200:203], 0
    s_waitcnt lgkmcnt(6)
    ds_read_b64_tr_b16 v[228:229], v249 offset:50848
    ds_read_b64_tr_b16 v[230:231], v249 offset:51360
    v_mfma_f32_16x16x32_bf16 v[4:7], v[232:235], v[192:195], 0
    v_add_f32 v250, v250, v209
    v_cvt_pk_bf16_f32 v208, v208, v209
    v_mfma_f32_16x16x32_bf16 v[68:71], v[232:235], v[200:203], 0
    s_waitcnt lgkmcnt(6)
    ds_read_b64_tr_b16 v[232:233], v249 offset:50880
    ds_read_b64_tr_b16 v[234:235], v249 offset:51392
    v_mfma_f32_16x16x32_bf16 v[8:11], v[236:239], v[192:195], 0
    v_exp_f32 v210, v210
    v_mfma_f32_16x16x32_bf16 v[72:75], v[236:239], v[200:203], 0
    s_waitcnt lgkmcnt(6)
    ds_read_b64_tr_b16 v[236:237], v249 offset:50912
    ds_read_b64_tr_b16 v[238:239], v249 offset:51424
    v_mfma_f32_16x16x32_bf16 v[12:15], v[240:243], v[192:195], 0
    v_add_f32 v250, v250, v210
    v_xor_b32 v255, 0x60, v252
    v_mfma_f32_16x16x32_bf16 v[76:79], v[240:243], v[200:203], 0
    s_waitcnt lgkmcnt(6)
    ds_read_b64_tr_b16 v[240:241], v249 offset:50944
    ds_read_b64_tr_b16 v[242:243], v249 offset:51456
    v_mfma_f32_16x16x32_bf16 v[16:19], v[224:227], v[192:195], 0
    s_mov_b32 s54, 15
    v_exp_f32 v211, v211
    v_mfma_f32_16x16x32_bf16 v[80:83], v[224:227], v[200:203], 0
    s_waitcnt lgkmcnt(6)
    ds_read_b64_tr_b16 v[224:225], v249 offset:51008
    ds_read_b64_tr_b16 v[226:227], v249 offset:51520
    v_mfma_f32_16x16x32_bf16 v[20:23], v[228:231], v[192:195], 0
    s_mov_b32 s55, 67584
    v_add_f32 v250, v250, v211
    v_cvt_pk_bf16_f32 v209, v210, v211
    v_mfma_f32_16x16x32_bf16 v[84:87], v[228:231], v[200:203], 0
    s_waitcnt lgkmcnt(6)
    ds_read_b64_tr_b16 v[228:229], v249 offset:51040
    ds_read_b64_tr_b16 v[230:231], v249 offset:51552
    v_mfma_f32_16x16x32_bf16 v[24:27], v[232:235], v[192:195], 0
    v_exp_f32 v216, v216
    v_mfma_f32_16x16x32_bf16 v[88:91], v[232:235], v[200:203], 0
    s_waitcnt lgkmcnt(6)
    ds_read_b64_tr_b16 v[232:233], v249 offset:51072
    ds_read_b64_tr_b16 v[234:235], v249 offset:51584
    v_mfma_f32_16x16x32_bf16 v[28:31], v[236:239], v[192:195], 0
    v_add_f32 v251, v251, v216
    v_mfma_f32_16x16x32_bf16 v[92:95], v[236:239], v[200:203], 0
    s_waitcnt lgkmcnt(6)
    ds_read_b64_tr_b16 v[236:237], v249 offset:51104
    ds_read_b64_tr_b16 v[238:239], v249 offset:51616
    v_mfma_f32_16x16x32_bf16 v[32:35], v[240:243], v[192:195], 0
    v_exp_f32 v217, v217
    v_mfma_f32_16x16x32_bf16 v[96:99], v[240:243], v[200:203], 0
    ds_read_b64_tr_b16 v[240:241], v249 offset:51136
    ds_read_b64_tr_b16 v[242:243], v249 offset:51648
    v_mfma_f32_16x16x32_bf16 v[36:39], v[244:247], v[192:195], 0
    v_add_f32 v251, v251, v217
    v_cvt_pk_bf16_f32 v216, v216, v217
    v_mfma_f32_16x16x32_bf16 v[100:103], v[244:247], v[200:203], 0
    s_waitcnt lgkmcnt(8)
    ds_read_b64_tr_b16 v[244:245], v249 offset:51168
    ds_read_b64_tr_b16 v[246:247], v249 offset:51680
    v_mfma_f32_16x16x32_bf16 v[40:43], v[224:227], v[192:195], 0
    v_exp_f32 v218, v218
    v_mfma_f32_16x16x32_bf16 v[104:107], v[224:227], v[200:203], 0
    s_waitcnt lgkmcnt(8)
    v_add_u32 v248, 4294899712, v248
    v_add_u32 v249, 4294899712, v249
    v_mfma_f32_16x16x32_bf16 v[44:47], v[228:231], v[192:195], 0
    s_waitcnt lgkmcnt(0)
    v_add_f32 v251, v251, v218
    v_mfma_f32_16x16x32_bf16 v[108:111], v[228:231], v[200:203], 0
    s_barrier
    ds_read_b128 v[224:227], v248 offset:0
    v_mfma_f32_16x16x32_bf16 v[48:51], v[232:235], v[192:195], 0
    v_exp_f32 v219, v219
    v_mfma_f32_16x16x32_bf16 v[112:115], v[232:235], v[200:203], 0
    ds_read_b128 v[228:231], v248 offset:64
    v_mfma_f32_16x16x32_bf16 v[52:55], v[236:239], v[192:195], 0
    v_add_f32 v251, v251, v219
    v_cvt_pk_bf16_f32 v217, v218, v219
    v_mfma_f32_16x16x32_bf16 v[116:119], v[236:239], v[200:203], 0
    ds_read_b128 v[232:235], v248 offset:128
    v_mfma_f32_16x16x32_bf16 v[56:59], v[240:243], v[192:195], 0
    v_exp_f32 v212, v212
    v_mfma_f32_16x16x32_bf16 v[120:123], v[240:243], v[200:203], 0
    ds_read_b128 v[236:239], v248 offset:192
    v_mfma_f32_16x16x32_bf16 v[60:63], v[244:247], v[192:195], 0
    v_add_f32 v250, v250, v212
    v_mfma_f32_16x16x32_bf16 v[124:127], v[244:247], v[200:203], 0
    s_waitcnt lgkmcnt(3)
    ds_read_b128 v[240:243], v248 offset:256
    .p2align 3
LA_main2:
    v_mfma_f32_16x16x32_bf16 v[192:195], v[224:227], v[128:131], 0
    v_exp_f32 v213, v213
    v_mfma_f32_16x16x32_bf16 v[200:203], v[224:227], v[160:163], 0
    s_waitcnt lgkmcnt(3)
    ds_read_b128 v[224:227], v248 offset:320
    v_mfma_f32_16x16x32_bf16 v[192:195], v[228:231], v[132:135], v[192:195]
    v_add_f32 v250, v250, v213
    v_cvt_pk_bf16_f32 v210, v212, v213
    v_mfma_f32_16x16x32_bf16 v[200:203], v[228:231], v[164:167], v[200:203]
    s_waitcnt lgkmcnt(3)
    ds_read_b128 v[228:231], v248 offset:384
    v_mfma_f32_16x16x32_bf16 v[192:195], v[232:235], v[136:139], v[192:195]
    v_exp_f32 v214, v214
    v_mfma_f32_16x16x32_bf16 v[200:203], v[232:235], v[168:171], v[200:203]
    s_waitcnt lgkmcnt(3)
    ds_read_b128 v[232:235], v248 offset:448
    v_mfma_f32_16x16x32_bf16 v[192:195], v[236:239], v[140:143], v[192:195]
    v_add_f32 v250, v250, v214
    v_mfma_f32_16x16x32_bf16 v[200:203], v[236:239], v[172:175], v[200:203]
    s_waitcnt lgkmcnt(3)
    ds_read_b128 v[236:239], v248 offset:512
    v_mfma_f32_16x16x32_bf16 v[192:195], v[240:243], v[144:147], v[192:195]
    v_exp_f32 v215, v215
    v_mfma_f32_16x16x32_bf16 v[200:203], v[240:243], v[176:179], v[200:203]
    s_waitcnt lgkmcnt(3)
    ds_read_b128 v[240:243], v248 offset:576
    v_mfma_f32_16x16x32_bf16 v[192:195], v[224:227], v[148:151], v[192:195]
    v_add_f32 v250, v250, v215
    v_cvt_pk_bf16_f32 v211, v214, v215
    v_mfma_f32_16x16x32_bf16 v[200:203], v[224:227], v[180:183], v[200:203]
    s_waitcnt lgkmcnt(3)
    ds_read_b128 v[224:227], v248 offset:640
    v_mfma_f32_16x16x32_bf16 v[192:195], v[228:231], v[152:155], v[192:195]
    v_exp_f32 v220, v220
    v_mfma_f32_16x16x32_bf16 v[200:203], v[228:231], v[184:187], v[200:203]
    s_waitcnt lgkmcnt(3)
    ds_read_b128 v[228:231], v248 offset:704
    v_mfma_f32_16x16x32_bf16 v[192:195], v[232:235], v[156:159], v[192:195]
    v_add_f32 v251, v251, v220
    v_mfma_f32_16x16x32_bf16 v[200:203], v[232:235], v[188:191], v[200:203]
    s_waitcnt lgkmcnt(3)
    ds_read_b128 v[232:235], v248 offset:768
    v_mfma_f32_16x16x32_bf16 v[196:199], v[236:239], v[128:131], 0
    v_exp_f32 v221, v221
    v_mfma_f32_16x16x32_bf16 v[204:207], v[236:239], v[160:163], 0
    s_waitcnt lgkmcnt(3)
    ds_read_b128 v[236:239], v248 offset:832
    ds_read_b64_tr_b16 v[244:245], v249 offset:17184
    v_mfma_f32_16x16x32_bf16 v[196:199], v[240:243], v[132:135], v[196:199]
    v_add_f32 v251, v251, v221
    v_cvt_pk_bf16_f32 v218, v220, v221
    v_mfma_f32_16x16x32_bf16 v[204:207], v[240:243], v[164:167], v[204:207]
    s_waitcnt lgkmcnt(4)
    ds_read_b128 v[240:243], v248 offset:896
    ds_read_b64_tr_b16 v[246:247], v249 offset:17696
    v_mfma_f32_16x16x32_bf16 v[196:199], v[224:227], v[136:139], v[196:199]
    v_exp_f32 v222, v222
    v_mfma_f32_16x16x32_bf16 v[204:207], v[224:227], v[168:171], v[204:207]
    s_waitcnt lgkmcnt(5)
    ds_read_b128 v[224:227], v248 offset:960
    v_mfma_f32_16x16x32_bf16 v[196:199], v[228:231], v[140:143], v[196:199]
    v_add_f32 v251, v251, v222
    v_mfma_f32_16x16x32_bf16 v[204:207], v[228:231], v[172:175], v[204:207]
    s_waitcnt lgkmcnt(5)
    ds_read_b64_tr_b16 v[228:229], v249 offset:16896
    ds_read_b64_tr_b16 v[230:231], v249 offset:17408
    v_mfma_f32_16x16x32_bf16 v[196:199], v[232:235], v[144:147], v[196:199]
    v_exp_f32 v223, v223
    v_mfma_f32_16x16x32_bf16 v[204:207], v[232:235], v[176:179], v[204:207]
    s_waitcnt lgkmcnt(6)
    ds_read_b64_tr_b16 v[232:233], v249 offset:16928
    ds_read_b64_tr_b16 v[234:235], v249 offset:17440
    v_mfma_f32_16x16x32_bf16 v[196:199], v[236:239], v[148:151], v[196:199]
    v_add_f32 v251, v251, v223
    v_cvt_pk_bf16_f32 v219, v222, v223
    v_mfma_f32_16x16x32_bf16 v[204:207], v[236:239], v[180:183], v[204:207]
    s_waitcnt lgkmcnt(6)
    ds_read_b64_tr_b16 v[236:237], v249 offset:16960
    ds_read_b64_tr_b16 v[238:239], v249 offset:17472
    v_mfma_f32_16x16x32_bf16 v[196:199], v[240:243], v[152:155], v[196:199]
    v_exp_f32 v192, v192
    v_mfma_f32_16x16x32_bf16 v[204:207], v[240:243], v[184:187], v[204:207]
    s_waitcnt lgkmcnt(6)
    ds_read_b64_tr_b16 v[240:241], v249 offset:16992
    ds_read_b64_tr_b16 v[242:243], v249 offset:17504
    v_mfma_f32_16x16x32_bf16 v[196:199], v[224:227], v[156:159], v[196:199]
    v_add_f32 v250, v250, v192
    v_mfma_f32_16x16x32_bf16 v[204:207], v[224:227], v[188:191], v[204:207]
    s_waitcnt lgkmcnt(6)
    ds_read_b64_tr_b16 v[224:225], v249 offset:17024
    ds_read_b64_tr_b16 v[226:227], v249 offset:17536
    v_mfma_f32_16x16x32_bf16 v[0:3], v[228:231], v[208:211], v[0:3]
    v_exp_f32 v193, v193
    v_mfma_f32_16x16x32_bf16 v[64:67], v[228:231], v[216:219], v[64:67]
    s_waitcnt lgkmcnt(6)
    ds_read_b64_tr_b16 v[228:229], v249 offset:17056
    ds_read_b64_tr_b16 v[230:231], v249 offset:17568
    v_mfma_f32_16x16x32_bf16 v[4:7], v[232:235], v[208:211], v[4:7]
    v_add_f32 v250, v250, v193
    v_cvt_pk_bf16_f32 v192, v192, v193
    v_mfma_f32_16x16x32_bf16 v[68:71], v[232:235], v[216:219], v[68:71]
    s_waitcnt lgkmcnt(6)
    ds_read_b64_tr_b16 v[232:233], v249 offset:17088
    ds_read_b64_tr_b16 v[234:235], v249 offset:17600
    v_mfma_f32_16x16x32_bf16 v[8:11], v[236:239], v[208:211], v[8:11]
    v_exp_f32 v194, v194
    v_mfma_f32_16x16x32_bf16 v[72:75], v[236:239], v[216:219], v[72:75]
    s_waitcnt lgkmcnt(6)
    ds_read_b64_tr_b16 v[236:237], v249 offset:17120
    ds_read_b64_tr_b16 v[238:239], v249 offset:17632
    v_mfma_f32_16x16x32_bf16 v[12:15], v[240:243], v[208:211], v[12:15]
    v_add_f32 v250, v250, v194
    v_mfma_f32_16x16x32_bf16 v[76:79], v[240:243], v[216:219], v[76:79]
    s_waitcnt lgkmcnt(6)
    ds_read_b64_tr_b16 v[240:241], v249 offset:17152
    ds_read_b64_tr_b16 v[242:243], v249 offset:17664
    v_mfma_f32_16x16x32_bf16 v[16:19], v[224:227], v[208:211], v[16:19]
    v_exp_f32 v195, v195
    v_mfma_f32_16x16x32_bf16 v[80:83], v[224:227], v[216:219], v[80:83]
    s_waitcnt lgkmcnt(6)
    ds_read_b64_tr_b16 v[224:225], v249 offset:17216
    ds_read_b64_tr_b16 v[226:227], v249 offset:17728
    v_mfma_f32_16x16x32_bf16 v[20:23], v[228:231], v[208:211], v[20:23]
    v_add_f32 v250, v250, v195
    v_cvt_pk_bf16_f32 v193, v194, v195
    v_mfma_f32_16x16x32_bf16 v[84:87], v[228:231], v[216:219], v[84:87]
    s_waitcnt lgkmcnt(6)
    ds_read_b64_tr_b16 v[228:229], v249 offset:17248
    ds_read_b64_tr_b16 v[230:231], v249 offset:17760
    v_mfma_f32_16x16x32_bf16 v[24:27], v[232:235], v[208:211], v[24:27]
    v_exp_f32 v200, v200
    v_mfma_f32_16x16x32_bf16 v[88:91], v[232:235], v[216:219], v[88:91]
    s_waitcnt lgkmcnt(6)
    ds_read_b64_tr_b16 v[232:233], v249 offset:17280
    ds_read_b64_tr_b16 v[234:235], v249 offset:17792
    v_mfma_f32_16x16x32_bf16 v[28:31], v[236:239], v[208:211], v[28:31]
    v_add_f32 v251, v251, v200
    v_mfma_f32_16x16x32_bf16 v[92:95], v[236:239], v[216:219], v[92:95]
    s_waitcnt lgkmcnt(6)
    ds_read_b64_tr_b16 v[236:237], v249 offset:17312
    ds_read_b64_tr_b16 v[238:239], v249 offset:17824
    v_mfma_f32_16x16x32_bf16 v[32:35], v[240:243], v[208:211], v[32:35]
    v_exp_f32 v201, v201
    v_mfma_f32_16x16x32_bf16 v[96:99], v[240:243], v[216:219], v[96:99]
    ds_read_b64_tr_b16 v[240:241], v249 offset:17344
    ds_read_b64_tr_b16 v[242:243], v249 offset:17856
    v_mfma_f32_16x16x32_bf16 v[36:39], v[244:247], v[208:211], v[36:39]
    v_add_f32 v251, v251, v201
    v_cvt_pk_bf16_f32 v200, v200, v201
    v_mfma_f32_16x16x32_bf16 v[100:103], v[244:247], v[216:219], v[100:103]
    s_waitcnt lgkmcnt(8)
    ds_read_b64_tr_b16 v[244:245], v249 offset:17376
    ds_read_b64_tr_b16 v[246:247], v249 offset:17888
    v_mfma_f32_16x16x32_bf16 v[40:43], v[224:227], v[208:211], v[40:43]
    v_exp_f32 v202, v202
    v_mfma_f32_16x16x32_bf16 v[104:107], v[224:227], v[216:219], v[104:107]
    s_waitcnt lgkmcnt(8)
    v_mfma_f32_16x16x32_bf16 v[44:47], v[228:231], v[208:211], v[44:47]
    s_waitcnt lgkmcnt(0)
    v_add_f32 v251, v251, v202
    v_mfma_f32_16x16x32_bf16 v[108:111], v[228:231], v[216:219], v[108:111]
    s_barrier
    ds_read_b128 v[224:227], v248 offset:33792
    v_mfma_f32_16x16x32_bf16 v[48:51], v[232:235], v[208:211], v[48:51]
    v_exp_f32 v203, v203
    v_mfma_f32_16x16x32_bf16 v[112:115], v[232:235], v[216:219], v[112:115]
    ds_read_b128 v[228:231], v248 offset:33856
    v_mfma_f32_16x16x32_bf16 v[52:55], v[236:239], v[208:211], v[52:55]
    v_add_f32 v251, v251, v203
    v_cvt_pk_bf16_f32 v201, v202, v203
    v_mfma_f32_16x16x32_bf16 v[116:119], v[236:239], v[216:219], v[116:119]
    ds_read_b128 v[232:235], v248 offset:33920
    v_mfma_f32_16x16x32_bf16 v[56:59], v[240:243], v[208:211], v[56:59]
    v_exp_f32 v196, v196
    v_mfma_f32_16x16x32_bf16 v[120:123], v[240:243], v[216:219], v[120:123]
    ds_read_b128 v[236:239], v248 offset:33984
    v_mfma_f32_16x16x32_bf16 v[60:63], v[244:247], v[208:211], v[60:63]
    v_add_f32 v250, v250, v196
    v_mfma_f32_16x16x32_bf16 v[124:127], v[244:247], v[216:219], v[124:127]
    s_waitcnt lgkmcnt(3)
    ds_read_b128 v[240:243], v248 offset:34048
    v_mfma_f32_16x16x32_bf16 v[208:211], v[224:227], v[128:131], 0
    v_exp_f32 v197, v197
    v_mfma_f32_16x16x32_bf16 v[216:219], v[224:227], v[160:163], 0
    s_waitcnt lgkmcnt(3)
    ds_read_b128 v[224:227], v248 offset:34112
    v_mfma_f32_16x16x32_bf16 v[208:211], v[228:231], v[132:135], v[208:211]
    v_add_f32 v250, v250, v197
    v_cvt_pk_bf16_f32 v194, v196, v197
    v_mfma_f32_16x16x32_bf16 v[216:219], v[228:231], v[164:167], v[216:219]
    s_waitcnt lgkmcnt(3)
    ds_read_b128 v[228:231], v248 offset:34176
    v_mfma_f32_16x16x32_bf16 v[208:211], v[232:235], v[136:139], v[208:211]
    v_exp_f32 v198, v198
    v_mfma_f32_16x16x32_bf16 v[216:219], v[232:235], v[168:171], v[216:219]
    s_waitcnt lgkmcnt(3)
    ds_read_b128 v[232:235], v248 offset:34240
    v_mfma_f32_16x16x32_bf16 v[208:211], v[236:239], v[140:143], v[208:211]
    v_add_f32 v250, v250, v198
    v_mfma_f32_16x16x32_bf16 v[216:219], v[236:239], v[172:175], v[216:219]
    s_waitcnt lgkmcnt(3)
    ds_read_b128 v[236:239], v248 offset:34304
    v_mfma_f32_16x16x32_bf16 v[208:211], v[240:243], v[144:147], v[208:211]
    v_exp_f32 v199, v199
    v_mfma_f32_16x16x32_bf16 v[216:219], v[240:243], v[176:179], v[216:219]
    s_waitcnt lgkmcnt(3)
    ds_read_b128 v[240:243], v248 offset:34368
    v_mfma_f32_16x16x32_bf16 v[208:211], v[224:227], v[148:151], v[208:211]
    v_add_f32 v250, v250, v199
    v_cvt_pk_bf16_f32 v195, v198, v199
    v_mfma_f32_16x16x32_bf16 v[216:219], v[224:227], v[180:183], v[216:219]
    s_waitcnt lgkmcnt(3)
    ds_read_b128 v[224:227], v248 offset:34432
    v_mfma_f32_16x16x32_bf16 v[208:211], v[228:231], v[152:155], v[208:211]
    v_exp_f32 v204, v204
    v_mfma_f32_16x16x32_bf16 v[216:219], v[228:231], v[184:187], v[216:219]
    s_waitcnt lgkmcnt(3)
    ds_read_b128 v[228:231], v248 offset:34496
    v_mfma_f32_16x16x32_bf16 v[208:211], v[232:235], v[156:159], v[208:211]
    v_add_f32 v251, v251, v204
    v_mfma_f32_16x16x32_bf16 v[216:219], v[232:235], v[188:191], v[216:219]
    s_waitcnt lgkmcnt(3)
    ds_read_b128 v[232:235], v248 offset:34560
    v_mfma_f32_16x16x32_bf16 v[212:215], v[236:239], v[128:131], 0
    v_exp_f32 v205, v205
    v_mfma_f32_16x16x32_bf16 v[220:223], v[236:239], v[160:163], 0
    s_waitcnt lgkmcnt(3)
    ds_read_b128 v[236:239], v248 offset:34624
    ds_read_b64_tr_b16 v[244:245], v249 offset:50976
    v_mfma_f32_16x16x32_bf16 v[212:215], v[240:243], v[132:135], v[212:215]
    v_add_f32 v251, v251, v205
    v_cvt_pk_bf16_f32 v202, v204, v205
    v_mfma_f32_16x16x32_bf16 v[220:223], v[240:243], v[164:167], v[220:223]
    s_waitcnt lgkmcnt(4)
    ds_read_b128 v[240:243], v248 offset:34688
    ds_read_b64_tr_b16 v[246:247], v249 offset:51488
    v_mfma_f32_16x16x32_bf16 v[212:215], v[224:227], v[136:139], v[212:215]
    v_exp_f32 v206, v206
    v_mfma_f32_16x16x32_bf16 v[220:223], v[224:227], v[168:171], v[220:223]
    s_waitcnt lgkmcnt(5)
    ds_read_b128 v[224:227], v248 offset:34752
    v_mfma_f32_16x16x32_bf16 v[212:215], v[228:231], v[140:143], v[212:215]
    v_add_f32 v251, v251, v206
    v_mfma_f32_16x16x32_bf16 v[220:223], v[228:231], v[172:175], v[220:223]
    s_waitcnt lgkmcnt(5)
    ds_read_b64_tr_b16 v[228:229], v249 offset:50688
    ds_read_b64_tr_b16 v[230:231], v249 offset:51200
    v_mfma_f32_16x16x32_bf16 v[212:215], v[232:235], v[144:147], v[212:215]
    v_exp_f32 v207, v207
    v_mfma_f32_16x16x32_bf16 v[220:223], v[232:235], v[176:179], v[220:223]
    s_waitcnt lgkmcnt(6)
    ds_read_b64_tr_b16 v[232:233], v249 offset:50720
    ds_read_b64_tr_b16 v[234:235], v249 offset:51232
    v_mfma_f32_16x16x32_bf16 v[212:215], v[236:239], v[148:151], v[212:215]
    v_add_f32 v251, v251, v207
    v_cvt_pk_bf16_f32 v203, v206, v207
    v_mfma_f32_16x16x32_bf16 v[220:223], v[236:239], v[180:183], v[220:223]
    s_waitcnt lgkmcnt(6)
    ds_read_b64_tr_b16 v[236:237], v249 offset:50752
    ds_read_b64_tr_b16 v[238:239], v249 offset:51264
    v_mfma_f32_16x16x32_bf16 v[212:215], v[240:243], v[152:155], v[212:215]
    v_exp_f32 v208, v208
    v_mfma_f32_16x16x32_bf16 v[220:223], v[240:243], v[184:187], v[220:223]
    s_waitcnt lgkmcnt(6)
    ds_read_b64_tr_b16 v[240:241], v249 offset:50784
    ds_read_b64_tr_b16 v[242:243], v249 offset:51296
    v_mfma_f32_16x16x32_bf16 v[212:215], v[224:227], v[156:159], v[212:215]
    v_add_f32 v250, v250, v208
    v_mfma_f32_16x16x32_bf16 v[220:223], v[224:227], v[188:191], v[220:223]
    s_waitcnt lgkmcnt(6)
    ds_read_b64_tr_b16 v[224:225], v249 offset:50816
    ds_read_b64_tr_b16 v[226:227], v249 offset:51328
    v_mfma_f32_16x16x32_bf16 v[0:3], v[228:231], v[192:195], v[0:3]
    v_exp_f32 v209, v209
    v_mfma_f32_16x16x32_bf16 v[64:67], v[228:231], v[200:203], v[64:67]
    s_waitcnt lgkmcnt(6)
    ds_read_b64_tr_b16 v[228:229], v249 offset:50848
    ds_read_b64_tr_b16 v[230:231], v249 offset:51360
    v_mfma_f32_16x16x32_bf16 v[4:7], v[232:235], v[192:195], v[4:7]
    v_add_f32 v250, v250, v209
    v_cvt_pk_bf16_f32 v208, v208, v209
    v_mfma_f32_16x16x32_bf16 v[68:71], v[232:235], v[200:203], v[68:71]
    s_waitcnt lgkmcnt(6)
    ds_read_b64_tr_b16 v[232:233], v249 offset:50880
    ds_read_b64_tr_b16 v[234:235], v249 offset:51392
    v_mfma_f32_16x16x32_bf16 v[8:11], v[236:239], v[192:195], v[8:11]
    v_exp_f32 v210, v210
    v_mfma_f32_16x16x32_bf16 v[72:75], v[236:239], v[200:203], v[72:75]
    s_waitcnt lgkmcnt(6)
    ds_read_b64_tr_b16 v[236:237], v249 offset:50912
    ds_read_b64_tr_b16 v[238:239], v249 offset:51424
    v_mfma_f32_16x16x32_bf16 v[12:15], v[240:243], v[192:195], v[12:15]
    v_add_f32 v250, v250, v210
    v_mfma_f32_16x16x32_bf16 v[76:79], v[240:243], v[200:203], v[76:79]
    s_waitcnt lgkmcnt(6)
    ds_read_b64_tr_b16 v[240:241], v249 offset:50944
    ds_read_b64_tr_b16 v[242:243], v249 offset:51456
    v_mfma_f32_16x16x32_bf16 v[16:19], v[224:227], v[192:195], v[16:19]
    v_exp_f32 v211, v211
    v_mfma_f32_16x16x32_bf16 v[80:83], v[224:227], v[200:203], v[80:83]
    s_waitcnt lgkmcnt(6)
    ds_read_b64_tr_b16 v[224:225], v249 offset:51008
    ds_read_b64_tr_b16 v[226:227], v249 offset:51520
    v_mfma_f32_16x16x32_bf16 v[20:23], v[228:231], v[192:195], v[20:23]
    v_add_f32 v250, v250, v211
    v_cvt_pk_bf16_f32 v209, v210, v211
    v_mfma_f32_16x16x32_bf16 v[84:87], v[228:231], v[200:203], v[84:87]
    s_waitcnt lgkmcnt(6)
    ds_read_b64_tr_b16 v[228:229], v249 offset:51040
    ds_read_b64_tr_b16 v[230:231], v249 offset:51552
    v_mfma_f32_16x16x32_bf16 v[24:27], v[232:235], v[192:195], v[24:27]
    v_exp_f32 v216, v216
    v_mfma_f32_16x16x32_bf16 v[88:91], v[232:235], v[200:203], v[88:91]
    s_waitcnt lgkmcnt(6)
    ds_read_b64_tr_b16 v[232:233], v249 offset:51072
    ds_read_b64_tr_b16 v[234:235], v249 offset:51584
    v_mfma_f32_16x16x32_bf16 v[28:31], v[236:239], v[192:195], v[28:31]
    v_add_f32 v251, v251, v216
    v_mfma_f32_16x16x32_bf16 v[92:95], v[236:239], v[200:203], v[92:95]
    s_waitcnt lgkmcnt(6)
    ds_read_b64_tr_b16 v[236:237], v249 offset:51104
    ds_read_b64_tr_b16 v[238:239], v249 offset:51616
    v_mfma_f32_16x16x32_bf16 v[32:35], v[240:243], v[192:195], v[32:35]
    v_exp_f32 v217, v217
    v_mfma_f32_16x16x32_bf16 v[96:99], v[240:243], v[200:203], v[96:99]
    ds_read_b64_tr_b16 v[240:241], v249 offset:51136
    ds_read_b64_tr_b16 v[242:243], v249 offset:51648
    v_mfma_f32_16x16x32_bf16 v[36:39], v[244:247], v[192:195], v[36:39]
    v_add_f32 v251, v251, v217
    v_cvt_pk_bf16_f32 v216, v216, v217
    v_mfma_f32_16x16x32_bf16 v[100:103], v[244:247], v[200:203], v[100:103]
    s_waitcnt lgkmcnt(8)
    ds_read_b64_tr_b16 v[244:245], v249 offset:51168
    ds_read_b64_tr_b16 v[246:247], v249 offset:51680
    v_mfma_f32_16x16x32_bf16 v[40:43], v[224:227], v[192:195], v[40:43]
    v_exp_f32 v218, v218
    v_mfma_f32_16x16x32_bf16 v[104:107], v[224:227], v[200:203], v[104:107]
    s_waitcnt lgkmcnt(8)
    v_add_u32 v248, s55, v248
    v_add_u32 v249, s55, v249
    v_mfma_f32_16x16x32_bf16 v[44:47], v[228:231], v[192:195], v[44:47]
    s_waitcnt lgkmcnt(0)
    v_add_f32 v251, v251, v218
    v_mfma_f32_16x16x32_bf16 v[108:111], v[228:231], v[200:203], v[108:111]
    s_barrier
    ds_read_b128 v[224:227], v248 offset:0
    v_mfma_f32_16x16x32_bf16 v[48:51], v[232:235], v[192:195], v[48:51]
    s_sub_u32 s55, 0, s55
    v_exp_f32 v219, v219
    v_mfma_f32_16x16x32_bf16 v[112:115], v[232:235], v[200:203], v[112:115]
    ds_read_b128 v[228:231], v248 offset:64
    v_mfma_f32_16x16x32_bf16 v[52:55], v[236:239], v[192:195], v[52:55]
    s_sub_u32 s54, s54, 1
    v_add_f32 v251, v251, v219
    v_cvt_pk_bf16_f32 v217, v218, v219
    v_mfma_f32_16x16x32_bf16 v[116:119], v[236:239], v[200:203], v[116:119]
    ds_read_b128 v[232:235], v248 offset:128
    v_mfma_f32_16x16x32_bf16 v[56:59], v[240:243], v[192:195], v[56:59]
    s_cmp_lg_u32 s54, 0
    v_exp_f32 v212, v212
    v_mfma_f32_16x16x32_bf16 v[120:123], v[240:243], v[200:203], v[120:123]
    ds_read_b128 v[236:239], v248 offset:192
    v_mfma_f32_16x16x32_bf16 v[60:63], v[244:247], v[192:195], v[60:63]
    v_add_f32 v250, v250, v212
    v_mfma_f32_16x16x32_bf16 v[124:127], v[244:247], v[200:203], v[124:127]
    s_waitcnt lgkmcnt(3)
    ds_read_b128 v[240:243], v248 offset:256
    s_cbranch_scc1 LA_main2
    ds_read_b64_tr_b16 v[224:225], v249 offset:16896
    ds_read_b64_tr_b16 v[226:227], v249 offset:17408
    ds_read_b64_tr_b16 v[228:229], v249 offset:16928
    ds_read_b64_tr_b16 v[230:231], v249 offset:17440
    ds_read_b64_tr_b16 v[232:233], v249 offset:16960
    ds_read_b64_tr_b16 v[234:235], v249 offset:17472
    ds_read_b64_tr_b16 v[236:237], v249 offset:16992
    ds_read_b64_tr_b16 v[238:239], v249 offset:17504
    ds_read_b64_tr_b16 v[240:241], v249 offset:17024
    ds_read_b64_tr_b16 v[242:243], v249 offset:17536
    v_exp_f32 v213, v213
    v_exp_f32 v214, v214
    v_exp_f32 v215, v215
    v_exp_f32 v220, v220
    v_exp_f32 v221, v221
    v_exp_f32 v222, v222
    v_exp_f32 v223, v223
    v_mbcnt_lo_u32_b32 v194, -1, 0
    v_add_f32 v250, v250, v213
    v_cvt_pk_bf16_f32 v210, v212, v213
    v_add_f32 v250, v250, v214
    v_add_f32 v250, v250, v215
    v_cvt_pk_bf16_f32 v211, v214, v215
    v_add_f32 v251, v251, v220
    v_add_f32 v251, v251, v221
    v_cvt_pk_bf16_f32 v218, v220, v221
    v_add_f32 v251, v251, v222
    v_add_f32 v251, v251, v223
    v_cvt_pk_bf16_f32 v219, v222, v223
LA_join2:
    v_mbcnt_hi_u32_b32 v194, -1, v194
    s_nop 0
    s_waitcnt lgkmcnt(8)
    v_mfma_f32_16x16x32_bf16 v[0:3], v[224:227], v[208:211], v[0:3]
    s_lshl_b32 s51, s44, 2
    v_mov_b32 v192, v250
    v_mov_b32 v193, v251
    v_mfma_f32_16x16x32_bf16 v[64:67], v[224:227], v[216:219], v[64:67]
    s_waitcnt lgkmcnt(6)
    ds_read_b64_tr_b16 v[224:225], v249 offset:17056
    ds_read_b64_tr_b16 v[226:227], v249 offset:17568
    v_mfma_f32_16x16x32_bf16 v[4:7], v[228:231], v[208:211], v[4:7]
    s_add_u32 s51, s51, 0
    v_lshlrev_b32 v248, 4, v194
    v_mov_b32 v195, 64
    v_mfma_f32_16x16x32_bf16 v[68:71], v[228:231], v[216:219], v[68:71]
    s_waitcnt lgkmcnt(6)
    ds_read_b64_tr_b16 v[228:229], v249 offset:17088
    ds_read_b64_tr_b16 v[230:231], v249 offset:17600
    v_mfma_f32_16x16x32_bf16 v[8:11], v[232:235], v[208:211], v[8:11]
    s_mov_b32 s52, 0x30800000
    v_permlane32_swap_b32 v192, v250
    v_permlane32_swap_b32 v193, v251
    v_mfma_f32_16x16x32_bf16 v[72:75], v[232:235], v[216:219], v[72:75]
    s_waitcnt lgkmcnt(6)
    ds_read_b64_tr_b16 v[232:233], v249 offset:17120
    ds_read_b64_tr_b16 v[234:235], v249 offset:17632
    v_mfma_f32_16x16x32_bf16 v[12:15], v[236:239], v[208:211], v[12:15]
    s_lshl_b32 s58, s46, 18
    v_add_f32 v250, v250, v192
    v_add_f32 v251, v251, v193
    v_mfma_f32_16x16x32_bf16 v[76:79], v[236:239], v[216:219], v[76:79]
    s_waitcnt lgkmcnt(6)
    ds_read_b64_tr_b16 v[236:237], v249 offset:17152
    ds_read_b64_tr_b16 v[238:239], v249 offset:17664
    v_mfma_f32_16x16x32_bf16 v[16:19], v[240:243], v[208:211], v[16:19]
    s_add_u32 s58, s58, s3
    v_cvt_pk_bf16_f32 v128, v0, v1
    v_cvt_pk_bf16_f32 v129, v2, v3
    v_mfma_f32_16x16x32_bf16 v[80:83], v[240:243], v[216:219], v[80:83]
    s_waitcnt lgkmcnt(6)
    ds_read_b64_tr_b16 v[240:241], v249 offset:17184
    ds_read_b64_tr_b16 v[242:243], v249 offset:17696
    v_mfma_f32_16x16x32_bf16 v[20:23], v[224:227], v[208:211], v[20:23]
    s_lshr_b32 s50, s44, 1
    v_cvt_pk_bf16_f32 v130, v4, v5
    v_cvt_pk_bf16_f32 v131, v6, v7
    v_mfma_f32_16x16x32_bf16 v[84:87], v[224:227], v[216:219], v[84:87]
    s_waitcnt lgkmcnt(6)
    ds_read_b64_tr_b16 v[224:225], v249 offset:17216
    ds_read_b64_tr_b16 v[226:227], v249 offset:17728
    v_mfma_f32_16x16x32_bf16 v[24:27], v[228:231], v[208:211], v[24:27]
    s_lshl_b32 s50, s50, 14
    v_cvt_pk_bf16_f32 v160, v64, v65
    v_cvt_pk_bf16_f32 v161, v66, v67
    v_mfma_f32_16x16x32_bf16 v[88:91], v[228:231], v[216:219], v[88:91]
    s_waitcnt lgkmcnt(6)
    ds_read_b64_tr_b16 v[228:229], v249 offset:17248
    ds_read_b64_tr_b16 v[230:231], v249 offset:17760
    v_mfma_f32_16x16x32_bf16 v[28:31], v[232:235], v[208:211], v[28:31]
    s_add_u32 s58, s58, s50
    v_cvt_pk_bf16_f32 v162, v68, v69
    v_cvt_pk_bf16_f32 v163, v70, v71
    v_mfma_f32_16x16x32_bf16 v[92:95], v[232:235], v[216:219], v[92:95]
    s_waitcnt lgkmcnt(6)
    ds_read_b64_tr_b16 v[232:233], v249 offset:17280
    ds_read_b64_tr_b16 v[234:235], v249 offset:17792
    v_mfma_f32_16x16x32_bf16 v[32:35], v[236:239], v[208:211], v[32:35]
    s_and_b32 s50, s44, 1
    v_cvt_pk_bf16_f32 v132, v8, v9
    v_cvt_pk_bf16_f32 v133, v10, v11
    v_mfma_f32_16x16x32_bf16 v[96:99], v[236:239], v[216:219], v[96:99]
    s_waitcnt lgkmcnt(6)
    ds_read_b64_tr_b16 v[236:237], v249 offset:17312
    ds_read_b64_tr_b16 v[238:239], v249 offset:17824
    v_mfma_f32_16x16x32_bf16 v[36:39], v[240:243], v[208:211], v[36:39]
    s_lshl_b32 s50, s50, 12
    v_cvt_pk_bf16_f32 v134, v12, v13
    v_cvt_pk_bf16_f32 v135, v14, v15
    v_mfma_f32_16x16x32_bf16 v[100:103], v[240:243], v[216:219], v[100:103]
    s_waitcnt lgkmcnt(6)
    ds_read_b64_tr_b16 v[240:241], v249 offset:17344
    ds_read_b64_tr_b16 v[242:243], v249 offset:17856
    v_mfma_f32_16x16x32_bf16 v[40:43], v[224:227], v[208:211], v[40:43]
    s_add_u32 s58, s58, s50
    ds_read_b64_tr_b16 v[244:245], v249 offset:17376
    ds_read_b64_tr_b16 v[246:247], v249 offset:17888
    v_mfma_f32_16x16x32_bf16 v[104:107], v[224:227], v[216:219], v[104:107]
    s_waitcnt lgkmcnt(8)
    v_cvt_pk_bf16_f32 v164, v72, v73
    v_cvt_pk_bf16_f32 v165, v74, v75
    v_mfma_f32_16x16x32_bf16 v[44:47], v[228:231], v[208:211], v[44:47]
    s_mov_b32 s59, s67
    v_cvt_pk_bf16_f32 v166, v76, v77
    v_cvt_pk_bf16_f32 v167, v78, v79
    v_mfma_f32_16x16x32_bf16 v[108:111], v[228:231], v[216:219], v[108:111]
    s_waitcnt lgkmcnt(6)
    v_cvt_pk_bf16_f32 v136, v16, v17
    v_cvt_pk_bf16_f32 v137, v18, v19
    s_waitcnt lgkmcnt(0)
    s_barrier
    v_mfma_f32_16x16x32_bf16 v[48:51], v[232:235], v[208:211], v[48:51]
    s_mov_b32 s56, s67
    ds_read_b64 v[68:69], v195
    ds_read_b64_tr_b16 v[224:225], v252 offset:32768
    v_mfma_f32_16x16x32_bf16 v[112:115], v[232:235], v[216:219], v[112:115]
    ds_read_b64_tr_b16 v[226:227], v252 offset:34816
    ds_read_b64_tr_b16 v[228:229], v253 offset:32768
    v_mfma_f32_16x16x32_bf16 v[52:55], v[236:239], v[208:211], v[52:55]
    ds_read_b64_tr_b16 v[230:231], v253 offset:34816
    ds_read_b64_tr_b16 v[232:233], v252 offset:36864
    v_mfma_f32_16x16x32_bf16 v[116:119], v[236:239], v[216:219], v[116:119]
    ds_read_b64_tr_b16 v[234:235], v252 offset:38912
    ds_read_b64_tr_b16 v[236:237], v253 offset:36864
    v_mfma_f32_16x16x32_bf16 v[56:59], v[240:243], v[208:211], v[56:59]
    ds_read_b64_tr_b16 v[238:239], v253 offset:38912
    v_cvt_pk_bf16_f32 v138, v20, v21
    v_mfma_f32_16x16x32_bf16 v[120:123], v[240:243], v[216:219], v[120:123]
    ds_read_b64_tr_b16 v[240:241], v252 offset:40960
    ds_read_b64_tr_b16 v[242:243], v252 offset:43008
    v_mfma_f32_16x16x32_bf16 v[60:63], v[244:247], v[208:211], v[60:63]
    v_cvt_pk_bf16_f32 v139, v22, v23
    v_cvt_pk_bf16_f32 v168, v80, v81
    v_mfma_f32_16x16x32_bf16 v[124:127], v[244:247], v[216:219], v[124:127]
    s_waitcnt lgkmcnt(8)
    ds_read_b64_tr_b16 v[244:245], v253 offset:40960
    ds_read_b64_tr_b16 v[246:247], v253 offset:43008
    v_readfirstlane_b32 s88, v68
    v_readfirstlane_b32 s89, v69
    v_mfma_f32_16x16x32_bf16 v[192:195], v[224:227], v[128:131], 0
    s_cmp_lt_u32 s46, 8
    v_cvt_pk_bf16_f32 v169, v82, v83
    v_cvt_pk_bf16_f32 v170, v84, v85
    v_mfma_f32_16x16x32_bf16 v[200:203], v[224:227], v[160:163], 0
    s_waitcnt lgkmcnt(8)
    ds_read_b64_tr_b16 v[72:73], v252 offset:45056
    v_cvt_pk_bf16_f32 v171, v86, v87
    v_cvt_pk_bf16_f32 v140, v24, v25
    v_mfma_f32_16x16x32_bf16 v[196:199], v[228:231], v[128:131], 0
    s_cselect_b32 s50, s88, s89
    ds_read_b64_tr_b16 v[74:75], v252 offset:47104
    v_cvt_pk_bf16_f32 v141, v26, v27
    v_cvt_pk_bf16_f32 v142, v28, v29
    v_mfma_f32_16x16x32_bf16 v[204:207], v[228:231], v[160:163], 0
    s_waitcnt lgkmcnt(8)
    ds_read_b64_tr_b16 v[76:77], v253 offset:45056
    v_cvt_pk_bf16_f32 v143, v30, v31
    v_cvt_pk_bf16_f32 v172, v88, v89
    v_mfma_f32_16x16x32_bf16 v[192:195], v[232:235], v[132:135], v[192:195]
    s_add_u32 s58, s58, s50
    ds_read_b64_tr_b16 v[78:79], v253 offset:47104
    v_cvt_pk_bf16_f32 v173, v90, v91
    v_cvt_pk_bf16_f32 v174, v92, v93
    v_mfma_f32_16x16x32_bf16 v[200:203], v[232:235], v[164:167], v[200:203]
    s_waitcnt lgkmcnt(8)
    ds_read_b64_tr_b16 v[224:225], v252 offset:49152
    v_cvt_pk_bf16_f32 v175, v94, v95
    v_cvt_pk_bf16_f32 v144, v32, v33
    v_mfma_f32_16x16x32_bf16 v[196:199], v[236:239], v[132:135], v[196:199]
    s_lshl_b32 s63, s59, 15
    ds_read_b64_tr_b16 v[226:227], v252 offset:51200
    v_cvt_pk_bf16_f32 v145, v34, v35
    v_cvt_pk_bf16_f32 v146, v36, v37
    v_mfma_f32_16x16x32_bf16 v[204:207], v[236:239], v[164:167], v[204:207]
    s_waitcnt lgkmcnt(8)
    ds_read_b64_tr_b16 v[228:229], v253 offset:49152
    v_cvt_pk_bf16_f32 v147, v38, v39
    v_cvt_pk_bf16_f32 v176, v96, v97
    v_mfma_f32_16x16x32_bf16 v[192:195], v[240:243], v[136:139], v[192:195]
    s_add_u32 s63, s63, s58
    ds_read_b64_tr_b16 v[230:231], v253 offset:51200
    v_cvt_pk_bf16_f32 v177, v98, v99
    v_cvt_pk_bf16_f32 v178, v100, v101
    v_mfma_f32_16x16x32_bf16 v[200:203], v[240:243], v[168:171], v[200:203]
    s_waitcnt lgkmcnt(8)
    ds_read_b64_tr_b16 v[232:233], v252 offset:53248
    v_cvt_pk_bf16_f32 v179, v102, v103
    v_cvt_pk_bf16_f32 v148, v40, v41
    v_mfma_f32_16x16x32_bf16 v[196:199], v[244:247], v[136:139], v[196:199]
    s_add_u32 s59, s59, 1
    ds_read_b64_tr_b16 v[234:235], v252 offset:55296
    v_cvt_pk_bf16_f32 v149, v42, v43
    v_cvt_pk_bf16_f32 v150, v44, v45
    v_mfma_f32_16x16x32_bf16 v[204:207], v[244:247], v[168:171], v[204:207]
    s_waitcnt lgkmcnt(8)
    ds_read_b64_tr_b16 v[236:237], v253 offset:53248
    v_cvt_pk_bf16_f32 v151, v46, v47
    v_cvt_pk_bf16_f32 v180, v104, v105
    v_mfma_f32_16x16x32_bf16 v[192:195], v[72:75], v[140:143], v[192:195]
    s_cmp_eq_u32 s59, 7
    ds_read_b64_tr_b16 v[238:239], v253 offset:55296
    v_cvt_pk_bf16_f32 v181, v106, v107
    v_cvt_pk_bf16_f32 v182, v108, v109
    v_mfma_f32_16x16x32_bf16 v[200:203], v[72:75], v[172:175], v[200:203]
    s_waitcnt lgkmcnt(8)
    ds_read_b64_tr_b16 v[240:241], v252 offset:57344
    v_cvt_pk_bf16_f32 v183, v110, v111
    v_cvt_pk_bf16_f32 v152, v48, v49
    v_mfma_f32_16x16x32_bf16 v[196:199], v[76:79], v[140:143], v[196:199]
    s_cselect_b32 s59, 0, s59
    ds_read_b64_tr_b16 v[242:243], v252 offset:59392
    v_cvt_pk_bf16_f32 v153, v50, v51
    v_cvt_pk_bf16_f32 v154, v52, v53
    v_mfma_f32_16x16x32_bf16 v[204:207], v[76:79], v[172:175], v[204:207]
    s_waitcnt lgkmcnt(8)
    ds_read_b64_tr_b16 v[244:245], v253 offset:57344
    v_cvt_pk_bf16_f32 v155, v54, v55
    v_cvt_pk_bf16_f32 v184, v112, v113
    v_mfma_f32_16x16x32_bf16 v[192:195], v[224:227], v[144:147], v[192:195]
    s_lshl_b32 s57, s44, 8
    ds_read_b64_tr_b16 v[246:247], v253 offset:59392
    v_cvt_pk_bf16_f32 v185, v114, v115
    v_cvt_pk_bf16_f32 v186, v116, v117
    v_mfma_f32_16x16x32_bf16 v[200:203], v[224:227], v[176:179], v[200:203]
    s_waitcnt lgkmcnt(8)
    ds_read_b64_tr_b16 v[72:73], v252 offset:61440
    v_cvt_pk_bf16_f32 v187, v118, v119
    v_mfma_f32_16x16x32_bf16 v[196:199], v[228:231], v[144:147], v[196:199]
    s_add_u32 s57, s57, s3
    ds_read_b64_tr_b16 v[74:75], v252 offset:63488
    v_cvt_pk_bf16_f32 v156, v56, v57
    v_mfma_f32_16x16x32_bf16 v[204:207], v[228:231], v[176:179], v[204:207]
    s_waitcnt lgkmcnt(8)
    ds_read_b64_tr_b16 v[76:77], v253 offset:61440
    v_cvt_pk_bf16_f32 v157, v58, v59
    v_mov_b32 v64, v250
    v_mfma_f32_16x16x32_bf16 v[192:195], v[232:235], v[148:151], v[192:195]
    s_add_u32 s57, s57, s88
    ds_read_b64_tr_b16 v[78:79], v253 offset:63488
    v_cvt_pk_bf16_f32 v158, v60, v61
    v_mov_b32 v65, v251
    v_mfma_f32_16x16x32_bf16 v[200:203], v[232:235], v[180:183], v[200:203]
    s_waitcnt lgkmcnt(8)
    ds_read_b64_tr_b16 v[224:225], v254 offset:32768
    v_cvt_pk_bf16_f32 v159, v62, v63
    v_mov_b32 v66, 0x4e800000
    v_mfma_f32_16x16x32_bf16 v[196:199], v[236:239], v[148:151], v[196:199]
    s_add_u32 s57, s57, 229376
    ds_read_b64_tr_b16 v[226:227], v254 offset:34816
    v_cvt_pk_bf16_f32 v188, v120, v121
    v_mov_b32 v67, s51
    v_mfma_f32_16x16x32_bf16 v[204:207], v[236:239], v[180:183], v[204:207]
    s_waitcnt lgkmcnt(8)
    ds_read_b64_tr_b16 v[228:229], v255 offset:32768
    v_cvt_pk_bf16_f32 v189, v122, v123
    v_permlane16_swap_b32 v64, v250
    v_mfma_f32_16x16x32_bf16 v[192:195], v[240:243], v[152:155], v[192:195]
    s_lshl_b32 s62, s46, 1
    ds_read_b64_tr_b16 v[230:231], v255 offset:34816
    v_cvt_pk_bf16_f32 v190, v124, v125
    v_permlane16_swap_b32 v65, v251
    v_mfma_f32_16x16x32_bf16 v[200:203], v[240:243], v[184:187], v[200:203]
    s_waitcnt lgkmcnt(8)
    ds_read_b64_tr_b16 v[232:233], v254 offset:36864
    v_cvt_pk_bf16_f32 v191, v126, v127
    v_add_f32 v250, v250, v64
    v_mfma_f32_16x16x32_bf16 v[196:199], v[244:247], v[152:155], v[196:199]
    s_and_b32 s62, s62, 24
    ds_read_b64_tr_b16 v[234:235], v254 offset:38912
    v_add_f32 v251, v251, v65
    v_mfma_f32_16x16x32_bf16 v[204:207], v[244:247], v[184:187], v[204:207]
    s_waitcnt lgkmcnt(8)
    ds_read_b64_tr_b16 v[236:237], v255 offset:36864
    v_med3_f32 v64, v250, s52, v66
    v_mfma_f32_16x16x32_bf16 v[192:195], v[72:75], v[156:159], v[192:195]
    s_lshl_b32 s62, 1, s62
    ds_read_b64_tr_b16 v[238:239], v255 offset:38912
    ds_read_b64_tr_b16 v[240:241], v254 offset:40960
    v_med3_f32 v65, v251, s52, v66
    v_mfma_f32_16x16x32_bf16 v[200:203], v[72:75], v[188:191], v[200:203]
    s_waitcnt lgkmcnt(9)
    ds_read_b64_tr_b16 v[242:243], v254 offset:43008
    ds_read_b64_tr_b16 v[244:245], v255 offset:40960
    v_cmp_neq_f32 vcc, v64, v250
    v_mfma_f32_16x16x32_bf16 v[196:199], v[76:79], v[156:159], v[196:199]
    s_mov_b32 s54, 3
    ds_read_b64_tr_b16 v[246:247], v255 offset:43008
    v_cmp_neq_f32 s[60:61], v65, v251
    v_mfma_f32_16x16x32_bf16 v[204:207], v[76:79], v[188:191], v[204:207]
    s_waitcnt lgkmcnt(10)
    ds_read_b64_tr_b16 v[72:73], v254 offset:45056
    ds_read_b64_tr_b16 v[74:75], v254 offset:47104
    v_rcp_f32 v250, v250
    v_mfma_f32_16x16x32_bf16 v[208:211], v[224:227], v[128:131], 0
    s_mov_b32 s55, 67584
    ds_read_b64_tr_b16 v[76:77], v255 offset:45056
    v_rcp_f32 v251, v251
    v_mfma_f32_16x16x32_bf16 v[216:219], v[224:227], v[160:163], 0
    s_waitcnt lgkmcnt(11)
    ds_read_b64_tr_b16 v[78:79], v255 offset:47104
    ds_read_b64_tr_b16 v[224:225], v254 offset:49152
    v_mfma_f32_16x16x32_bf16 v[212:215], v[228:231], v[128:131], 0
    s_or_b64 vcc, vcc, s[60:61]
    ds_read_b64_tr_b16 v[226:227], v254 offset:51200
    v_mul_f32 v192, v250, v192
    v_mfma_f32_16x16x32_bf16 v[220:223], v[228:231], v[160:163], 0
    s_waitcnt lgkmcnt(12)
    ds_read_b64_tr_b16 v[228:229], v255 offset:49152
    v_mul_f32 v193, v250, v193
    v_mfma_f32_16x16x32_bf16 v[208:211], v[232:235], v[132:135], v[208:211]
    s_cmp_lg_u64 vcc, 0
    ds_read_b64_tr_b16 v[230:231], v255 offset:51200
    v_mul_f32 v194, v250, v194
    v_mfma_f32_16x16x32_bf16 v[216:219], v[232:235], v[164:167], v[216:219]
    s_waitcnt lgkmcnt(12)
    ds_read_b64_tr_b16 v[232:233], v254 offset:53248
    v_mul_f32 v195, v250, v195
    v_mfma_f32_16x16x32_bf16 v[212:215], v[236:239], v[132:135], v[212:215]
    s_cselect_b32 s53, 1, 0
    ds_read_b64_tr_b16 v[234:235], v254 offset:55296
    v_mul_f32 v196, v250, v196
    v_mfma_f32_16x16x32_bf16 v[220:223], v[236:239], v[164:167], v[220:223]
    s_waitcnt lgkmcnt(12)
    ds_read_b64_tr_b16 v[236:237], v255 offset:53248
    v_mul_f32 v197, v250, v197
    v_mfma_f32_16x16x32_bf16 v[208:211], v[240:243], v[136:139], v[208:211]
    s_cmp_eq_u32 s97, 0
    ds_read_b64_tr_b16 v[238:239], v255 offset:55296
    v_mul_f32 v198, v250, v198
    v_mfma_f32_16x16x32_bf16 v[216:219], v[240:243], v[168:171], v[216:219]
    s_waitcnt lgkmcnt(12)
    ds_read_b64_tr_b16 v[240:241], v254 offset:57344
    v_mul_f32 v199, v250, v199
    v_mfma_f32_16x16x32_bf16 v[212:215], v[244:247], v[136:139], v[212:215]
    s_cselect_b32 s53, s53, s97
    ds_read_b64_tr_b16 v[242:243], v254 offset:59392
    v_cvt_pk_bf16_f32 v0, v192, v193
    v_mfma_f32_16x16x32_bf16 v[220:223], v[244:247], v[168:171], v[220:223]
    s_waitcnt lgkmcnt(12)
    ds_read_b64_tr_b16 v[244:245], v255 offset:57344
    v_cvt_pk_bf16_f32 v1, v194, v195
    v_mfma_f32_16x16x32_bf16 v[208:211], v[72:75], v[140:143], v[208:211]
    s_and_b32 s53, s53, 1
    ds_read_b64_tr_b16 v[246:247], v255 offset:59392
    v_cvt_pk_bf16_f32 v2, v196, v197
    v_mfma_f32_16x16x32_bf16 v[216:219], v[72:75], v[172:175], v[216:219]
    s_waitcnt lgkmcnt(12)
    ds_read_b64_tr_b16 v[72:73], v254 offset:61440
    v_cvt_pk_bf16_f32 v3, v198, v199
    v_mfma_f32_16x16x32_bf16 v[212:215], v[76:79], v[140:143], v[212:215]
    ds_read_b64_tr_b16 v[74:75], v254 offset:63488
    v_mov_b32 v64, s53
    v_mfma_f32_16x16x32_bf16 v[220:223], v[76:79], v[172:175], v[220:223]
    s_waitcnt lgkmcnt(12)
    ds_read_b64_tr_b16 v[76:77], v255 offset:61440
    ds_read_b64_tr_b16 v[78:79], v255 offset:63488
    v_mfma_f32_16x16x32_bf16 v[208:211], v[224:227], v[144:147], v[208:211]
    ds_write_b32 v67, v64
    v_mov_b32 v65, 0
    v_mfma_f32_16x16x32_bf16 v[216:219], v[224:227], v[176:179], v[216:219]
    s_waitcnt lgkmcnt(13)
    v_add_u32 v252, 4294899712, v252
    v_add_u32 v253, 4294899712, v253
    v_mfma_f32_16x16x32_bf16 v[212:215], v[228:231], v[144:147], v[212:215]
    v_add_u32 v254, 4294899712, v254
    v_add_u32 v255, 4294899712, v255
    v_mfma_f32_16x16x32_bf16 v[220:223], v[228:231], v[176:179], v[220:223]
    s_waitcnt lgkmcnt(11)
    buffer_store_dwordx4 v[0:3], v248, s[40:43], s63 offen offset:0 sc0 sc1
    v_mul_f32 v200, v251, v200
    s_waitcnt lgkmcnt(0)
    s_barrier
    v_mfma_f32_16x16x32_bf16 v[208:211], v[232:235], v[148:151], v[208:211]
    ds_read_b128 v[80:83], v65
    ds_read_b64_tr_b16 v[224:225], v252 offset:0
    v_mfma_f32_16x16x32_bf16 v[216:219], v[232:235], v[180:183], v[216:219]
    ds_read_b64_tr_b16 v[226:227], v252 offset:2048
    v_mul_f32 v201, v251, v201
    v_mfma_f32_16x16x32_bf16 v[212:215], v[236:239], v[148:151], v[212:215]
    ds_read_b64_tr_b16 v[228:229], v253 offset:0
    v_mul_f32 v202, v251, v202
    v_mfma_f32_16x16x32_bf16 v[220:223], v[236:239], v[180:183], v[220:223]
    ds_read_b64_tr_b16 v[230:231], v253 offset:2048
    v_mul_f32 v203, v251, v203
    v_mfma_f32_16x16x32_bf16 v[208:211], v[240:243], v[152:155], v[208:211]
    ds_read_b64_tr_b16 v[232:233], v252 offset:4096
    v_mul_f32 v204, v251, v204
    v_mfma_f32_16x16x32_bf16 v[216:219], v[240:243], v[184:187], v[216:219]
    ds_read_b64_tr_b16 v[234:235], v252 offset:6144
    v_mul_f32 v205, v251, v205
    v_mfma_f32_16x16x32_bf16 v[212:215], v[244:247], v[152:155], v[212:215]
    ds_read_b64_tr_b16 v[236:237], v253 offset:4096
    v_mul_f32 v206, v251, v206
    v_mfma_f32_16x16x32_bf16 v[220:223], v[244:247], v[184:187], v[220:223]
    ds_read_b64_tr_b16 v[238:239], v253 offset:6144
    v_mul_f32 v207, v251, v207
    v_mfma_f32_16x16x32_bf16 v[208:211], v[72:75], v[156:159], v[208:211]
    ds_read_b64_tr_b16 v[240:241], v252 offset:8192
    v_cvt_pk_bf16_f32 v4, v200, v201
    v_mfma_f32_16x16x32_bf16 v[216:219], v[72:75], v[188:191], v[216:219]
    ds_read_b64_tr_b16 v[242:243], v252 offset:10240
    v_cvt_pk_bf16_f32 v5, v202, v203
    v_mfma_f32_16x16x32_bf16 v[212:215], v[76:79], v[156:159], v[212:215]
    ds_read_b64_tr_b16 v[244:245], v253 offset:8192
    v_cvt_pk_bf16_f32 v6, v204, v205
    v_mfma_f32_16x16x32_bf16 v[220:223], v[76:79], v[188:191], v[220:223]
    s_waitcnt lgkmcnt(9)
    ds_read_b64_tr_b16 v[246:247], v253 offset:10240
    v_cvt_pk_bf16_f32 v7, v206, v207
    buffer_store_dwordx4 v[4:7], v248, s[40:43], s63 offen offset:2048 sc0 sc1
    v_or3_b32 v80, v80, v81, v82
    v_or_b32 v80, v80, v83
    v_cmp_ne_u32 vcc, 0, v80
    v_min_u32 v249, 16, v248
    v_mul_u32_u24 v249, 0x700000, v249
    v_lshlrev_b32 v249, 4, v249
    v_mov_b32 v66, s62
    s_cbranch_vccnz LA_redo2
    .p2align 3
LA_op2:
    v_mfma_f32_16x16x32_bf16 v[192:195], v[224:227], v[128:131], 0
    s_lshl_b32 s64, s59, 15
    v_mfma_f32_16x16x32_bf16 v[200:203], v[224:227], v[160:163], 0
    s_waitcnt lgkmcnt(8)
    ds_read_b64_tr_b16 v[72:73], v252 offset:12288
    v_mul_f32 v208, v250, v208
    v_mfma_f32_16x16x32_bf16 v[196:199], v[228:231], v[128:131], 0
    s_add_u32 s64, s64, s58
    ds_read_b64_tr_b16 v[74:75], v252 offset:14336
    v_mul_f32 v209, v250, v209
    v_mfma_f32_16x16x32_bf16 v[204:207], v[228:231], v[160:163], 0
    s_waitcnt lgkmcnt(8)
    ds_read_b64_tr_b16 v[76:77], v253 offset:12288
    v_mul_f32 v210, v250, v210
    v_mfma_f32_16x16x32_bf16 v[192:195], v[232:235], v[132:135], v[192:195]
    s_add_u32 s59, s59, 1
    ds_read_b64_tr_b16 v[78:79], v253 offset:14336
    v_mul_f32 v211, v250, v211
    v_mfma_f32_16x16x32_bf16 v[200:203], v[232:235], v[164:167], v[200:203]
    s_waitcnt lgkmcnt(8)
    ds_read_b64_tr_b16 v[224:225], v252 offset:16384
    v_mul_f32 v212, v250, v212
    v_mfma_f32_16x16x32_bf16 v[196:199], v[236:239], v[132:135], v[196:199]
    s_cmp_eq_u32 s59, 7
    ds_read_b64_tr_b16 v[226:227], v252 offset:18432
    v_mul_f32 v213, v250, v213
    v_mfma_f32_16x16x32_bf16 v[204:207], v[236:239], v[164:167], v[204:207]
    s_waitcnt lgkmcnt(8)
    ds_read_b64_tr_b16 v[228:229], v253 offset:16384
    v_mul_f32 v214, v250, v214
    v_mfma_f32_16x16x32_bf16 v[192:195], v[240:243], v[136:139], v[192:195]
    s_cselect_b32 s59, 0, s59
    ds_read_b64_tr_b16 v[230:231], v253 offset:18432
    v_mul_f32 v215, v250, v215
    v_mfma_f32_16x16x32_bf16 v[200:203], v[240:243], v[168:171], v[200:203]
    s_waitcnt lgkmcnt(8)
    ds_read_b64_tr_b16 v[232:233], v252 offset:20480
    v_cvt_pk_bf16_f32 v8, v208, v209
    v_mfma_f32_16x16x32_bf16 v[196:199], v[244:247], v[136:139], v[196:199]
    s_mul_i32 s51, s56, 1024
    ds_read_b64_tr_b16 v[234:235], v252 offset:22528
    v_cvt_pk_bf16_f32 v9, v210, v211
    v_mfma_f32_16x16x32_bf16 v[204:207], v[244:247], v[168:171], v[204:207]
    s_waitcnt lgkmcnt(8)
    ds_read_b64_tr_b16 v[236:237], v253 offset:20480
    v_cvt_pk_bf16_f32 v10, v212, v213
    v_mfma_f32_16x16x32_bf16 v[192:195], v[72:75], v[140:143], v[192:195]
    s_add_u32 s51, s51, s57
    ds_read_b64_tr_b16 v[238:239], v253 offset:22528
    v_cvt_pk_bf16_f32 v11, v214, v215
    v_mfma_f32_16x16x32_bf16 v[200:203], v[72:75], v[172:175], v[200:203]
    s_waitcnt lgkmcnt(8)
    ds_read_b64_tr_b16 v[240:241], v252 offset:24576
    buffer_store_dwordx4 v[8:11], v248, s[40:43], s63 offen offset:1024 sc0 sc1
    v_mfma_f32_16x16x32_bf16 v[196:199], v[76:79], v[140:143], v[196:199]
    s_add_u32 s52, s56, 1
    ds_read_b64_tr_b16 v[242:243], v252 offset:26624
    v_mul_f32 v216, v251, v216
    v_mfma_f32_16x16x32_bf16 v[204:207], v[76:79], v[172:175], v[204:207]
    s_waitcnt lgkmcnt(8)
    ds_read_b64_tr_b16 v[244:245], v253 offset:24576
    v_mul_f32 v217, v251, v217
    v_mfma_f32_16x16x32_bf16 v[192:195], v[224:227], v[144:147], v[192:195]
    s_cmp_eq_u32 s52, 7
    ds_read_b64_tr_b16 v[246:247], v253 offset:26624
    v_mul_f32 v218, v251, v218
    v_mfma_f32_16x16x32_bf16 v[200:203], v[224:227], v[176:179], v[200:203]
    s_waitcnt lgkmcnt(8)
    ds_read_b64_tr_b16 v[72:73], v252 offset:28672
    v_mul_f32 v219, v251, v219
    v_mfma_f32_16x16x32_bf16 v[196:199], v[228:231], v[144:147], v[196:199]
    s_cselect_b32 s52, 0, s52
    ds_read_b64_tr_b16 v[74:75], v252 offset:30720
    v_mul_f32 v220, v251, v220
    v_mfma_f32_16x16x32_bf16 v[204:207], v[228:231], v[176:179], v[204:207]
    s_waitcnt lgkmcnt(8)
    ds_read_b64_tr_b16 v[76:77], v253 offset:28672
    v_mul_f32 v221, v251, v221
    v_mfma_f32_16x16x32_bf16 v[192:195], v[232:235], v[148:151], v[192:195]
    s_cmp_eq_u32 s54, 3
    ds_read_b64_tr_b16 v[78:79], v253 offset:30720
    v_mul_f32 v222, v251, v222
    v_mfma_f32_16x16x32_bf16 v[200:203], v[232:235], v[180:183], v[200:203]
    s_waitcnt lgkmcnt(8)
    ds_read_b64_tr_b16 v[224:225], v254 offset:0
    v_mul_f32 v223, v251, v223
    v_mfma_f32_16x16x32_bf16 v[196:199], v[236:239], v[148:151], v[196:199]
    s_cselect_b32 s51, 0x7ff00000, s51
    ds_read_b64_tr_b16 v[226:227], v254 offset:2048
    v_cvt_pk_bf16_f32 v12, v216, v217
    v_mfma_f32_16x16x32_bf16 v[204:207], v[236:239], v[180:183], v[204:207]
    s_waitcnt lgkmcnt(8)
    ds_read_b64_tr_b16 v[228:229], v255 offset:0
    v_cvt_pk_bf16_f32 v13, v218, v219
    v_mfma_f32_16x16x32_bf16 v[192:195], v[240:243], v[152:155], v[192:195]
    s_cselect_b32 s56, s56, s52
    ds_read_b64_tr_b16 v[230:231], v255 offset:2048
    v_cvt_pk_bf16_f32 v14, v220, v221
    v_mfma_f32_16x16x32_bf16 v[200:203], v[240:243], v[184:187], v[200:203]
    s_waitcnt lgkmcnt(8)
    ds_read_b64_tr_b16 v[232:233], v254 offset:4096
    v_cvt_pk_bf16_f32 v15, v222, v223
    v_mfma_f32_16x16x32_bf16 v[196:199], v[244:247], v[152:155], v[196:199]
    ds_read_b64_tr_b16 v[234:235], v254 offset:6144
    buffer_store_dwordx4 v[12:15], v248, s[40:43], s63 offen offset:3072 sc0 sc1
    v_mfma_f32_16x16x32_bf16 v[204:207], v[244:247], v[184:187], v[204:207]
    s_waitcnt lgkmcnt(8)
    ds_read_b64_tr_b16 v[236:237], v255 offset:4096
    v_mfma_f32_16x16x32_bf16 v[192:195], v[72:75], v[156:159], v[192:195]
    ds_read_b64_tr_b16 v[238:239], v255 offset:6144
    ds_read_b64_tr_b16 v[240:241], v254 offset:8192
    v_mfma_f32_16x16x32_bf16 v[200:203], v[72:75], v[188:191], v[200:203]
    s_waitcnt lgkmcnt(9)
    ds_read_b64_tr_b16 v[242:243], v254 offset:10240
    ds_read_b64_tr_b16 v[244:245], v255 offset:8192
    v_mfma_f32_16x16x32_bf16 v[196:199], v[76:79], v[156:159], v[196:199]
    ds_read_b64_tr_b16 v[246:247], v255 offset:10240
    v_mfma_f32_16x16x32_bf16 v[204:207], v[76:79], v[188:191], v[204:207]
    s_waitcnt lgkmcnt(10)
    ds_read_b64_tr_b16 v[72:73], v254 offset:12288
    ds_read_b64_tr_b16 v[74:75], v254 offset:14336
    v_mfma_f32_16x16x32_bf16 v[208:211], v[224:227], v[128:131], 0
    ds_read_b128 v[80:83], v65 offset:32
    ds_read_b64_tr_b16 v[76:77], v255 offset:12288
    v_mfma_f32_16x16x32_bf16 v[216:219], v[224:227], v[160:163], 0
    s_waitcnt lgkmcnt(12)
    ds_read_b64_tr_b16 v[78:79], v255 offset:14336
    ds_read_b64_tr_b16 v[224:225], v254 offset:16384
    v_mfma_f32_16x16x32_bf16 v[212:215], v[228:231], v[128:131], 0
    ds_read_b64_tr_b16 v[226:227], v254 offset:18432
    v_mul_f32 v192, v250, v192
    v_mfma_f32_16x16x32_bf16 v[220:223], v[228:231], v[160:163], 0
    s_waitcnt lgkmcnt(13)
    ds_read_b64_tr_b16 v[228:229], v255 offset:16384
    v_mul_f32 v193, v250, v193
    v_mfma_f32_16x16x32_bf16 v[208:211], v[232:235], v[132:135], v[208:211]
    ds_read_b64_tr_b16 v[230:231], v255 offset:18432
    v_mul_f32 v194, v250, v194
    v_mfma_f32_16x16x32_bf16 v[216:219], v[232:235], v[164:167], v[216:219]
    s_waitcnt lgkmcnt(13)
    ds_read_b64_tr_b16 v[232:233], v254 offset:20480
    v_mul_f32 v195, v250, v195
    v_mfma_f32_16x16x32_bf16 v[212:215], v[236:239], v[132:135], v[212:215]
    ds_read_b64_tr_b16 v[234:235], v254 offset:22528
    v_mul_f32 v196, v250, v196
    v_mfma_f32_16x16x32_bf16 v[220:223], v[236:239], v[164:167], v[220:223]
    s_waitcnt lgkmcnt(13)
    ds_read_b64_tr_b16 v[236:237], v255 offset:20480
    v_mul_f32 v197, v250, v197
    v_mfma_f32_16x16x32_bf16 v[208:211], v[240:243], v[136:139], v[208:211]
    ds_read_b64_tr_b16 v[238:239], v255 offset:22528
    v_mul_f32 v198, v250, v198
    v_mfma_f32_16x16x32_bf16 v[216:219], v[240:243], v[168:171], v[216:219]
    s_waitcnt lgkmcnt(13)
    ds_read_b64_tr_b16 v[240:241], v254 offset:24576
    v_mul_f32 v199, v250, v199
    v_mfma_f32_16x16x32_bf16 v[212:215], v[244:247], v[136:139], v[212:215]
    ds_read_b64_tr_b16 v[242:243], v254 offset:26624
    v_cvt_pk_bf16_f32 v16, v192, v193
    v_mfma_f32_16x16x32_bf16 v[220:223], v[244:247], v[168:171], v[220:223]
    s_waitcnt lgkmcnt(13)
    ds_read_b64_tr_b16 v[244:245], v255 offset:24576
    v_cvt_pk_bf16_f32 v17, v194, v195
    v_mfma_f32_16x16x32_bf16 v[208:211], v[72:75], v[140:143], v[208:211]
    ds_read_b64_tr_b16 v[246:247], v255 offset:26624
    v_cvt_pk_bf16_f32 v18, v196, v197
    v_mfma_f32_16x16x32_bf16 v[216:219], v[72:75], v[172:175], v[216:219]
    s_waitcnt lgkmcnt(12)
    ds_read_b64_tr_b16 v[72:73], v254 offset:28672
    v_cvt_pk_bf16_f32 v19, v198, v199
    v_mfma_f32_16x16x32_bf16 v[212:215], v[76:79], v[140:143], v[212:215]
    ds_read_b64_tr_b16 v[74:75], v254 offset:30720
    buffer_store_dwordx4 v[16:19], v248, s[40:43], s64 offen offset:0 sc0 sc1
    v_mfma_f32_16x16x32_bf16 v[220:223], v[76:79], v[172:175], v[220:223]
    s_waitcnt lgkmcnt(12)
    ds_read_b64_tr_b16 v[76:77], v255 offset:28672
    ds_read_b64_tr_b16 v[78:79], v255 offset:30720
    v_mfma_f32_16x16x32_bf16 v[208:211], v[224:227], v[144:147], v[208:211]
    v_mul_f32 v200, v251, v200
    v_mul_f32 v201, v251, v201
    v_mfma_f32_16x16x32_bf16 v[216:219], v[224:227], v[176:179], v[216:219]
    s_waitcnt lgkmcnt(12)
    v_mul_f32 v202, v251, v202
    v_mul_f32 v203, v251, v203
    v_mfma_f32_16x16x32_bf16 v[212:215], v[228:231], v[144:147], v[212:215]
    s_cmp_lt_u32 s54, 2
    v_mul_f32 v204, v251, v204
    v_mul_f32 v205, v251, v205
    v_mfma_f32_16x16x32_bf16 v[220:223], v[228:231], v[176:179], v[220:223]
    s_waitcnt lgkmcnt(10)
    v_mul_f32 v206, v251, v206
    v_mul_f32 v207, v251, v207
    s_waitcnt lgkmcnt(0)
    s_cbranch_scc1 LA_lw2
    s_barrier
LA_lr2:
    v_mfma_f32_16x16x32_bf16 v[208:211], v[232:235], v[148:151], v[208:211]
    ds_read_b64_tr_b16 v[224:225], v252 offset:32768
    v_cvt_pk_bf16_f32 v20, v200, v201
    v_mfma_f32_16x16x32_bf16 v[216:219], v[232:235], v[180:183], v[216:219]
    ds_read_b64_tr_b16 v[226:227], v252 offset:34816
    v_cvt_pk_bf16_f32 v21, v202, v203
    v_mfma_f32_16x16x32_bf16 v[212:215], v[236:239], v[148:151], v[212:215]
    ds_read_b64_tr_b16 v[228:229], v253 offset:32768
    v_cvt_pk_bf16_f32 v22, v204, v205
    v_mfma_f32_16x16x32_bf16 v[220:223], v[236:239], v[180:183], v[220:223]
    ds_read_b64_tr_b16 v[230:231], v253 offset:34816
    v_cvt_pk_bf16_f32 v23, v206, v207
    v_mfma_f32_16x16x32_bf16 v[208:211], v[240:243], v[152:155], v[208:211]
    ds_read_b64_tr_b16 v[232:233], v252 offset:36864
    buffer_store_dwordx4 v[20:23], v248, s[40:43], s64 offen offset:2048 sc0 sc1
    v_mfma_f32_16x16x32_bf16 v[216:219], v[240:243], v[184:187], v[216:219]
    ds_read_b64_tr_b16 v[234:235], v252 offset:38912
    v_mfma_f32_16x16x32_bf16 v[212:215], v[244:247], v[152:155], v[212:215]
    ds_read_b64_tr_b16 v[236:237], v253 offset:36864
    v_mfma_f32_16x16x32_bf16 v[220:223], v[244:247], v[184:187], v[220:223]
    ds_read_b64_tr_b16 v[238:239], v253 offset:38912
    v_mfma_f32_16x16x32_bf16 v[208:211], v[72:75], v[156:159], v[208:211]
    ds_read_b64_tr_b16 v[240:241], v252 offset:40960
    v_mfma_f32_16x16x32_bf16 v[216:219], v[72:75], v[188:191], v[216:219]
    ds_read_b64_tr_b16 v[242:243], v252 offset:43008
    v_mfma_f32_16x16x32_bf16 v[212:215], v[76:79], v[156:159], v[212:215]
    s_waitcnt vmcnt(7)
    buffer_atomic_add v66, v249, s[40:43], s51 offen sc1
    v_mfma_f32_16x16x32_bf16 v[220:223], v[76:79], v[188:191], v[220:223]
    s_waitcnt lgkmcnt(8)
    ds_read_b64_tr_b16 v[244:245], v253 offset:40960
    ds_read_b64_tr_b16 v[246:247], v253 offset:43008
    v_mfma_f32_16x16x32_bf16 v[192:195], v[224:227], v[128:131], 0
    s_lshl_b32 s63, s59, 15
    v_mfma_f32_16x16x32_bf16 v[200:203], v[224:227], v[160:163], 0
    s_waitcnt lgkmcnt(8)
    ds_read_b64_tr_b16 v[72:73], v252 offset:45056
    v_mul_f32 v208, v250, v208
    v_mfma_f32_16x16x32_bf16 v[196:199], v[228:231], v[128:131], 0
    s_add_u32 s63, s63, s58
    ds_read_b64_tr_b16 v[74:75], v252 offset:47104
    v_mul_f32 v209, v250, v209
    v_mfma_f32_16x16x32_bf16 v[204:207], v[228:231], v[160:163], 0
    s_waitcnt lgkmcnt(8)
    ds_read_b64_tr_b16 v[76:77], v253 offset:45056
    v_mul_f32 v210, v250, v210
    v_mfma_f32_16x16x32_bf16 v[192:195], v[232:235], v[132:135], v[192:195]
    s_add_u32 s59, s59, 1
    ds_read_b64_tr_b16 v[78:79], v253 offset:47104
    v_mul_f32 v211, v250, v211
    v_mfma_f32_16x16x32_bf16 v[200:203], v[232:235], v[164:167], v[200:203]
    s_waitcnt lgkmcnt(8)
    ds_read_b64_tr_b16 v[224:225], v252 offset:49152
    v_mul_f32 v212, v250, v212
    v_mfma_f32_16x16x32_bf16 v[196:199], v[236:239], v[132:135], v[196:199]
    s_cmp_eq_u32 s59, 7
    ds_read_b64_tr_b16 v[226:227], v252 offset:51200
    v_mul_f32 v213, v250, v213
    v_mfma_f32_16x16x32_bf16 v[204:207], v[236:239], v[164:167], v[204:207]
    s_waitcnt lgkmcnt(8)
    ds_read_b64_tr_b16 v[228:229], v253 offset:49152
    v_mul_f32 v214, v250, v214
    v_mfma_f32_16x16x32_bf16 v[192:195], v[240:243], v[136:139], v[192:195]
    s_cselect_b32 s59, 0, s59
    ds_read_b64_tr_b16 v[230:231], v253 offset:51200
    v_mul_f32 v215, v250, v215
    v_mfma_f32_16x16x32_bf16 v[200:203], v[240:243], v[168:171], v[200:203]
    s_waitcnt lgkmcnt(8)
    ds_read_b64_tr_b16 v[232:233], v252 offset:53248
    v_cvt_pk_bf16_f32 v24, v208, v209
    v_mfma_f32_16x16x32_bf16 v[196:199], v[244:247], v[136:139], v[196:199]
    s_mul_i32 s51, s56, 1024
    ds_read_b64_tr_b16 v[234:235], v252 offset:55296
    v_cvt_pk_bf16_f32 v25, v210, v211
    v_mfma_f32_16x16x32_bf16 v[204:207], v[244:247], v[168:171], v[204:207]
    s_waitcnt lgkmcnt(8)
    ds_read_b64_tr_b16 v[236:237], v253 offset:53248
    v_cvt_pk_bf16_f32 v26, v212, v213
    v_mfma_f32_16x16x32_bf16 v[192:195], v[72:75], v[140:143], v[192:195]
    s_add_u32 s51, s51, s57
    ds_read_b64_tr_b16 v[238:239], v253 offset:55296
    v_cvt_pk_bf16_f32 v27, v214, v215
    v_mfma_f32_16x16x32_bf16 v[200:203], v[72:75], v[172:175], v[200:203]
    s_waitcnt lgkmcnt(8)
    ds_read_b64_tr_b16 v[240:241], v252 offset:57344
    buffer_store_dwordx4 v[24:27], v248, s[40:43], s64 offen offset:1024 sc0 sc1
    v_mfma_f32_16x16x32_bf16 v[196:199], v[76:79], v[140:143], v[196:199]
    s_add_u32 s56, s56, 1
    ds_read_b64_tr_b16 v[242:243], v252 offset:59392
    v_mul_f32 v216, v251, v216
    v_mfma_f32_16x16x32_bf16 v[204:207], v[76:79], v[172:175], v[204:207]
    s_waitcnt lgkmcnt(8)
    ds_read_b64_tr_b16 v[244:245], v253 offset:57344
    v_mul_f32 v217, v251, v217
    v_mfma_f32_16x16x32_bf16 v[192:195], v[224:227], v[144:147], v[192:195]
    s_cmp_eq_u32 s56, 7
    ds_read_b64_tr_b16 v[246:247], v253 offset:59392
    v_mul_f32 v218, v251, v218
    v_mfma_f32_16x16x32_bf16 v[200:203], v[224:227], v[176:179], v[200:203]
    s_waitcnt lgkmcnt(8)
    ds_read_b64_tr_b16 v[72:73], v252 offset:61440
    v_mul_f32 v219, v251, v219
    v_mfma_f32_16x16x32_bf16 v[196:199], v[228:231], v[144:147], v[196:199]
    s_cselect_b32 s56, 0, s56
    ds_read_b64_tr_b16 v[74:75], v252 offset:63488
    v_mul_f32 v220, v251, v220
    v_mfma_f32_16x16x32_bf16 v[204:207], v[228:231], v[176:179], v[204:207]
    s_waitcnt lgkmcnt(8)
    ds_read_b64_tr_b16 v[76:77], v253 offset:61440
    v_mul_f32 v221, v251, v221
    v_mfma_f32_16x16x32_bf16 v[192:195], v[232:235], v[148:151], v[192:195]
    ds_read_b64_tr_b16 v[78:79], v253 offset:63488
    v_mul_f32 v222, v251, v222
    v_mfma_f32_16x16x32_bf16 v[200:203], v[232:235], v[180:183], v[200:203]
    s_waitcnt lgkmcnt(8)
    ds_read_b64_tr_b16 v[224:225], v254 offset:32768
    v_mul_f32 v223, v251, v223
    v_mfma_f32_16x16x32_bf16 v[196:199], v[236:239], v[148:151], v[196:199]
    ds_read_b64_tr_b16 v[226:227], v254 offset:34816
    v_cvt_pk_bf16_f32 v28, v216, v217
    v_mfma_f32_16x16x32_bf16 v[204:207], v[236:239], v[180:183], v[204:207]
    s_waitcnt lgkmcnt(8)
    ds_read_b64_tr_b16 v[228:229], v255 offset:32768
    v_cvt_pk_bf16_f32 v29, v218, v219
    v_mfma_f32_16x16x32_bf16 v[192:195], v[240:243], v[152:155], v[192:195]
    ds_read_b64_tr_b16 v[230:231], v255 offset:34816
    v_cvt_pk_bf16_f32 v30, v220, v221
    v_mfma_f32_16x16x32_bf16 v[200:203], v[240:243], v[184:187], v[200:203]
    s_waitcnt lgkmcnt(8)
    ds_read_b64_tr_b16 v[232:233], v254 offset:36864
    v_cvt_pk_bf16_f32 v31, v222, v223
    v_mfma_f32_16x16x32_bf16 v[196:199], v[244:247], v[152:155], v[196:199]
    ds_read_b64_tr_b16 v[234:235], v254 offset:38912
    buffer_store_dwordx4 v[28:31], v248, s[40:43], s64 offen offset:3072 sc0 sc1
    v_mfma_f32_16x16x32_bf16 v[204:207], v[244:247], v[184:187], v[204:207]
    s_waitcnt lgkmcnt(8)
    ds_read_b64_tr_b16 v[236:237], v255 offset:36864
    v_mfma_f32_16x16x32_bf16 v[192:195], v[72:75], v[156:159], v[192:195]
    ds_read_b64_tr_b16 v[238:239], v255 offset:38912
    ds_read_b64_tr_b16 v[240:241], v254 offset:40960
    v_mfma_f32_16x16x32_bf16 v[200:203], v[72:75], v[188:191], v[200:203]
    s_waitcnt lgkmcnt(9)
    ds_read_b64_tr_b16 v[242:243], v254 offset:43008
    ds_read_b64_tr_b16 v[244:245], v255 offset:40960
    v_mfma_f32_16x16x32_bf16 v[196:199], v[76:79], v[156:159], v[196:199]
    ds_read_b64_tr_b16 v[246:247], v255 offset:43008
    v_mfma_f32_16x16x32_bf16 v[204:207], v[76:79], v[188:191], v[204:207]
    s_waitcnt lgkmcnt(10)
    ds_read_b64_tr_b16 v[72:73], v254 offset:45056
    ds_read_b64_tr_b16 v[74:75], v254 offset:47104
    v_mfma_f32_16x16x32_bf16 v[208:211], v[224:227], v[128:131], 0
    ds_read_b64_tr_b16 v[76:77], v255 offset:45056
    v_mfma_f32_16x16x32_bf16 v[216:219], v[224:227], v[160:163], 0
    s_waitcnt lgkmcnt(11)
    ds_read_b64_tr_b16 v[78:79], v255 offset:47104
    ds_read_b64_tr_b16 v[224:225], v254 offset:49152
    v_mfma_f32_16x16x32_bf16 v[212:215], v[228:231], v[128:131], 0
    ds_read_b64_tr_b16 v[226:227], v254 offset:51200
    v_mul_f32 v192, v250, v192
    v_mfma_f32_16x16x32_bf16 v[220:223], v[228:231], v[160:163], 0
    s_waitcnt lgkmcnt(12)
    ds_read_b64_tr_b16 v[228:229], v255 offset:49152
    v_mul_f32 v193, v250, v193
    v_mfma_f32_16x16x32_bf16 v[208:211], v[232:235], v[132:135], v[208:211]
    ds_read_b64_tr_b16 v[230:231], v255 offset:51200
    v_mul_f32 v194, v250, v194
    v_mfma_f32_16x16x32_bf16 v[216:219], v[232:235], v[164:167], v[216:219]
    s_waitcnt lgkmcnt(12)
    ds_read_b64_tr_b16 v[232:233], v254 offset:53248
    v_mul_f32 v195, v250, v195
    v_mfma_f32_16x16x32_bf16 v[212:215], v[236:239], v[132:135], v[212:215]
    ds_read_b64_tr_b16 v[234:235], v254 offset:55296
    v_mul_f32 v196, v250, v196
    v_mfma_f32_16x16x32_bf16 v[220:223], v[236:239], v[164:167], v[220:223]
    s_waitcnt lgkmcnt(12)
    ds_read_b64_tr_b16 v[236:237], v255 offset:53248
    v_mul_f32 v197, v250, v197
    v_mfma_f32_16x16x32_bf16 v[208:211], v[240:243], v[136:139], v[208:211]
    ds_read_b64_tr_b16 v[238:239], v255 offset:55296
    v_mul_f32 v198, v250, v198
    v_mfma_f32_16x16x32_bf16 v[216:219], v[240:243], v[168:171], v[216:219]
    s_waitcnt lgkmcnt(12)
    ds_read_b64_tr_b16 v[240:241], v254 offset:57344
    v_mul_f32 v199, v250, v199
    v_mfma_f32_16x16x32_bf16 v[212:215], v[244:247], v[136:139], v[212:215]
    ds_read_b64_tr_b16 v[242:243], v254 offset:59392
    v_cvt_pk_bf16_f32 v0, v192, v193
    v_mfma_f32_16x16x32_bf16 v[220:223], v[244:247], v[168:171], v[220:223]
    s_waitcnt lgkmcnt(12)
    ds_read_b64_tr_b16 v[244:245], v255 offset:57344
    v_cvt_pk_bf16_f32 v1, v194, v195
    v_mfma_f32_16x16x32_bf16 v[208:211], v[72:75], v[140:143], v[208:211]
    ds_read_b64_tr_b16 v[246:247], v255 offset:59392
    v_cvt_pk_bf16_f32 v2, v196, v197
    v_mfma_f32_16x16x32_bf16 v[216:219], v[72:75], v[172:175], v[216:219]
    s_waitcnt lgkmcnt(12)
    ds_read_b64_tr_b16 v[72:73], v254 offset:61440
    v_cvt_pk_bf16_f32 v3, v198, v199
    v_mfma_f32_16x16x32_bf16 v[212:215], v[76:79], v[140:143], v[212:215]
    ds_read_b64_tr_b16 v[74:75], v254 offset:63488
    buffer_store_dwordx4 v[0:3], v248, s[40:43], s63 offen offset:0 sc0 sc1
    v_mfma_f32_16x16x32_bf16 v[220:223], v[76:79], v[172:175], v[220:223]
    s_waitcnt lgkmcnt(12)
    ds_read_b64_tr_b16 v[76:77], v255 offset:61440
    ds_read_b64_tr_b16 v[78:79], v255 offset:63488
    v_mfma_f32_16x16x32_bf16 v[208:211], v[224:227], v[144:147], v[208:211]
    v_mul_f32 v200, v251, v200
    v_mul_f32 v201, v251, v201
    v_mfma_f32_16x16x32_bf16 v[216:219], v[224:227], v[176:179], v[216:219]
    s_waitcnt lgkmcnt(12)
    v_add_u32 v252, s55, v252
    v_add_u32 v253, s55, v253
    v_mfma_f32_16x16x32_bf16 v[212:215], v[228:231], v[144:147], v[212:215]
    s_cmp_eq_u32 s54, 3
    v_add_u32 v254, s55, v254
    v_add_u32 v255, s55, v255
    v_mfma_f32_16x16x32_bf16 v[220:223], v[228:231], v[176:179], v[220:223]
    s_waitcnt lgkmcnt(10)
    v_mul_f32 v202, v251, v202
    v_mul_f32 v203, v251, v203
    s_cbranch_scc1 LA_b22
LA_b2r2:
    v_mfma_f32_16x16x32_bf16 v[208:211], v[232:235], v[148:151], v[208:211]
    ds_read_b64_tr_b16 v[224:225], v252 offset:0
    v_mul_f32 v204, v251, v204
    v_mfma_f32_16x16x32_bf16 v[216:219], v[232:235], v[180:183], v[216:219]
    s_waitcnt lgkmcnt(9)
    ds_read_b64_tr_b16 v[226:227], v252 offset:2048
    v_mul_f32 v205, v251, v205
    v_mfma_f32_16x16x32_bf16 v[212:215], v[236:239], v[148:151], v[212:215]
    s_sub_u32 s55, 0, s55
    ds_read_b64_tr_b16 v[228:229], v253 offset:0
    v_mul_f32 v206, v251, v206
    v_mfma_f32_16x16x32_bf16 v[220:223], v[236:239], v[180:183], v[220:223]
    s_waitcnt lgkmcnt(9)
    ds_read_b64_tr_b16 v[230:231], v253 offset:2048
    v_mul_f32 v207, v251, v207
    v_mfma_f32_16x16x32_bf16 v[208:211], v[240:243], v[152:155], v[208:211]
    s_sub_u32 s54, s54, 1
    ds_read_b64_tr_b16 v[232:233], v252 offset:4096
    v_cvt_pk_bf16_f32 v4, v200, v201
    v_mfma_f32_16x16x32_bf16 v[216:219], v[240:243], v[184:187], v[216:219]
    s_waitcnt lgkmcnt(9)
    ds_read_b64_tr_b16 v[234:235], v252 offset:6144
    v_cvt_pk_bf16_f32 v5, v202, v203
    v_mfma_f32_16x16x32_bf16 v[212:215], v[244:247], v[152:155], v[212:215]
    s_cmp_lg_u32 s54, 0
    ds_read_b64_tr_b16 v[236:237], v253 offset:4096
    v_cvt_pk_bf16_f32 v6, v204, v205
    v_mfma_f32_16x16x32_bf16 v[220:223], v[244:247], v[184:187], v[220:223]
    s_waitcnt lgkmcnt(9)
    ds_read_b64_tr_b16 v[238:239], v253 offset:6144
    v_cvt_pk_bf16_f32 v7, v206, v207
    v_mfma_f32_16x16x32_bf16 v[208:211], v[72:75], v[156:159], v[208:211]
    ds_read_b64_tr_b16 v[240:241], v252 offset:8192
    buffer_store_dwordx4 v[4:7], v248, s[40:43], s63 offen offset:2048 sc0 sc1
    v_mfma_f32_16x16x32_bf16 v[216:219], v[72:75], v[188:191], v[216:219]
    s_waitcnt lgkmcnt(9)
    ds_read_b64_tr_b16 v[242:243], v252 offset:10240
    v_mfma_f32_16x16x32_bf16 v[212:215], v[76:79], v[156:159], v[212:215]
    s_waitcnt vmcnt(7)
    buffer_atomic_add v66, v249, s[40:43], s51 offen sc1
    v_mfma_f32_16x16x32_bf16 v[220:223], v[76:79], v[188:191], v[220:223]
    s_waitcnt lgkmcnt(8)
    ds_read_b64_tr_b16 v[244:245], v253 offset:8192
    ds_read_b64_tr_b16 v[246:247], v253 offset:10240
    s_cbranch_scc1 LA_op2
    s_nop 1
    s_add_u32 s52, s3, s88
    s_add_u32 s52, s52, 236800
    v_mov_b32 v84, 1
    buffer_atomic_add v84, v249, s[40:43], s52 offen sc0 sc1
    s_nop 1
    v_pk_mul_f32 v[208:209], v[208:209], v[250:251] op_sel:[0,0] op_sel_hi:[1,0]
    v_pk_mul_f32 v[210:211], v[210:211], v[250:251] op_sel:[0,0] op_sel_hi:[1,0]
    v_pk_mul_f32 v[212:213], v[212:213], v[250:251] op_sel:[0,0] op_sel_hi:[1,0]
    v_pk_mul_f32 v[214:215], v[214:215], v[250:251] op_sel:[0,0] op_sel_hi:[1,0]
    v_cvt_pk_bf16_f32 v8, v208, v209
    v_cvt_pk_bf16_f32 v9, v210, v211
    v_cvt_pk_bf16_f32 v10, v212, v213
    v_cvt_pk_bf16_f32 v11, v214, v215
    buffer_store_dwordx4 v[8:11], v248, s[40:43], s63 offen offset:1024 sc0 sc1
    v_pk_mul_f32 v[216:217], v[216:217], v[250:251] op_sel:[0,1] op_sel_hi:[1,1]
    v_pk_mul_f32 v[218:219], v[218:219], v[250:251] op_sel:[0,1] op_sel_hi:[1,1]
    v_pk_mul_f32 v[220:221], v[220:221], v[250:251] op_sel:[0,1] op_sel_hi:[1,1]
    v_pk_mul_f32 v[222:223], v[222:223], v[250:251] op_sel:[0,1] op_sel_hi:[1,1]
    v_cvt_pk_bf16_f32 v12, v216, v217
    v_cvt_pk_bf16_f32 v13, v218, v219
    v_cvt_pk_bf16_f32 v14, v220, v221
    v_cvt_pk_bf16_f32 v15, v222, v223
    buffer_store_dwordx4 v[12:15], v248, s[40:43], s63 offen offset:3072 sc0 sc1
    s_mul_i32 s51, s56, 1024
    s_add_u32 s51, s51, s57
    s_add_u32 s56, s56, 1
    s_cmp_eq_u32 s56, 7
    s_cselect_b32 s56, 0, s56
    s_waitcnt vmcnt(5)
    buffer_atomic_add v66, v249, s[40:43], s51 offen sc1
    s_mul_i32 s51, s56, 1024
    s_add_u32 s51, s51, s57
    s_add_u32 s56, s56, 1
    s_cmp_eq_u32 s56, 7
    s_cselect_b32 s56, 0, s56
    s_waitcnt vmcnt(1)
    buffer_atomic_add v66, v249, s[40:43], s51 offen sc1
    s_waitcnt vmcnt(0) lgkmcnt(0)
    v_readfirstlane_b32 s54, v84
    s_mov_b64 exec, -1
    v_mbcnt_lo_u32_b32 v0, -1, 0
    v_mbcnt_hi_u32_b32 v0, -1, v0
    s_add_u32 s54, s54, 42
    s_cmp_lt_u32 s54, 98
    s_cbranch_scc1 LA_rsetup
    s_endpgm
LA_lw22:
    ds_read_b128 v[80:83], v65 offset:32
    s_waitcnt lgkmcnt(0)
LA_lw2:
    v_min3_u32 v80, v80, v81, v82
    v_min_u32 v80, v80, v83
    v_cmp_eq_u32 vcc, 0, v80
    s_cbranch_vccnz LA_lw22
    s_branch LA_lr2
LA_b22:
    s_waitcnt lgkmcnt(0)
    s_barrier
    s_branch LA_b2r2
    .p2align 6
LA_c1:
    s_branch LA_b01
LA_hb1:
    s_barrier
    s_branch LA_nh1
LA_b01:
    s_barrier
    ds_read_b128 v[208:211], v248 offset:0
    ds_read_b64_tr_b16 v[224:225], v249 offset:0
    ds_read_b64_tr_b16 v[226:227], v249 offset:512
    ds_read_b64_tr_b16 v[228:229], v249 offset:32
    ds_read_b64_tr_b16 v[230:231], v249 offset:544
    ds_read_b64_tr_b16 v[232:233], v249 offset:64
    ds_read_b64_tr_b16 v[234:235], v249 offset:576
    ds_read_b64_tr_b16 v[236:237], v249 offset:96
    ds_read_b64_tr_b16 v[238:239], v249 offset:608
    ds_read_b64_tr_b16 v[240:241], v249 offset:128
    ds_read_b64_tr_b16 v[242:243], v249 offset:640
    ds_read_b64_tr_b16 v[244:245], v249 offset:160
    ds_read_b64_tr_b16 v[246:247], v249 offset:672
    s_waitcnt lgkmcnt(10)
    .p2align 3
LA_qp1:
    v_mfma_f32_16x16x32_bf16 v[0:3], v[224:227], v[208:211], v[0:3]
    s_waitcnt lgkmcnt(8)
    ds_read_b64_tr_b16 v[192:193], v249 offset:192
    v_mfma_f32_16x16x32_bf16 v[4:7], v[228:231], v[208:211], v[4:7]
    ds_read_b64_tr_b16 v[194:195], v249 offset:704
    s_waitcnt lgkmcnt(8)
    ds_read_b64_tr_b16 v[196:197], v249 offset:224
    v_mfma_f32_16x16x32_bf16 v[8:11], v[232:235], v[208:211], v[8:11]
    ds_read_b64_tr_b16 v[198:199], v249 offset:736
    s_waitcnt lgkmcnt(8)
    ds_read_b64_tr_b16 v[224:225], v249 offset:256
    v_mfma_f32_16x16x32_bf16 v[12:15], v[236:239], v[208:211], v[12:15]
    ds_read_b128 v[216:219], v248 offset:64
    ds_read_b64_tr_b16 v[226:227], v249 offset:768
    s_waitcnt lgkmcnt(9)
    ds_read_b64_tr_b16 v[228:229], v249 offset:288
    v_mfma_f32_16x16x32_bf16 v[16:19], v[240:243], v[208:211], v[16:19]
    ds_read_b64_tr_b16 v[230:231], v249 offset:800
    s_waitcnt lgkmcnt(9)
    ds_read_b64_tr_b16 v[232:233], v249 offset:320
    v_mfma_f32_16x16x32_bf16 v[20:23], v[244:247], v[208:211], v[20:23]
    ds_read_b64_tr_b16 v[234:235], v249 offset:832
    s_waitcnt lgkmcnt(9)
    ds_read_b64_tr_b16 v[236:237], v249 offset:352
    v_mfma_f32_16x16x32_bf16 v[24:27], v[192:195], v[208:211], v[24:27]
    ds_read_b64_tr_b16 v[238:239], v249 offset:864
    s_waitcnt lgkmcnt(9)
    ds_read_b64_tr_b16 v[240:241], v249 offset:384
    v_mfma_f32_16x16x32_bf16 v[28:31], v[196:199], v[208:211], v[28:31]
    ds_read_b64_tr_b16 v[242:243], v249 offset:896
    s_waitcnt lgkmcnt(8)
    ds_read_b64_tr_b16 v[244:245], v249 offset:416
    v_mfma_f32_16x16x32_bf16 v[32:35], v[224:227], v[208:211], v[32:35]
    s_cmp_eq_u32 s54, 6
    ds_read_b64_tr_b16 v[246:247], v249 offset:928
    s_waitcnt lgkmcnt(8)
    ds_read_b64_tr_b16 v[192:193], v249 offset:448
    v_mfma_f32_16x16x32_bf16 v[36:39], v[228:231], v[208:211], v[36:39]
    s_cbranch_scc1 LA_hb1
LA_nh1:
    ds_read_b64_tr_b16 v[194:195], v249 offset:960
    s_waitcnt lgkmcnt(8)
    ds_read_b64_tr_b16 v[196:197], v249 offset:480
    v_mfma_f32_16x16x32_bf16 v[40:43], v[232:235], v[208:211], v[40:43]
    s_add_u32 s56, s56, 1
    ds_read_b64_tr_b16 v[198:199], v249 offset:992
    s_waitcnt lgkmcnt(8)
    ds_read_b64_tr_b16 v[224:225], v249 offset:16896
    v_mfma_f32_16x16x32_bf16 v[44:47], v[236:239], v[208:211], v[44:47]
    s_cmp_eq_u32 s56, 3
    ds_read_b64_tr_b16 v[226:227], v249 offset:17408
    s_waitcnt lgkmcnt(8)
    ds_read_b64_tr_b16 v[228:229], v249 offset:16928
    v_mfma_f32_16x16x32_bf16 v[48:51], v[240:243], v[208:211], v[48:51]
    s_cselect_b32 s56, 0, s56
    ds_read_b64_tr_b16 v[230:231], v249 offset:17440
    s_waitcnt lgkmcnt(8)
    ds_read_b64_tr_b16 v[232:233], v249 offset:16960
    v_mfma_f32_16x16x32_bf16 v[52:55], v[244:247], v[208:211], v[52:55]
    s_cselect_b32 s55, -2, 1
    ds_read_b64_tr_b16 v[234:235], v249 offset:17472
    s_waitcnt lgkmcnt(8)
    ds_read_b64_tr_b16 v[236:237], v249 offset:16992
    v_mfma_f32_16x16x32_bf16 v[56:59], v[192:195], v[208:211], v[56:59]
    s_mul_i32 s57, s55, 16896
    ds_read_b64_tr_b16 v[238:239], v249 offset:17504
    s_waitcnt lgkmcnt(8)
    ds_read_b64_tr_b16 v[240:241], v249 offset:17024
    v_mfma_f32_16x16x32_bf16 v[60:63], v[196:199], v[208:211], v[60:63]
    s_mul_i32 s55, s55, 33792
    ds_read_b64_tr_b16 v[242:243], v249 offset:17536
    s_waitcnt lgkmcnt(8)
    ds_read_b64_tr_b16 v[244:245], v249 offset:17056
    v_mfma_f32_16x16x32_bf16 v[0:3], v[224:227], v[216:219], v[0:3]
    s_sub_u32 s54, s54, 1
    ds_read_b64_tr_b16 v[246:247], v249 offset:17568
    s_waitcnt lgkmcnt(8)
    ds_read_b64_tr_b16 v[192:193], v249 offset:17088
    v_mfma_f32_16x16x32_bf16 v[4:7], v[228:231], v[216:219], v[4:7]
    s_cmp_lg_u32 s54, 0
    ds_read_b64_tr_b16 v[194:195], v249 offset:17600
    s_waitcnt lgkmcnt(8)
    ds_read_b64_tr_b16 v[196:197], v249 offset:17120
    v_mfma_f32_16x16x32_bf16 v[8:11], v[232:235], v[216:219], v[8:11]
    ds_read_b64_tr_b16 v[198:199], v249 offset:17632
    s_waitcnt lgkmcnt(8)
    ds_read_b64_tr_b16 v[224:225], v249 offset:17152
    ds_read_b64_tr_b16 v[226:227], v249 offset:17664
    v_mfma_f32_16x16x32_bf16 v[12:15], v[236:239], v[216:219], v[12:15]
    ds_read_b64_tr_b16 v[228:229], v249 offset:17184
    s_waitcnt lgkmcnt(9)
    ds_read_b64_tr_b16 v[230:231], v249 offset:17696
    ds_read_b64_tr_b16 v[232:233], v249 offset:17216
    v_mfma_f32_16x16x32_bf16 v[16:19], v[240:243], v[216:219], v[16:19]
    ds_read_b64_tr_b16 v[234:235], v249 offset:17728
    s_waitcnt lgkmcnt(10)
    ds_read_b64_tr_b16 v[236:237], v249 offset:17248
    ds_read_b64_tr_b16 v[238:239], v249 offset:17760
    v_mfma_f32_16x16x32_bf16 v[20:23], v[244:247], v[216:219], v[20:23]
    ds_read_b64_tr_b16 v[240:241], v249 offset:17280
    s_waitcnt lgkmcnt(11)
    ds_read_b64_tr_b16 v[242:243], v249 offset:17792
    ds_read_b64_tr_b16 v[244:245], v249 offset:17312
    v_mfma_f32_16x16x32_bf16 v[24:27], v[192:195], v[216:219], v[24:27]
    ds_read_b64_tr_b16 v[246:247], v249 offset:17824
    s_waitcnt lgkmcnt(12)
    ds_read_b64_tr_b16 v[192:193], v249 offset:17344
    ds_read_b64_tr_b16 v[194:195], v249 offset:17856
    v_mfma_f32_16x16x32_bf16 v[28:31], v[196:199], v[216:219], v[28:31]
    s_waitcnt lgkmcnt(12)
    ds_read_b64_tr_b16 v[196:197], v249 offset:17376
    ds_read_b64_tr_b16 v[198:199], v249 offset:17888
    v_mfma_f32_16x16x32_bf16 v[32:35], v[224:227], v[216:219], v[32:35]
    s_waitcnt lgkmcnt(12)
    v_add_u32 v249, s55, v249
    v_add_u32 v248, s57, v248
    v_mfma_f32_16x16x32_bf16 v[36:39], v[228:231], v[216:219], v[36:39]
    s_waitcnt lgkmcnt(10)
    s_waitcnt lgkmcnt(0)
    s_barrier
    v_mfma_f32_16x16x32_bf16 v[40:43], v[232:235], v[216:219], v[40:43]
    ds_read_b128 v[208:211], v248 offset:0
    ds_read_b64_tr_b16 v[224:225], v249 offset:0
    ds_read_b64_tr_b16 v[226:227], v249 offset:512
    v_mfma_f32_16x16x32_bf16 v[44:47], v[236:239], v[216:219], v[44:47]
    ds_read_b64_tr_b16 v[228:229], v249 offset:32
    ds_read_b64_tr_b16 v[230:231], v249 offset:544
    v_mfma_f32_16x16x32_bf16 v[48:51], v[240:243], v[216:219], v[48:51]
    ds_read_b64_tr_b16 v[232:233], v249 offset:64
    ds_read_b64_tr_b16 v[234:235], v249 offset:576
    v_mfma_f32_16x16x32_bf16 v[52:55], v[244:247], v[216:219], v[52:55]
    ds_read_b64_tr_b16 v[236:237], v249 offset:96
    ds_read_b64_tr_b16 v[238:239], v249 offset:608
    v_mfma_f32_16x16x32_bf16 v[56:59], v[192:195], v[216:219], v[56:59]
    ds_read_b64_tr_b16 v[240:241], v249 offset:128
    ds_read_b64_tr_b16 v[242:243], v249 offset:640
    v_mfma_f32_16x16x32_bf16 v[60:63], v[196:199], v[216:219], v[60:63]
    ds_read_b64_tr_b16 v[244:245], v249 offset:160
    s_waitcnt lgkmcnt(9)
    ds_read_b64_tr_b16 v[246:247], v249 offset:672
    s_cbranch_scc1 LA_qp1
    v_mfma_f32_16x16x32_bf16 v[0:3], v[224:227], v[208:211], v[0:3]
    s_waitcnt lgkmcnt(8)
    ds_read_b64_tr_b16 v[192:193], v249 offset:16896
    v_mfma_f32_16x16x32_bf16 v[4:7], v[228:231], v[208:211], v[4:7]
    ds_read_b128 v[216:219], v248 offset:64
    ds_read_b64_tr_b16 v[194:195], v249 offset:17408
    s_waitcnt lgkmcnt(9)
    ds_read_b64_tr_b16 v[196:197], v249 offset:192
    v_mfma_f32_16x16x32_bf16 v[8:11], v[232:235], v[208:211], v[8:11]
    ds_read_b64_tr_b16 v[198:199], v249 offset:704
    s_waitcnt lgkmcnt(9)
    ds_read_b64_tr_b16 v[224:225], v249 offset:16928
    v_mfma_f32_16x16x32_bf16 v[12:15], v[236:239], v[208:211], v[12:15]
    ds_read_b64_tr_b16 v[226:227], v249 offset:17440
    s_waitcnt lgkmcnt(9)
    ds_read_b64_tr_b16 v[228:229], v249 offset:224
    v_mfma_f32_16x16x32_bf16 v[16:19], v[240:243], v[208:211], v[16:19]
    ds_read_b64_tr_b16 v[230:231], v249 offset:736
    s_waitcnt lgkmcnt(9)
    ds_read_b64_tr_b16 v[232:233], v249 offset:16960
    v_mfma_f32_16x16x32_bf16 v[20:23], v[244:247], v[208:211], v[20:23]
    ds_read_b64_tr_b16 v[234:235], v249 offset:17472
    s_waitcnt lgkmcnt(8)
    ds_read_b64_tr_b16 v[236:237], v249 offset:256
    v_mfma_f32_16x16x32_bf16 v[0:3], v[192:195], v[216:219], v[0:3]
    ds_read_b64_tr_b16 v[238:239], v249 offset:768
    s_waitcnt lgkmcnt(8)
    ds_read_b64_tr_b16 v[240:241], v249 offset:16992
    v_mfma_f32_16x16x32_bf16 v[24:27], v[196:199], v[208:211], v[24:27]
    ds_read_b64_tr_b16 v[242:243], v249 offset:17504
    s_waitcnt lgkmcnt(8)
    ds_read_b64_tr_b16 v[244:245], v249 offset:288
    v_mfma_f32_16x16x32_bf16 v[4:7], v[224:227], v[216:219], v[4:7]
    ds_read_b64_tr_b16 v[246:247], v249 offset:800
    s_waitcnt lgkmcnt(8)
    ds_read_b64_tr_b16 v[192:193], v249 offset:17024
    v_mfma_f32_16x16x32_bf16 v[28:31], v[228:231], v[208:211], v[28:31]
    ds_read_b64_tr_b16 v[194:195], v249 offset:17536
    s_waitcnt lgkmcnt(8)
    ds_read_b64_tr_b16 v[196:197], v249 offset:320
    v_mfma_f32_16x16x32_bf16 v[8:11], v[232:235], v[216:219], v[8:11]
    ds_read_b64_tr_b16 v[198:199], v249 offset:832
    s_waitcnt lgkmcnt(8)
    ds_read_b64_tr_b16 v[224:225], v249 offset:17056
    v_mfma_f32_16x16x32_bf16 v[32:35], v[236:239], v[208:211], v[32:35]
    ds_read_b64_tr_b16 v[226:227], v249 offset:17568
    s_waitcnt lgkmcnt(8)
    ds_read_b64_tr_b16 v[228:229], v249 offset:352
    v_mfma_f32_16x16x32_bf16 v[12:15], v[240:243], v[216:219], v[12:15]
    ds_read_b64_tr_b16 v[230:231], v249 offset:864
    s_waitcnt lgkmcnt(8)
    ds_read_b64_tr_b16 v[232:233], v249 offset:17088
    v_mfma_f32_16x16x32_bf16 v[36:39], v[244:247], v[208:211], v[36:39]
    ds_read_b64_tr_b16 v[234:235], v249 offset:17600
    v_mul_f32 v0, s68, v0
    s_waitcnt lgkmcnt(8)
    ds_read_b64_tr_b16 v[236:237], v249 offset:384
    v_mul_f32 v1, s68, v1
    v_mfma_f32_16x16x32_bf16 v[16:19], v[192:195], v[216:219], v[16:19]
    ds_read_b64_tr_b16 v[238:239], v249 offset:896
    v_mul_f32 v2, s68, v2
    s_waitcnt lgkmcnt(8)
    ds_read_b64_tr_b16 v[240:241], v249 offset:17120
    v_mul_f32 v3, s68, v3
    v_mfma_f32_16x16x32_bf16 v[40:43], v[196:199], v[208:211], v[40:43]
    ds_read_b64_tr_b16 v[242:243], v249 offset:17632
    v_mul_f32 v4, s68, v4
    s_waitcnt lgkmcnt(8)
    ds_read_b64_tr_b16 v[244:245], v249 offset:416
    v_mul_f32 v5, s68, v5
    v_mfma_f32_16x16x32_bf16 v[20:23], v[224:227], v[216:219], v[20:23]
    ds_read_b64_tr_b16 v[246:247], v249 offset:928
    v_mul_f32 v6, s68, v6
    s_waitcnt lgkmcnt(8)
    ds_read_b64_tr_b16 v[192:193], v249 offset:17152
    v_mul_f32 v7, s68, v7
    v_mfma_f32_16x16x32_bf16 v[44:47], v[228:231], v[208:211], v[44:47]
    ds_read_b64_tr_b16 v[194:195], v249 offset:17664
    v_cvt_pk_bf16_f32 v128, v0, v1
    s_waitcnt lgkmcnt(8)
    ds_read_b64_tr_b16 v[196:197], v249 offset:448
    v_cvt_pk_bf16_f32 v129, v2, v3
    v_mfma_f32_16x16x32_bf16 v[24:27], v[232:235], v[216:219], v[24:27]
    ds_read_b64_tr_b16 v[198:199], v249 offset:960
    v_cvt_pk_bf16_f32 v130, v4, v5
    s_waitcnt lgkmcnt(8)
    ds_read_b64_tr_b16 v[224:225], v249 offset:17184
    ds_read_b64_tr_b16 v[226:227], v249 offset:17696
    v_mfma_f32_16x16x32_bf16 v[48:51], v[236:239], v[208:211], v[48:51]
    ds_read_b64_tr_b16 v[228:229], v249 offset:480
    v_cvt_pk_bf16_f32 v131, v6, v7
    s_waitcnt lgkmcnt(9)
    ds_read_b64_tr_b16 v[230:231], v249 offset:992
    ds_read_b64_tr_b16 v[232:233], v249 offset:17216
    v_mfma_f32_16x16x32_bf16 v[28:31], v[240:243], v[216:219], v[28:31]
    ds_read_b64_tr_b16 v[234:235], v249 offset:17728
    v_mul_f32 v8, s68, v8
    s_waitcnt lgkmcnt(10)
    ds_read_b64_tr_b16 v[236:237], v249 offset:17248
    ds_read_b64_tr_b16 v[238:239], v249 offset:17760
    v_mfma_f32_16x16x32_bf16 v[52:55], v[244:247], v[208:211], v[52:55]
    ds_read_b64_tr_b16 v[240:241], v249 offset:17280
    v_mul_f32 v9, s68, v9
    s_waitcnt lgkmcnt(11)
    ds_read_b64_tr_b16 v[242:243], v249 offset:17792
    ds_read_b64_tr_b16 v[244:245], v249 offset:17312
    v_mfma_f32_16x16x32_bf16 v[32:35], v[192:195], v[216:219], v[32:35]
    ds_read_b64_tr_b16 v[246:247], v249 offset:17824
    v_mul_f32 v10, s68, v10
    s_waitcnt lgkmcnt(12)
    ds_read_b64_tr_b16 v[192:193], v249 offset:17344
    ds_read_b64_tr_b16 v[194:195], v249 offset:17856
    v_mfma_f32_16x16x32_bf16 v[56:59], v[196:199], v[208:211], v[56:59]
    v_mul_f32 v11, s68, v11
    v_mul_f32 v12, s68, v12
    s_waitcnt lgkmcnt(12)
    ds_read_b64_tr_b16 v[196:197], v249 offset:17376
    ds_read_b64_tr_b16 v[198:199], v249 offset:17888
    v_mfma_f32_16x16x32_bf16 v[36:39], v[224:227], v[216:219], v[36:39]
    v_mul_f32 v13, s68, v13
    v_mul_f32 v14, s68, v14
    s_waitcnt lgkmcnt(12)
    v_add_u32 v248, 96256, v253
    v_add_u32 v249, 96256, v252
    v_mfma_f32_16x16x32_bf16 v[60:63], v[228:231], v[208:211], v[60:63]
    v_mul_f32 v15, s68, v15
    v_cvt_pk_bf16_f32 v132, v8, v9
    s_waitcnt lgkmcnt(10)
    v_cvt_pk_bf16_f32 v133, v10, v11
    v_cvt_pk_bf16_f32 v134, v12, v13
    s_waitcnt lgkmcnt(0)
    s_barrier
    v_mfma_f32_16x16x32_bf16 v[40:43], v[232:235], v[216:219], v[40:43]
    ds_read_b128 v[224:227], v248 offset:0
    v_cvt_pk_bf16_f32 v135, v14, v15
    ds_read_b128 v[228:231], v248 offset:512
    v_permlane16_swap_b32 v128, v130
    v_mfma_f32_16x16x32_bf16 v[44:47], v[236:239], v[216:219], v[44:47]
    ds_read_b128 v[232:235], v248 offset:64
    v_permlane16_swap_b32 v129, v131
    ds_read_b128 v[236:239], v248 offset:576
    v_mul_f32 v16, s68, v16
    v_mfma_f32_16x16x32_bf16 v[48:51], v[240:243], v[216:219], v[48:51]
    v_mul_f32 v17, s68, v17
    v_mul_f32 v18, s68, v18
    ds_read_b128 v[240:243], v248 offset:128
    v_mul_f32 v19, s68, v19
    v_mfma_f32_16x16x32_bf16 v[52:55], v[244:247], v[216:219], v[52:55]
    v_mul_f32 v20, s68, v20
    v_mul_f32 v21, s68, v21
    v_mul_f32 v22, s68, v22
    v_mul_f32 v23, s68, v23
    v_mfma_f32_16x16x32_bf16 v[56:59], v[192:195], v[216:219], v[56:59]
    v_cvt_pk_bf16_f32 v136, v16, v17
    v_cvt_pk_bf16_f32 v137, v18, v19
    v_cvt_pk_bf16_f32 v138, v20, v21
    v_cvt_pk_bf16_f32 v139, v22, v23
    v_mfma_f32_16x16x32_bf16 v[60:63], v[196:199], v[216:219], v[60:63]
    v_permlane16_swap_b32 v132, v134
    v_permlane16_swap_b32 v133, v135
    s_waitcnt lgkmcnt(4)
    v_mul_f32 v24, s68, v24
    v_mul_f32 v25, s68, v25
    v_mul_f32 v26, s68, v26
    v_mul_f32 v27, s68, v27
    v_mul_f32 v28, s68, v28
    v_mul_f32 v29, s68, v29
    v_mul_f32 v30, s68, v30
    v_mul_f32 v31, s68, v31
    v_cvt_pk_bf16_f32 v140, v24, v25
    v_cvt_pk_bf16_f32 v141, v26, v27
    v_cvt_pk_bf16_f32 v142, v28, v29
    v_cvt_pk_bf16_f32 v143, v30, v31
    v_permlane16_swap_b32 v136, v138
    v_permlane16_swap_b32 v137, v139
    s_nop 3
    v_pk_mul_f32 v[32:33], v[32:33], s[68:69] op_sel_hi:[1,0]
    v_pk_mul_f32 v[34:35], v[34:35], s[68:69] op_sel_hi:[1,0]
    v_pk_mul_f32 v[36:37], v[36:37], s[68:69] op_sel_hi:[1,0]
    v_pk_mul_f32 v[38:39], v[38:39], s[68:69] op_sel_hi:[1,0]
    v_cvt_pk_bf16_f32 v144, v32, v33
    v_cvt_pk_bf16_f32 v145, v34, v35
    v_cvt_pk_bf16_f32 v146, v36, v37
    v_cvt_pk_bf16_f32 v147, v38, v39
    v_permlane16_swap_b32 v140, v142
    v_permlane16_swap_b32 v141, v143
    v_pk_mul_f32 v[40:41], v[40:41], s[68:69] op_sel_hi:[1,0]
    v_pk_mul_f32 v[42:43], v[42:43], s[68:69] op_sel_hi:[1,0]
    v_pk_mul_f32 v[44:45], v[44:45], s[68:69] op_sel_hi:[1,0]
    v_pk_mul_f32 v[46:47], v[46:47], s[68:69] op_sel_hi:[1,0]
    v_permlane16_swap_b32 v144, v146
    v_permlane16_swap_b32 v145, v147
    v_pk_mul_f32 v[48:49], v[48:49], s[68:69] op_sel_hi:[1,0]
    v_pk_mul_f32 v[50:51], v[50:51], s[68:69] op_sel_hi:[1,0]
    v_pk_mul_f32 v[52:53], v[52:53], s[68:69] op_sel_hi:[1,0]
    v_pk_mul_f32 v[54:55], v[54:55], s[68:69] op_sel_hi:[1,0]
    v_pk_mul_f32 v[56:57], v[56:57], s[68:69] op_sel_hi:[1,0]
    v_pk_mul_f32 v[58:59], v[58:59], s[68:69] op_sel_hi:[1,0]
    v_pk_mul_f32 v[60:61], v[60:61], s[68:69] op_sel_hi:[1,0]
    v_pk_mul_f32 v[62:63], v[62:63], s[68:69] op_sel_hi:[1,0]
    s_nop 1
    v_mfma_f32_16x16x32_bf16 v[192:195], v[224:227], v[128:131], 0
    v_cvt_pk_bf16_f32 v148, v40, v41
    v_cvt_pk_bf16_f32 v149, v42, v43
    s_waitcnt lgkmcnt(3)
    ds_read_b128 v[224:227], v248 offset:640
    v_cvt_pk_bf16_f32 v150, v44, v45
    v_mfma_f32_16x16x32_bf16 v[196:199], v[228:231], v[128:131], 0
    v_cvt_pk_bf16_f32 v151, v46, v47
    s_nop 0
    s_waitcnt lgkmcnt(3)
    ds_read_b128 v[228:231], v248 offset:192
    s_nop 0
    v_mfma_f32_16x16x32_bf16 v[192:195], v[232:235], v[132:135], v[192:195]
    v_permlane16_swap_b32 v148, v150
    v_permlane16_swap_b32 v149, v151
    s_waitcnt lgkmcnt(3)
    ds_read_b128 v[232:235], v248 offset:704
    v_cvt_pk_bf16_f32 v152, v48, v49
    v_mfma_f32_16x16x32_bf16 v[196:199], v[236:239], v[132:135], v[196:199]
    v_cvt_pk_bf16_f32 v153, v50, v51
    v_cvt_pk_bf16_f32 v154, v52, v53
    s_waitcnt lgkmcnt(3)
    ds_read_b128 v[236:239], v248 offset:256
    v_cvt_pk_bf16_f32 v155, v54, v55
    v_mfma_f32_16x16x32_bf16 v[192:195], v[240:243], v[136:139], v[192:195]
    s_nop 0
    s_nop 0
    s_waitcnt lgkmcnt(3)
    ds_read_b128 v[240:243], v248 offset:768
    v_permlane16_swap_b32 v152, v154
    v_mfma_f32_16x16x32_bf16 v[196:199], v[224:227], v[136:139], v[196:199]
    v_permlane16_swap_b32 v153, v155
    v_cvt_pk_bf16_f32 v156, v56, v57
    s_waitcnt lgkmcnt(3)
    ds_read_b128 v[224:227], v248 offset:320
    v_cvt_pk_bf16_f32 v157, v58, v59
    v_mfma_f32_16x16x32_bf16 v[192:195], v[228:231], v[140:143], v[192:195]
    v_cvt_pk_bf16_f32 v158, v60, v61
    v_cvt_pk_bf16_f32 v159, v62, v63
    s_waitcnt lgkmcnt(3)
    ds_read_b128 v[228:231], v248 offset:832
    s_nop 0
    v_mfma_f32_16x16x32_bf16 v[196:199], v[232:235], v[140:143], v[196:199]
    s_nop 0
    v_permlane16_swap_b32 v156, v158
    s_waitcnt lgkmcnt(3)
    ds_read_b128 v[232:235], v248 offset:384
    v_permlane16_swap_b32 v157, v159
    v_mfma_f32_16x16x32_bf16 v[192:195], v[236:239], v[144:147], v[192:195]
    s_waitcnt lgkmcnt(3)
    ds_read_b128 v[236:239], v248 offset:896
    v_mfma_f32_16x16x32_bf16 v[196:199], v[240:243], v[144:147], v[196:199]
    s_waitcnt lgkmcnt(3)
    ds_read_b128 v[240:243], v248 offset:448
    ds_read_b128 v[244:247], v248 offset:960
    v_mfma_f32_16x16x32_bf16 v[192:195], v[224:227], v[148:151], v[192:195]
    s_waitcnt lgkmcnt(4)
    v_mfma_f32_16x16x32_bf16 v[196:199], v[228:231], v[148:151], v[196:199]
    s_waitcnt lgkmcnt(3)
    s_waitcnt lgkmcnt(0)
    s_barrier
    v_mfma_f32_16x16x32_bf16 v[192:195], v[232:235], v[152:155], v[192:195]
    ds_read_b128 v[224:227], v248 offset:33792
    ds_read_b128 v[228:231], v248 offset:33856
    v_mfma_f32_16x16x32_bf16 v[196:199], v[236:239], v[152:155], v[196:199]
    ds_read_b128 v[232:235], v248 offset:33920
    ds_read_b128 v[236:239], v248 offset:33984
    v_mfma_f32_16x16x32_bf16 v[192:195], v[240:243], v[156:159], v[192:195]
    ds_read_b128 v[240:243], v248 offset:34048
    v_mfma_f32_16x16x32_bf16 v[196:199], v[244:247], v[156:159], v[196:199]
    s_waitcnt lgkmcnt(4)
    s_cmp_lg_u32 s97, 0
    s_cbranch_scc1 LA_gen1
    v_mfma_f32_16x16x32_bf16 v[208:211], v[224:227], v[128:131], 0
    v_mbcnt_lo_u32_b32 v255, -1, 0
    v_mbcnt_hi_u32_b32 v255, -1, v255
    s_waitcnt lgkmcnt(3)
    ds_read_b128 v[224:227], v248 offset:34112
    v_lshrrev_b32 v252, 2, v255
    v_mfma_f32_16x16x32_bf16 v[208:211], v[228:231], v[132:135], v[208:211]
    v_lshlrev_b32 v252, 7, v252
    v_bfe_u32 v253, v255, 3, 2
    s_waitcnt lgkmcnt(3)
    ds_read_b128 v[228:231], v248 offset:34176
    v_lshl_add_u32 v252, v253, 5, v252
    v_mfma_f32_16x16x32_bf16 v[208:211], v[232:235], v[136:139], v[208:211]
    v_and_b32 v253, 3, v255
    v_lshl_add_u32 v252, v253, 3, v252
    s_waitcnt lgkmcnt(3)
    ds_read_b128 v[232:235], v248 offset:34240
    v_add_u32 v252, 97280, v252
    v_mfma_f32_16x16x32_bf16 v[208:211], v[236:239], v[140:143], v[208:211]
    v_xor_b32 v253, 32, v252
    v_xor_b32 v254, 64, v252
    s_waitcnt lgkmcnt(3)
    ds_read_b128 v[236:239], v248 offset:34304
    v_xor_b32 v255, 0x60, v252
    v_mfma_f32_16x16x32_bf16 v[208:211], v[240:243], v[144:147], v[208:211]
    v_exp_f32 v192, v192
    s_nop 0
    s_waitcnt lgkmcnt(3)
    ds_read_b128 v[240:243], v248 offset:34368
    v_exp_f32 v193, v193
    v_mfma_f32_16x16x32_bf16 v[208:211], v[224:227], v[148:151], v[208:211]
    v_add_f32 v250, v250, v192
    s_waitcnt lgkmcnt(3)
    ds_read_b128 v[224:227], v248 offset:34432
    v_exp_f32 v194, v194
    v_mfma_f32_16x16x32_bf16 v[208:211], v[228:231], v[152:155], v[208:211]
    v_add_f32 v250, v250, v193
    s_waitcnt lgkmcnt(3)
    ds_read_b128 v[228:231], v248 offset:34496
    v_cvt_pk_bf16_f32 v192, v192, v193
    v_mfma_f32_16x16x32_bf16 v[208:211], v[232:235], v[156:159], v[208:211]
    v_exp_f32 v195, v195
    s_nop 0
    s_waitcnt lgkmcnt(3)
    ds_read_b128 v[232:235], v248 offset:34560
    v_add_f32 v250, v250, v194
    v_mfma_f32_16x16x32_bf16 v[212:215], v[236:239], v[128:131], 0
    v_add_f32 v250, v250, v195
    s_waitcnt lgkmcnt(3)
    ds_read_b128 v[236:239], v248 offset:34624
    ds_read_b64_tr_b16 v[244:245], v249 offset:50976
    v_cvt_pk_bf16_f32 v193, v194, v195
    v_mfma_f32_16x16x32_bf16 v[212:215], v[240:243], v[132:135], v[212:215]
    v_exp_f32 v196, v196
    s_nop 0
    s_waitcnt lgkmcnt(4)
    ds_read_b128 v[240:243], v248 offset:34688
    ds_read_b64_tr_b16 v[246:247], v249 offset:51488
    v_exp_f32 v197, v197
    v_mfma_f32_16x16x32_bf16 v[212:215], v[224:227], v[136:139], v[212:215]
    v_add_f32 v250, v250, v196
    s_waitcnt lgkmcnt(5)
    ds_read_b128 v[224:227], v248 offset:34752
    v_exp_f32 v198, v198
    v_mfma_f32_16x16x32_bf16 v[212:215], v[228:231], v[140:143], v[212:215]
    v_add_f32 v250, v250, v197
    s_waitcnt lgkmcnt(5)
    ds_read_b64_tr_b16 v[228:229], v249 offset:50688
    ds_read_b64_tr_b16 v[230:231], v249 offset:51200
    v_cvt_pk_bf16_f32 v194, v196, v197
    v_mfma_f32_16x16x32_bf16 v[212:215], v[232:235], v[144:147], v[212:215]
    v_exp_f32 v199, v199
    s_nop 0
    s_waitcnt lgkmcnt(6)
    ds_read_b64_tr_b16 v[232:233], v249 offset:50720
    ds_read_b64_tr_b16 v[234:235], v249 offset:51232
    v_add_f32 v250, v250, v198
    v_mfma_f32_16x16x32_bf16 v[212:215], v[236:239], v[148:151], v[212:215]
    v_add_f32 v250, v250, v199
    s_waitcnt lgkmcnt(6)
    ds_read_b64_tr_b16 v[236:237], v249 offset:50752
    ds_read_b64_tr_b16 v[238:239], v249 offset:51264
    v_cvt_pk_bf16_f32 v195, v198, v199
    v_mfma_f32_16x16x32_bf16 v[212:215], v[240:243], v[152:155], v[212:215]
    v_exp_f32 v208, v208
    s_nop 0
    s_waitcnt lgkmcnt(6)
    ds_read_b64_tr_b16 v[240:241], v249 offset:50784
    ds_read_b64_tr_b16 v[242:243], v249 offset:51296
    v_mfma_f32_16x16x32_bf16 v[212:215], v[224:227], v[156:159], v[212:215]
    v_add_f32 v250, v250, v208
    s_waitcnt lgkmcnt(6)
    ds_read_b64_tr_b16 v[224:225], v249 offset:50816
    ds_read_b64_tr_b16 v[226:227], v249 offset:51328
    v_mfma_f32_16x16x32_bf16 v[0:3], v[228:231], v[192:195], 0
    v_exp_f32 v209, v209
    s_nop 0
    s_waitcnt lgkmcnt(6)
    ds_read_b64_tr_b16 v[228:229], v249 offset:50848
    ds_read_b64_tr_b16 v[230:231], v249 offset:51360
    v_mfma_f32_16x16x32_bf16 v[4:7], v[232:235], v[192:195], 0
    v_add_f32 v250, v250, v209
    v_cvt_pk_bf16_f32 v208, v208, v209
    s_waitcnt lgkmcnt(6)
    ds_read_b64_tr_b16 v[232:233], v249 offset:50880
    ds_read_b64_tr_b16 v[234:235], v249 offset:51392
    v_mfma_f32_16x16x32_bf16 v[8:11], v[236:239], v[192:195], 0
    v_exp_f32 v210, v210
    s_nop 0
    s_waitcnt lgkmcnt(6)
    ds_read_b64_tr_b16 v[236:237], v249 offset:50912
    ds_read_b64_tr_b16 v[238:239], v249 offset:51424
    v_mfma_f32_16x16x32_bf16 v[12:15], v[240:243], v[192:195], 0
    v_add_f32 v250, v250, v210
    s_waitcnt lgkmcnt(6)
    ds_read_b64_tr_b16 v[240:241], v249 offset:50944
    ds_read_b64_tr_b16 v[242:243], v249 offset:51456
    v_mfma_f32_16x16x32_bf16 v[16:19], v[224:227], v[192:195], 0
    s_mov_b32 s54, 15
    v_exp_f32 v211, v211
    s_nop 0
    s_waitcnt lgkmcnt(6)
    ds_read_b64_tr_b16 v[224:225], v249 offset:51008
    ds_read_b64_tr_b16 v[226:227], v249 offset:51520
    v_mfma_f32_16x16x32_bf16 v[20:23], v[228:231], v[192:195], 0
    s_mov_b32 s55, 67584
    v_add_f32 v250, v250, v211
    v_cvt_pk_bf16_f32 v209, v210, v211
    s_waitcnt lgkmcnt(6)
    ds_read_b64_tr_b16 v[228:229], v249 offset:51040
    ds_read_b64_tr_b16 v[230:231], v249 offset:51552
    v_mfma_f32_16x16x32_bf16 v[24:27], v[232:235], v[192:195], 0
    s_waitcnt lgkmcnt(6)
    ds_read_b64_tr_b16 v[232:233], v249 offset:51072
    ds_read_b64_tr_b16 v[234:235], v249 offset:51584
    v_mfma_f32_16x16x32_bf16 v[28:31], v[236:239], v[192:195], 0
    s_waitcnt lgkmcnt(6)
    ds_read_b64_tr_b16 v[236:237], v249 offset:51104
    ds_read_b64_tr_b16 v[238:239], v249 offset:51616
    v_mfma_f32_16x16x32_bf16 v[32:35], v[240:243], v[192:195], 0
    ds_read_b64_tr_b16 v[240:241], v249 offset:51136
    ds_read_b64_tr_b16 v[242:243], v249 offset:51648
    v_mfma_f32_16x16x32_bf16 v[36:39], v[244:247], v[192:195], 0
    s_waitcnt lgkmcnt(8)
    ds_read_b64_tr_b16 v[244:245], v249 offset:51168
    ds_read_b64_tr_b16 v[246:247], v249 offset:51680
    v_mfma_f32_16x16x32_bf16 v[40:43], v[224:227], v[192:195], 0
    s_waitcnt lgkmcnt(8)
    v_add_u32 v248, 4294899712, v248
    v_add_u32 v249, 4294899712, v249
    v_mfma_f32_16x16x32_bf16 v[44:47], v[228:231], v[192:195], 0
    s_waitcnt lgkmcnt(6)
    s_waitcnt lgkmcnt(0)
    s_barrier
    v_mfma_f32_16x16x32_bf16 v[48:51], v[232:235], v[192:195], 0
    ds_read_b128 v[224:227], v248 offset:0
    ds_read_b128 v[228:231], v248 offset:64
    v_mfma_f32_16x16x32_bf16 v[52:55], v[236:239], v[192:195], 0
    ds_read_b128 v[232:235], v248 offset:128
    ds_read_b128 v[236:239], v248 offset:192
    v_mfma_f32_16x16x32_bf16 v[56:59], v[240:243], v[192:195], 0
    v_exp_f32 v212, v212
    s_nop 0
    ds_read_b128 v[240:243], v248 offset:256
    v_mfma_f32_16x16x32_bf16 v[60:63], v[244:247], v[192:195], 0
    v_add_f32 v250, v250, v212
    s_waitcnt lgkmcnt(4)
    .p2align 3
LA_main1:
    v_mfma_f32_16x16x32_bf16 v[192:195], v[224:227], v[128:131], 0
    v_exp_f32 v213, v213
    s_nop 0
    s_waitcnt lgkmcnt(3)
    ds_read_b128 v[224:227], v248 offset:320
    v_mfma_f32_16x16x32_bf16 v[192:195], v[228:231], v[132:135], v[192:195]
    v_add_f32 v250, v250, v213
    v_cvt_pk_bf16_f32 v210, v212, v213
    s_waitcnt lgkmcnt(3)
    ds_read_b128 v[228:231], v248 offset:384
    v_mfma_f32_16x16x32_bf16 v[192:195], v[232:235], v[136:139], v[192:195]
    v_exp_f32 v214, v214
    s_nop 0
    s_waitcnt lgkmcnt(3)
    ds_read_b128 v[232:235], v248 offset:448
    v_mfma_f32_16x16x32_bf16 v[192:195], v[236:239], v[140:143], v[192:195]
    v_add_f32 v250, v250, v214
    s_waitcnt lgkmcnt(3)
    ds_read_b128 v[236:239], v248 offset:512
    v_mfma_f32_16x16x32_bf16 v[192:195], v[240:243], v[144:147], v[192:195]
    v_exp_f32 v215, v215
    s_nop 0
    s_waitcnt lgkmcnt(3)
    ds_read_b128 v[240:243], v248 offset:576
    v_mfma_f32_16x16x32_bf16 v[192:195], v[224:227], v[148:151], v[192:195]
    v_add_f32 v250, v250, v215
    v_cvt_pk_bf16_f32 v211, v214, v215
    s_waitcnt lgkmcnt(3)
    ds_read_b128 v[224:227], v248 offset:640
    v_mfma_f32_16x16x32_bf16 v[192:195], v[228:231], v[152:155], v[192:195]
    s_waitcnt lgkmcnt(3)
    ds_read_b128 v[228:231], v248 offset:704
    v_mfma_f32_16x16x32_bf16 v[192:195], v[232:235], v[156:159], v[192:195]
    s_waitcnt lgkmcnt(3)
    ds_read_b128 v[232:235], v248 offset:768
    v_mfma_f32_16x16x32_bf16 v[196:199], v[236:239], v[128:131], 0
    s_waitcnt lgkmcnt(3)
    ds_read_b128 v[236:239], v248 offset:832
    ds_read_b64_tr_b16 v[244:245], v249 offset:17184
    v_mfma_f32_16x16x32_bf16 v[196:199], v[240:243], v[132:135], v[196:199]
    s_waitcnt lgkmcnt(4)
    ds_read_b128 v[240:243], v248 offset:896
    ds_read_b64_tr_b16 v[246:247], v249 offset:17696
    v_mfma_f32_16x16x32_bf16 v[196:199], v[224:227], v[136:139], v[196:199]
    s_waitcnt lgkmcnt(5)
    ds_read_b128 v[224:227], v248 offset:960
    v_mfma_f32_16x16x32_bf16 v[196:199], v[228:231], v[140:143], v[196:199]
    s_waitcnt lgkmcnt(5)
    ds_read_b64_tr_b16 v[228:229], v249 offset:16896
    ds_read_b64_tr_b16 v[230:231], v249 offset:17408
    v_mfma_f32_16x16x32_bf16 v[196:199], v[232:235], v[144:147], v[196:199]
    s_waitcnt lgkmcnt(6)
    ds_read_b64_tr_b16 v[232:233], v249 offset:16928
    ds_read_b64_tr_b16 v[234:235], v249 offset:17440
    v_mfma_f32_16x16x32_bf16 v[196:199], v[236:239], v[148:151], v[196:199]
    s_waitcnt lgkmcnt(6)
    ds_read_b64_tr_b16 v[236:237], v249 offset:16960
    ds_read_b64_tr_b16 v[238:239], v249 offset:17472
    v_mfma_f32_16x16x32_bf16 v[196:199], v[240:243], v[152:155], v[196:199]
    v_exp_f32 v192, v192
    s_nop 0
    s_waitcnt lgkmcnt(6)
    ds_read_b64_tr_b16 v[240:241], v249 offset:16992
    ds_read_b64_tr_b16 v[242:243], v249 offset:17504
    v_mfma_f32_16x16x32_bf16 v[196:199], v[224:227], v[156:159], v[196:199]
    v_add_f32 v250, v250, v192
    s_waitcnt lgkmcnt(6)
    ds_read_b64_tr_b16 v[224:225], v249 offset:17024
    ds_read_b64_tr_b16 v[226:227], v249 offset:17536
    v_mfma_f32_16x16x32_bf16 v[0:3], v[228:231], v[208:211], v[0:3]
    v_exp_f32 v193, v193
    s_nop 0
    s_waitcnt lgkmcnt(6)
    ds_read_b64_tr_b16 v[228:229], v249 offset:17056
    ds_read_b64_tr_b16 v[230:231], v249 offset:17568
    v_mfma_f32_16x16x32_bf16 v[4:7], v[232:235], v[208:211], v[4:7]
    v_add_f32 v250, v250, v193
    v_cvt_pk_bf16_f32 v192, v192, v193
    s_waitcnt lgkmcnt(6)
    ds_read_b64_tr_b16 v[232:233], v249 offset:17088
    ds_read_b64_tr_b16 v[234:235], v249 offset:17600
    v_mfma_f32_16x16x32_bf16 v[8:11], v[236:239], v[208:211], v[8:11]
    v_exp_f32 v194, v194
    s_nop 0
    s_waitcnt lgkmcnt(6)
    ds_read_b64_tr_b16 v[236:237], v249 offset:17120
    ds_read_b64_tr_b16 v[238:239], v249 offset:17632
    v_mfma_f32_16x16x32_bf16 v[12:15], v[240:243], v[208:211], v[12:15]
    v_add_f32 v250, v250, v194
    s_waitcnt lgkmcnt(6)
    ds_read_b64_tr_b16 v[240:241], v249 offset:17152
    ds_read_b64_tr_b16 v[242:243], v249 offset:17664
    v_mfma_f32_16x16x32_bf16 v[16:19], v[224:227], v[208:211], v[16:19]
    v_exp_f32 v195, v195
    s_nop 0
    s_waitcnt lgkmcnt(6)
    ds_read_b64_tr_b16 v[224:225], v249 offset:17216
    ds_read_b64_tr_b16 v[226:227], v249 offset:17728
    v_mfma_f32_16x16x32_bf16 v[20:23], v[228:231], v[208:211], v[20:23]
    v_add_f32 v250, v250, v195
    v_cvt_pk_bf16_f32 v193, v194, v195
    s_waitcnt lgkmcnt(6)
    ds_read_b64_tr_b16 v[228:229], v249 offset:17248
    ds_read_b64_tr_b16 v[230:231], v249 offset:17760
    v_mfma_f32_16x16x32_bf16 v[24:27], v[232:235], v[208:211], v[24:27]
    s_waitcnt lgkmcnt(6)
    ds_read_b64_tr_b16 v[232:233], v249 offset:17280
    ds_read_b64_tr_b16 v[234:235], v249 offset:17792
    v_mfma_f32_16x16x32_bf16 v[28:31], v[236:239], v[208:211], v[28:31]
    s_waitcnt lgkmcnt(6)
    ds_read_b64_tr_b16 v[236:237], v249 offset:17312
    ds_read_b64_tr_b16 v[238:239], v249 offset:17824
    v_mfma_f32_16x16x32_bf16 v[32:35], v[240:243], v[208:211], v[32:35]
    ds_read_b64_tr_b16 v[240:241], v249 offset:17344
    ds_read_b64_tr_b16 v[242:243], v249 offset:17856
    v_mfma_f32_16x16x32_bf16 v[36:39], v[244:247], v[208:211], v[36:39]
    s_waitcnt lgkmcnt(8)
    ds_read_b64_tr_b16 v[244:245], v249 offset:17376
    ds_read_b64_tr_b16 v[246:247], v249 offset:17888
    v_mfma_f32_16x16x32_bf16 v[40:43], v[224:227], v[208:211], v[40:43]
    s_waitcnt lgkmcnt(8)
    v_mfma_f32_16x16x32_bf16 v[44:47], v[228:231], v[208:211], v[44:47]
    s_waitcnt lgkmcnt(6)
    s_waitcnt lgkmcnt(0)
    s_barrier
    v_mfma_f32_16x16x32_bf16 v[48:51], v[232:235], v[208:211], v[48:51]
    ds_read_b128 v[224:227], v248 offset:33792
    ds_read_b128 v[228:231], v248 offset:33856
    v_mfma_f32_16x16x32_bf16 v[52:55], v[236:239], v[208:211], v[52:55]
    ds_read_b128 v[232:235], v248 offset:33920
    ds_read_b128 v[236:239], v248 offset:33984
    v_mfma_f32_16x16x32_bf16 v[56:59], v[240:243], v[208:211], v[56:59]
    v_exp_f32 v196, v196
    s_nop 0
    ds_read_b128 v[240:243], v248 offset:34048
    v_mfma_f32_16x16x32_bf16 v[60:63], v[244:247], v[208:211], v[60:63]
    v_add_f32 v250, v250, v196
    s_waitcnt lgkmcnt(4)
    v_mfma_f32_16x16x32_bf16 v[208:211], v[224:227], v[128:131], 0
    v_exp_f32 v197, v197
    s_nop 0
    s_waitcnt lgkmcnt(3)
    ds_read_b128 v[224:227], v248 offset:34112
    v_mfma_f32_16x16x32_bf16 v[208:211], v[228:231], v[132:135], v[208:211]
    v_add_f32 v250, v250, v197
    v_cvt_pk_bf16_f32 v194, v196, v197
    s_waitcnt lgkmcnt(3)
    ds_read_b128 v[228:231], v248 offset:34176
    v_mfma_f32_16x16x32_bf16 v[208:211], v[232:235], v[136:139], v[208:211]
    v_exp_f32 v198, v198
    s_nop 0
    s_waitcnt lgkmcnt(3)
    ds_read_b128 v[232:235], v248 offset:34240
    v_mfma_f32_16x16x32_bf16 v[208:211], v[236:239], v[140:143], v[208:211]
    v_add_f32 v250, v250, v198
    s_waitcnt lgkmcnt(3)
    ds_read_b128 v[236:239], v248 offset:34304
    v_mfma_f32_16x16x32_bf16 v[208:211], v[240:243], v[144:147], v[208:211]
    v_exp_f32 v199, v199
    s_nop 0
    s_waitcnt lgkmcnt(3)
    ds_read_b128 v[240:243], v248 offset:34368
    v_mfma_f32_16x16x32_bf16 v[208:211], v[224:227], v[148:151], v[208:211]
    v_add_f32 v250, v250, v199
    v_cvt_pk_bf16_f32 v195, v198, v199
    s_waitcnt lgkmcnt(3)
    ds_read_b128 v[224:227], v248 offset:34432
    v_mfma_f32_16x16x32_bf16 v[208:211], v[228:231], v[152:155], v[208:211]
    s_waitcnt lgkmcnt(3)
    ds_read_b128 v[228:231], v248 offset:34496
    v_mfma_f32_16x16x32_bf16 v[208:211], v[232:235], v[156:159], v[208:211]
    s_waitcnt lgkmcnt(3)
    ds_read_b128 v[232:235], v248 offset:34560
    v_mfma_f32_16x16x32_bf16 v[212:215], v[236:239], v[128:131], 0
    s_waitcnt lgkmcnt(3)
    ds_read_b128 v[236:239], v248 offset:34624
    ds_read_b64_tr_b16 v[244:245], v249 offset:50976
    v_mfma_f32_16x16x32_bf16 v[212:215], v[240:243], v[132:135], v[212:215]
    s_waitcnt lgkmcnt(4)
    ds_read_b128 v[240:243], v248 offset:34688
    ds_read_b64_tr_b16 v[246:247], v249 offset:51488
    v_mfma_f32_16x16x32_bf16 v[212:215], v[224:227], v[136:139], v[212:215]
    s_waitcnt lgkmcnt(5)
    ds_read_b128 v[224:227], v248 offset:34752
    v_mfma_f32_16x16x32_bf16 v[212:215], v[228:231], v[140:143], v[212:215]
    s_waitcnt lgkmcnt(5)
    ds_read_b64_tr_b16 v[228:229], v249 offset:50688
    ds_read_b64_tr_b16 v[230:231], v249 offset:51200
    v_mfma_f32_16x16x32_bf16 v[212:215], v[232:235], v[144:147], v[212:215]
    s_waitcnt lgkmcnt(6)
    ds_read_b64_tr_b16 v[232:233], v249 offset:50720
    ds_read_b64_tr_b16 v[234:235], v249 offset:51232
    v_mfma_f32_16x16x32_bf16 v[212:215], v[236:239], v[148:151], v[212:215]
    s_waitcnt lgkmcnt(6)
    ds_read_b64_tr_b16 v[236:237], v249 offset:50752
    ds_read_b64_tr_b16 v[238:239], v249 offset:51264
    v_mfma_f32_16x16x32_bf16 v[212:215], v[240:243], v[152:155], v[212:215]
    v_exp_f32 v208, v208
    s_nop 0
    s_waitcnt lgkmcnt(6)
    ds_read_b64_tr_b16 v[240:241], v249 offset:50784
    ds_read_b64_tr_b16 v[242:243], v249 offset:51296
    v_mfma_f32_16x16x32_bf16 v[212:215], v[224:227], v[156:159], v[212:215]
    v_add_f32 v250, v250, v208
    s_waitcnt lgkmcnt(6)
    ds_read_b64_tr_b16 v[224:225], v249 offset:50816
    ds_read_b64_tr_b16 v[226:227], v249 offset:51328
    v_mfma_f32_16x16x32_bf16 v[0:3], v[228:231], v[192:195], v[0:3]
    v_exp_f32 v209, v209
    s_nop 0
    s_waitcnt lgkmcnt(6)
    ds_read_b64_tr_b16 v[228:229], v249 offset:50848
    ds_read_b64_tr_b16 v[230:231], v249 offset:51360
    v_mfma_f32_16x16x32_bf16 v[4:7], v[232:235], v[192:195], v[4:7]
    v_add_f32 v250, v250, v209
    v_cvt_pk_bf16_f32 v208, v208, v209
    s_waitcnt lgkmcnt(6)
    ds_read_b64_tr_b16 v[232:233], v249 offset:50880
    ds_read_b64_tr_b16 v[234:235], v249 offset:51392
    v_mfma_f32_16x16x32_bf16 v[8:11], v[236:239], v[192:195], v[8:11]
    v_exp_f32 v210, v210
    s_nop 0
    s_waitcnt lgkmcnt(6)
    ds_read_b64_tr_b16 v[236:237], v249 offset:50912
    ds_read_b64_tr_b16 v[238:239], v249 offset:51424
    v_mfma_f32_16x16x32_bf16 v[12:15], v[240:243], v[192:195], v[12:15]
    v_add_f32 v250, v250, v210
    s_waitcnt lgkmcnt(6)
    ds_read_b64_tr_b16 v[240:241], v249 offset:50944
    ds_read_b64_tr_b16 v[242:243], v249 offset:51456
    v_mfma_f32_16x16x32_bf16 v[16:19], v[224:227], v[192:195], v[16:19]
    v_exp_f32 v211, v211
    s_nop 0
    s_waitcnt lgkmcnt(6)
    ds_read_b64_tr_b16 v[224:225], v249 offset:51008
    ds_read_b64_tr_b16 v[226:227], v249 offset:51520
    v_mfma_f32_16x16x32_bf16 v[20:23], v[228:231], v[192:195], v[20:23]
    v_add_f32 v250, v250, v211
    v_cvt_pk_bf16_f32 v209, v210, v211
    s_waitcnt lgkmcnt(6)
    ds_read_b64_tr_b16 v[228:229], v249 offset:51040
    ds_read_b64_tr_b16 v[230:231], v249 offset:51552
    v_mfma_f32_16x16x32_bf16 v[24:27], v[232:235], v[192:195], v[24:27]
    s_waitcnt lgkmcnt(6)
    ds_read_b64_tr_b16 v[232:233], v249 offset:51072
    ds_read_b64_tr_b16 v[234:235], v249 offset:51584
    v_mfma_f32_16x16x32_bf16 v[28:31], v[236:239], v[192:195], v[28:31]
    s_waitcnt lgkmcnt(6)
    ds_read_b64_tr_b16 v[236:237], v249 offset:51104
    ds_read_b64_tr_b16 v[238:239], v249 offset:51616
    v_mfma_f32_16x16x32_bf16 v[32:35], v[240:243], v[192:195], v[32:35]
    ds_read_b64_tr_b16 v[240:241], v249 offset:51136
    ds_read_b64_tr_b16 v[242:243], v249 offset:51648
    v_mfma_f32_16x16x32_bf16 v[36:39], v[244:247], v[192:195], v[36:39]
    s_waitcnt lgkmcnt(8)
    ds_read_b64_tr_b16 v[244:245], v249 offset:51168
    ds_read_b64_tr_b16 v[246:247], v249 offset:51680
    v_mfma_f32_16x16x32_bf16 v[40:43], v[224:227], v[192:195], v[40:43]
    s_waitcnt lgkmcnt(8)
    v_add_u32 v248, s55, v248
    v_add_u32 v249, s55, v249
    v_mfma_f32_16x16x32_bf16 v[44:47], v[228:231], v[192:195], v[44:47]
    s_waitcnt lgkmcnt(6)
    s_waitcnt lgkmcnt(0)
    s_barrier
    v_mfma_f32_16x16x32_bf16 v[48:51], v[232:235], v[192:195], v[48:51]
    s_sub_u32 s55, 0, s55
    ds_read_b128 v[224:227], v248 offset:0
    ds_read_b128 v[228:231], v248 offset:64
    v_mfma_f32_16x16x32_bf16 v[52:55], v[236:239], v[192:195], v[52:55]
    s_sub_u32 s54, s54, 1
    ds_read_b128 v[232:235], v248 offset:128
    ds_read_b128 v[236:239], v248 offset:192
    v_mfma_f32_16x16x32_bf16 v[56:59], v[240:243], v[192:195], v[56:59]
    s_cmp_lg_u32 s54, 0
    v_exp_f32 v212, v212
    s_nop 0
    ds_read_b128 v[240:243], v248 offset:256
    v_mfma_f32_16x16x32_bf16 v[60:63], v[244:247], v[192:195], v[60:63]
    v_add_f32 v250, v250, v212
    s_waitcnt lgkmcnt(4)
    s_cbranch_scc1 LA_main1
    ds_read_b64_tr_b16 v[224:225], v249 offset:16896
    ds_read_b64_tr_b16 v[226:227], v249 offset:17408
    ds_read_b64_tr_b16 v[228:229], v249 offset:16928
    ds_read_b64_tr_b16 v[230:231], v249 offset:17440
    ds_read_b64_tr_b16 v[232:233], v249 offset:16960
    ds_read_b64_tr_b16 v[234:235], v249 offset:17472
    ds_read_b64_tr_b16 v[236:237], v249 offset:16992
    ds_read_b64_tr_b16 v[238:239], v249 offset:17504
    ds_read_b64_tr_b16 v[240:241], v249 offset:17024
    ds_read_b64_tr_b16 v[242:243], v249 offset:17536
    v_exp_f32 v213, v213
    v_exp_f32 v214, v214
    v_exp_f32 v215, v215
    v_mbcnt_lo_u32_b32 v194, -1, 0
    v_add_f32 v250, v250, v213
    v_cvt_pk_bf16_f32 v210, v212, v213
    v_add_f32 v250, v250, v214
    v_add_f32 v250, v250, v215
    v_cvt_pk_bf16_f32 v211, v214, v215
LA_join1:
    v_mbcnt_hi_u32_b32 v194, -1, v194
    s_nop 0
    s_waitcnt lgkmcnt(8)
    v_mfma_f32_16x16x32_bf16 v[0:3], v[224:227], v[208:211], v[0:3]
    s_lshl_b32 s51, s44, 2
    v_mov_b32 v192, v250
    v_lshlrev_b32 v248, 4, v194
    s_waitcnt lgkmcnt(6)
    ds_read_b64_tr_b16 v[224:225], v249 offset:17056
    ds_read_b64_tr_b16 v[226:227], v249 offset:17568
    v_mfma_f32_16x16x32_bf16 v[4:7], v[228:231], v[208:211], v[4:7]
    s_add_u32 s51, s51, 0
    v_mov_b32 v195, 64
    v_permlane32_swap_b32 v192, v250
    s_waitcnt lgkmcnt(6)
    ds_read_b64_tr_b16 v[228:229], v249 offset:17088
    ds_read_b64_tr_b16 v[230:231], v249 offset:17600
    v_mfma_f32_16x16x32_bf16 v[8:11], v[232:235], v[208:211], v[8:11]
    s_mov_b32 s52, 0x30800000
    v_add_f32 v250, v250, v192
    s_waitcnt lgkmcnt(6)
    ds_read_b64_tr_b16 v[232:233], v249 offset:17120
    ds_read_b64_tr_b16 v[234:235], v249 offset:17632
    v_mfma_f32_16x16x32_bf16 v[12:15], v[236:239], v[208:211], v[12:15]
    s_lshl_b32 s58, s46, 18
    s_waitcnt lgkmcnt(6)
    ds_read_b64_tr_b16 v[236:237], v249 offset:17152
    ds_read_b64_tr_b16 v[238:239], v249 offset:17664
    v_mfma_f32_16x16x32_bf16 v[16:19], v[240:243], v[208:211], v[16:19]
    s_add_u32 s58, s58, s3
    s_waitcnt lgkmcnt(6)
    ds_read_b64_tr_b16 v[240:241], v249 offset:17184
    ds_read_b64_tr_b16 v[242:243], v249 offset:17696
    v_mfma_f32_16x16x32_bf16 v[20:23], v[224:227], v[208:211], v[20:23]
    s_lshr_b32 s50, s44, 1
    s_waitcnt lgkmcnt(6)
    ds_read_b64_tr_b16 v[224:225], v249 offset:17216
    ds_read_b64_tr_b16 v[226:227], v249 offset:17728
    v_mfma_f32_16x16x32_bf16 v[24:27], v[228:231], v[208:211], v[24:27]
    s_lshl_b32 s50, s50, 14
    v_cvt_pk_bf16_f32 v128, v0, v1
    v_cvt_pk_bf16_f32 v129, v2, v3
    s_waitcnt lgkmcnt(6)
    ds_read_b64_tr_b16 v[228:229], v249 offset:17248
    ds_read_b64_tr_b16 v[230:231], v249 offset:17760
    v_mfma_f32_16x16x32_bf16 v[28:31], v[232:235], v[208:211], v[28:31]
    s_add_u32 s58, s58, s50
    v_cvt_pk_bf16_f32 v130, v4, v5
    v_cvt_pk_bf16_f32 v131, v6, v7
    s_waitcnt lgkmcnt(6)
    ds_read_b64_tr_b16 v[232:233], v249 offset:17280
    ds_read_b64_tr_b16 v[234:235], v249 offset:17792
    v_mfma_f32_16x16x32_bf16 v[32:35], v[236:239], v[208:211], v[32:35]
    s_and_b32 s50, s44, 1
    v_cvt_pk_bf16_f32 v132, v8, v9
    v_cvt_pk_bf16_f32 v133, v10, v11
    s_waitcnt lgkmcnt(6)
    ds_read_b64_tr_b16 v[236:237], v249 offset:17312
    ds_read_b64_tr_b16 v[238:239], v249 offset:17824
    v_mfma_f32_16x16x32_bf16 v[36:39], v[240:243], v[208:211], v[36:39]
    s_lshl_b32 s50, s50, 12
    v_cvt_pk_bf16_f32 v134, v12, v13
    v_cvt_pk_bf16_f32 v135, v14, v15
    s_waitcnt lgkmcnt(6)
    ds_read_b64_tr_b16 v[240:241], v249 offset:17344
    ds_read_b64_tr_b16 v[242:243], v249 offset:17856
    v_mfma_f32_16x16x32_bf16 v[40:43], v[224:227], v[208:211], v[40:43]
    s_add_u32 s58, s58, s50
    ds_read_b64_tr_b16 v[244:245], v249 offset:17376
    ds_read_b64_tr_b16 v[246:247], v249 offset:17888
    s_waitcnt lgkmcnt(8)
    v_cvt_pk_bf16_f32 v136, v16, v17
    v_cvt_pk_bf16_f32 v137, v18, v19
    v_mfma_f32_16x16x32_bf16 v[44:47], v[228:231], v[208:211], v[44:47]
    s_mov_b32 s59, s67
    v_cvt_pk_bf16_f32 v138, v20, v21
    v_cvt_pk_bf16_f32 v139, v22, v23
    s_waitcnt lgkmcnt(6)
    s_waitcnt lgkmcnt(0)
    s_barrier
    v_mfma_f32_16x16x32_bf16 v[48:51], v[232:235], v[208:211], v[48:51]
    s_mov_b32 s56, s67
    ds_read_b64 v[68:69], v195
    ds_read_b64_tr_b16 v[224:225], v252 offset:32768
    ds_read_b64_tr_b16 v[226:227], v252 offset:34816
    ds_read_b64_tr_b16 v[228:229], v253 offset:32768
    v_mfma_f32_16x16x32_bf16 v[52:55], v[236:239], v[208:211], v[52:55]
    ds_read_b64_tr_b16 v[230:231], v253 offset:34816
    ds_read_b64_tr_b16 v[232:233], v252 offset:36864
    ds_read_b64_tr_b16 v[234:235], v252 offset:38912
    ds_read_b64_tr_b16 v[236:237], v253 offset:36864
    v_mfma_f32_16x16x32_bf16 v[56:59], v[240:243], v[208:211], v[56:59]
    ds_read_b64_tr_b16 v[238:239], v253 offset:38912
    v_cvt_pk_bf16_f32 v140, v24, v25
    ds_read_b64_tr_b16 v[240:241], v252 offset:40960
    ds_read_b64_tr_b16 v[242:243], v252 offset:43008
    v_mfma_f32_16x16x32_bf16 v[60:63], v[244:247], v[208:211], v[60:63]
    v_cvt_pk_bf16_f32 v141, v26, v27
    v_cvt_pk_bf16_f32 v142, v28, v29
    s_waitcnt lgkmcnt(8)
    ds_read_b64_tr_b16 v[244:245], v253 offset:40960
    ds_read_b64_tr_b16 v[246:247], v253 offset:43008
    v_readfirstlane_b32 s88, v68
    v_readfirstlane_b32 s89, v69
    v_mfma_f32_16x16x32_bf16 v[192:195], v[224:227], v[128:131], 0
    s_cmp_lt_u32 s46, 8
    v_cvt_pk_bf16_f32 v143, v30, v31
    s_waitcnt lgkmcnt(8)
    ds_read_b64_tr_b16 v[72:73], v252 offset:45056
    v_cvt_pk_bf16_f32 v144, v32, v33
    v_mfma_f32_16x16x32_bf16 v[196:199], v[228:231], v[128:131], 0
    s_cselect_b32 s50, s88, s89
    ds_read_b64_tr_b16 v[74:75], v252 offset:47104
    v_cvt_pk_bf16_f32 v145, v34, v35
    s_waitcnt lgkmcnt(8)
    ds_read_b64_tr_b16 v[76:77], v253 offset:45056
    v_cvt_pk_bf16_f32 v146, v36, v37
    v_mfma_f32_16x16x32_bf16 v[192:195], v[232:235], v[132:135], v[192:195]
    s_add_u32 s58, s58, s50
    ds_read_b64_tr_b16 v[78:79], v253 offset:47104
    v_cvt_pk_bf16_f32 v147, v38, v39
    s_waitcnt lgkmcnt(8)
    ds_read_b64_tr_b16 v[224:225], v252 offset:49152
    v_cvt_pk_bf16_f32 v148, v40, v41
    v_mfma_f32_16x16x32_bf16 v[196:199], v[236:239], v[132:135], v[196:199]
    s_lshl_b32 s63, s59, 15
    ds_read_b64_tr_b16 v[226:227], v252 offset:51200
    v_cvt_pk_bf16_f32 v149, v42, v43
    s_waitcnt lgkmcnt(8)
    ds_read_b64_tr_b16 v[228:229], v253 offset:49152
    v_cvt_pk_bf16_f32 v150, v44, v45
    v_mfma_f32_16x16x32_bf16 v[192:195], v[240:243], v[136:139], v[192:195]
    s_add_u32 s63, s63, s58
    ds_read_b64_tr_b16 v[230:231], v253 offset:51200
    v_cvt_pk_bf16_f32 v151, v46, v47
    s_waitcnt lgkmcnt(8)
    ds_read_b64_tr_b16 v[232:233], v252 offset:53248
    v_cvt_pk_bf16_f32 v152, v48, v49
    v_mfma_f32_16x16x32_bf16 v[196:199], v[244:247], v[136:139], v[196:199]
    s_add_u32 s59, s59, 1
    ds_read_b64_tr_b16 v[234:235], v252 offset:55296
    v_cvt_pk_bf16_f32 v153, v50, v51
    s_waitcnt lgkmcnt(8)
    ds_read_b64_tr_b16 v[236:237], v253 offset:53248
    v_cvt_pk_bf16_f32 v154, v52, v53
    v_mfma_f32_16x16x32_bf16 v[192:195], v[72:75], v[140:143], v[192:195]
    s_cmp_eq_u32 s59, 7
    ds_read_b64_tr_b16 v[238:239], v253 offset:55296
    v_cvt_pk_bf16_f32 v155, v54, v55
    s_waitcnt lgkmcnt(8)
    ds_read_b64_tr_b16 v[240:241], v252 offset:57344
    v_cvt_pk_bf16_f32 v156, v56, v57
    v_mfma_f32_16x16x32_bf16 v[196:199], v[76:79], v[140:143], v[196:199]
    s_cselect_b32 s59, 0, s59
    ds_read_b64_tr_b16 v[242:243], v252 offset:59392
    v_cvt_pk_bf16_f32 v157, v58, v59
    s_waitcnt lgkmcnt(8)
    ds_read_b64_tr_b16 v[244:245], v253 offset:57344
    v_cvt_pk_bf16_f32 v158, v60, v61
    v_mfma_f32_16x16x32_bf16 v[192:195], v[224:227], v[144:147], v[192:195]
    s_lshl_b32 s57, s44, 8
    ds_read_b64_tr_b16 v[246:247], v253 offset:59392
    v_cvt_pk_bf16_f32 v159, v62, v63
    s_waitcnt lgkmcnt(8)
    ds_read_b64_tr_b16 v[72:73], v252 offset:61440
    v_mov_b32 v64, v250
    v_mfma_f32_16x16x32_bf16 v[196:199], v[228:231], v[144:147], v[196:199]
    s_add_u32 s57, s57, s3
    ds_read_b64_tr_b16 v[74:75], v252 offset:63488
    v_mov_b32 v66, 0x4e800000
    s_waitcnt lgkmcnt(8)
    ds_read_b64_tr_b16 v[76:77], v253 offset:61440
    v_mov_b32 v67, s51
    v_mfma_f32_16x16x32_bf16 v[192:195], v[232:235], v[148:151], v[192:195]
    s_add_u32 s57, s57, s88
    ds_read_b64_tr_b16 v[78:79], v253 offset:63488
    v_permlane16_swap_b32 v64, v250
    s_waitcnt lgkmcnt(8)
    ds_read_b64_tr_b16 v[224:225], v254 offset:32768
    v_add_f32 v250, v250, v64
    v_mfma_f32_16x16x32_bf16 v[196:199], v[236:239], v[148:151], v[196:199]
    s_add_u32 s57, s57, 229376
    ds_read_b64_tr_b16 v[226:227], v254 offset:34816
    v_med3_f32 v64, v250, s52, v66
    s_waitcnt lgkmcnt(8)
    ds_read_b64_tr_b16 v[228:229], v255 offset:32768
    v_cmp_neq_f32 vcc, v64, v250
    v_mfma_f32_16x16x32_bf16 v[192:195], v[240:243], v[152:155], v[192:195]
    s_lshl_b32 s62, s46, 1
    ds_read_b64_tr_b16 v[230:231], v255 offset:34816
    v_rcp_f32 v250, v250
    s_nop 0
    s_waitcnt lgkmcnt(8)
    ds_read_b64_tr_b16 v[232:233], v254 offset:36864
    v_mfma_f32_16x16x32_bf16 v[196:199], v[244:247], v[152:155], v[196:199]
    s_and_b32 s62, s62, 24
    ds_read_b64_tr_b16 v[234:235], v254 offset:38912
    s_waitcnt lgkmcnt(8)
    ds_read_b64_tr_b16 v[236:237], v255 offset:36864
    v_mfma_f32_16x16x32_bf16 v[192:195], v[72:75], v[156:159], v[192:195]
    s_lshl_b32 s62, 1, s62
    ds_read_b64_tr_b16 v[238:239], v255 offset:38912
    ds_read_b64_tr_b16 v[240:241], v254 offset:40960
    s_waitcnt lgkmcnt(9)
    ds_read_b64_tr_b16 v[242:243], v254 offset:43008
    ds_read_b64_tr_b16 v[244:245], v255 offset:40960
    v_mfma_f32_16x16x32_bf16 v[196:199], v[76:79], v[156:159], v[196:199]
    s_mov_b32 s54, 3
    ds_read_b64_tr_b16 v[246:247], v255 offset:43008
    s_waitcnt lgkmcnt(10)
    ds_read_b64_tr_b16 v[72:73], v254 offset:45056
    ds_read_b64_tr_b16 v[74:75], v254 offset:47104
    v_mfma_f32_16x16x32_bf16 v[208:211], v[224:227], v[128:131], 0
    s_mov_b32 s55, 67584
    ds_read_b64_tr_b16 v[76:77], v255 offset:45056
    s_waitcnt lgkmcnt(11)
    ds_read_b64_tr_b16 v[78:79], v255 offset:47104
    ds_read_b64_tr_b16 v[224:225], v254 offset:49152
    v_mfma_f32_16x16x32_bf16 v[212:215], v[228:231], v[128:131], 0
    s_cmp_lg_u64 vcc, 0
    ds_read_b64_tr_b16 v[226:227], v254 offset:51200
    s_waitcnt lgkmcnt(12)
    ds_read_b64_tr_b16 v[228:229], v255 offset:49152
    v_mfma_f32_16x16x32_bf16 v[208:211], v[232:235], v[132:135], v[208:211]
    s_cselect_b32 s53, 1, 0
    ds_read_b64_tr_b16 v[230:231], v255 offset:51200
    s_waitcnt lgkmcnt(12)
    ds_read_b64_tr_b16 v[232:233], v254 offset:53248
    v_mul_f32 v192, v250, v192
    v_mfma_f32_16x16x32_bf16 v[212:215], v[236:239], v[132:135], v[212:215]
    s_cmp_eq_u32 s97, 0
    ds_read_b64_tr_b16 v[234:235], v254 offset:55296
    v_mul_f32 v193, v250, v193
    s_waitcnt lgkmcnt(12)
    ds_read_b64_tr_b16 v[236:237], v255 offset:53248
    v_mul_f32 v194, v250, v194
    v_mfma_f32_16x16x32_bf16 v[208:211], v[240:243], v[136:139], v[208:211]
    s_cselect_b32 s53, s53, s97
    ds_read_b64_tr_b16 v[238:239], v255 offset:55296
    v_mul_f32 v195, v250, v195
    s_waitcnt lgkmcnt(12)
    ds_read_b64_tr_b16 v[240:241], v254 offset:57344
    v_mul_f32 v196, v250, v196
    v_mfma_f32_16x16x32_bf16 v[212:215], v[244:247], v[136:139], v[212:215]
    s_and_b32 s53, s53, 1
    ds_read_b64_tr_b16 v[242:243], v254 offset:59392
    v_mul_f32 v197, v250, v197
    s_waitcnt lgkmcnt(12)
    ds_read_b64_tr_b16 v[244:245], v255 offset:57344
    v_mul_f32 v198, v250, v198
    v_mfma_f32_16x16x32_bf16 v[208:211], v[72:75], v[140:143], v[208:211]
    ds_read_b64_tr_b16 v[246:247], v255 offset:59392
    v_mul_f32 v199, v250, v199
    s_waitcnt lgkmcnt(12)
    ds_read_b64_tr_b16 v[72:73], v254 offset:61440
    v_cvt_pk_bf16_f32 v0, v192, v193
    v_mfma_f32_16x16x32_bf16 v[212:215], v[76:79], v[140:143], v[212:215]
    ds_read_b64_tr_b16 v[74:75], v254 offset:63488
    v_mov_b32 v64, s53
    s_waitcnt lgkmcnt(12)
    ds_read_b64_tr_b16 v[76:77], v255 offset:61440
    ds_read_b64_tr_b16 v[78:79], v255 offset:63488
    v_mfma_f32_16x16x32_bf16 v[208:211], v[224:227], v[144:147], v[208:211]
    ds_write_b32 v67, v64
    v_mov_b32 v65, 0
    s_waitcnt lgkmcnt(13)
    v_add_u32 v252, 4294899712, v252
    v_add_u32 v253, 4294899712, v253
    v_mfma_f32_16x16x32_bf16 v[212:215], v[228:231], v[144:147], v[212:215]
    v_add_u32 v254, 4294899712, v254
    v_add_u32 v255, 4294899712, v255
    s_waitcnt lgkmcnt(11)
    v_cvt_pk_bf16_f32 v1, v194, v195
    v_cvt_pk_bf16_f32 v2, v196, v197
    s_waitcnt lgkmcnt(0)
    s_barrier
    v_mfma_f32_16x16x32_bf16 v[208:211], v[232:235], v[148:151], v[208:211]
    ds_read_b128 v[80:83], v65
    ds_read_b64_tr_b16 v[224:225], v252 offset:0
    ds_read_b64_tr_b16 v[226:227], v252 offset:2048
    v_cvt_pk_bf16_f32 v3, v198, v199
    v_mfma_f32_16x16x32_bf16 v[212:215], v[236:239], v[148:151], v[212:215]
    ds_read_b64_tr_b16 v[228:229], v253 offset:0
    buffer_store_dwordx4 v[0:3], v248, s[40:43], s63 offen offset:0 sc0 sc1
    ds_read_b64_tr_b16 v[230:231], v253 offset:2048
    v_mfma_f32_16x16x32_bf16 v[208:211], v[240:243], v[152:155], v[208:211]
    ds_read_b64_tr_b16 v[232:233], v252 offset:4096
    ds_read_b64_tr_b16 v[234:235], v252 offset:6144
    v_mfma_f32_16x16x32_bf16 v[212:215], v[244:247], v[152:155], v[212:215]
    ds_read_b64_tr_b16 v[236:237], v253 offset:4096
    ds_read_b64_tr_b16 v[238:239], v253 offset:6144
    v_mfma_f32_16x16x32_bf16 v[208:211], v[72:75], v[156:159], v[208:211]
    ds_read_b64_tr_b16 v[240:241], v252 offset:8192
    ds_read_b64_tr_b16 v[242:243], v252 offset:10240
    v_mfma_f32_16x16x32_bf16 v[212:215], v[76:79], v[156:159], v[212:215]
    ds_read_b64_tr_b16 v[244:245], v253 offset:8192
    s_waitcnt lgkmcnt(9)
    ds_read_b64_tr_b16 v[246:247], v253 offset:10240
    v_or3_b32 v80, v80, v81, v82
    v_or_b32 v80, v80, v83
    v_cmp_ne_u32 vcc, 0, v80
    v_min_u32 v249, 16, v248
    v_mul_u32_u24 v249, 0x700000, v249
    v_lshlrev_b32 v249, 4, v249
    v_mov_b32 v66, s62
    s_cbranch_vccnz LA_redo1
    .p2align 3
LA_op1:
    v_mfma_f32_16x16x32_bf16 v[192:195], v[224:227], v[128:131], 0
    s_lshl_b32 s64, s59, 15
    s_waitcnt lgkmcnt(8)
    ds_read_b64_tr_b16 v[72:73], v252 offset:12288
    v_mfma_f32_16x16x32_bf16 v[196:199], v[228:231], v[128:131], 0
    s_add_u32 s64, s64, s58
    ds_read_b64_tr_b16 v[74:75], v252 offset:14336
    s_waitcnt lgkmcnt(8)
    ds_read_b64_tr_b16 v[76:77], v253 offset:12288
    v_mul_f32 v208, v250, v208
    v_mfma_f32_16x16x32_bf16 v[192:195], v[232:235], v[132:135], v[192:195]
    s_add_u32 s59, s59, 1
    ds_read_b64_tr_b16 v[78:79], v253 offset:14336
    v_mul_f32 v209, v250, v209
    s_waitcnt lgkmcnt(8)
    ds_read_b64_tr_b16 v[224:225], v252 offset:16384
    v_mul_f32 v210, v250, v210
    v_mfma_f32_16x16x32_bf16 v[196:199], v[236:239], v[132:135], v[196:199]
    s_cmp_eq_u32 s59, 7
    ds_read_b64_tr_b16 v[226:227], v252 offset:18432
    v_mul_f32 v211, v250, v211
    s_waitcnt lgkmcnt(8)
    ds_read_b64_tr_b16 v[228:229], v253 offset:16384
    v_mul_f32 v212, v250, v212
    v_mfma_f32_16x16x32_bf16 v[192:195], v[240:243], v[136:139], v[192:195]
    s_cselect_b32 s59, 0, s59
    ds_read_b64_tr_b16 v[230:231], v253 offset:18432
    v_mul_f32 v213, v250, v213
    s_waitcnt lgkmcnt(8)
    ds_read_b64_tr_b16 v[232:233], v252 offset:20480
    v_mul_f32 v214, v250, v214
    v_mfma_f32_16x16x32_bf16 v[196:199], v[244:247], v[136:139], v[196:199]
    s_mul_i32 s51, s56, 1024
    ds_read_b64_tr_b16 v[234:235], v252 offset:22528
    v_mul_f32 v215, v250, v215
    s_waitcnt lgkmcnt(8)
    ds_read_b64_tr_b16 v[236:237], v253 offset:20480
    v_cvt_pk_bf16_f32 v8, v208, v209
    v_mfma_f32_16x16x32_bf16 v[192:195], v[72:75], v[140:143], v[192:195]
    s_add_u32 s51, s51, s57
    ds_read_b64_tr_b16 v[238:239], v253 offset:22528
    v_cvt_pk_bf16_f32 v9, v210, v211
    s_waitcnt lgkmcnt(8)
    ds_read_b64_tr_b16 v[240:241], v252 offset:24576
    v_cvt_pk_bf16_f32 v10, v212, v213
    v_mfma_f32_16x16x32_bf16 v[196:199], v[76:79], v[140:143], v[196:199]
    s_add_u32 s52, s56, 1
    ds_read_b64_tr_b16 v[242:243], v252 offset:26624
    v_cvt_pk_bf16_f32 v11, v214, v215
    s_waitcnt lgkmcnt(8)
    ds_read_b64_tr_b16 v[244:245], v253 offset:24576
    buffer_store_dwordx4 v[8:11], v248, s[40:43], s63 offen offset:1024 sc0 sc1
    v_mfma_f32_16x16x32_bf16 v[192:195], v[224:227], v[144:147], v[192:195]
    s_cmp_eq_u32 s52, 7
    ds_read_b64_tr_b16 v[246:247], v253 offset:26624
    s_waitcnt lgkmcnt(8)
    ds_read_b64_tr_b16 v[72:73], v252 offset:28672
    v_mfma_f32_16x16x32_bf16 v[196:199], v[228:231], v[144:147], v[196:199]
    s_cselect_b32 s52, 0, s52
    ds_read_b64_tr_b16 v[74:75], v252 offset:30720
    s_waitcnt lgkmcnt(8)
    ds_read_b64_tr_b16 v[76:77], v253 offset:28672
    v_mfma_f32_16x16x32_bf16 v[192:195], v[232:235], v[148:151], v[192:195]
    s_cmp_eq_u32 s54, 3
    ds_read_b64_tr_b16 v[78:79], v253 offset:30720
    s_waitcnt lgkmcnt(8)
    ds_read_b64_tr_b16 v[224:225], v254 offset:0
    v_mfma_f32_16x16x32_bf16 v[196:199], v[236:239], v[148:151], v[196:199]
    s_cselect_b32 s51, 0x7ff00000, s51
    ds_read_b64_tr_b16 v[226:227], v254 offset:2048
    s_waitcnt lgkmcnt(8)
    ds_read_b64_tr_b16 v[228:229], v255 offset:0
    v_mfma_f32_16x16x32_bf16 v[192:195], v[240:243], v[152:155], v[192:195]
    s_cselect_b32 s56, s56, s52
    ds_read_b64_tr_b16 v[230:231], v255 offset:2048
    s_waitcnt lgkmcnt(8)
    ds_read_b64_tr_b16 v[232:233], v254 offset:4096
    v_mfma_f32_16x16x32_bf16 v[196:199], v[244:247], v[152:155], v[196:199]
    ds_read_b64_tr_b16 v[234:235], v254 offset:6144
    s_waitcnt lgkmcnt(8)
    ds_read_b64_tr_b16 v[236:237], v255 offset:4096
    v_mfma_f32_16x16x32_bf16 v[192:195], v[72:75], v[156:159], v[192:195]
    ds_read_b64_tr_b16 v[238:239], v255 offset:6144
    ds_read_b64_tr_b16 v[240:241], v254 offset:8192
    s_waitcnt lgkmcnt(9)
    ds_read_b64_tr_b16 v[242:243], v254 offset:10240
    ds_read_b64_tr_b16 v[244:245], v255 offset:8192
    v_mfma_f32_16x16x32_bf16 v[196:199], v[76:79], v[156:159], v[196:199]
    ds_read_b64_tr_b16 v[246:247], v255 offset:10240
    s_waitcnt lgkmcnt(10)
    ds_read_b64_tr_b16 v[72:73], v254 offset:12288
    ds_read_b64_tr_b16 v[74:75], v254 offset:14336
    v_mfma_f32_16x16x32_bf16 v[208:211], v[224:227], v[128:131], 0
    ds_read_b128 v[80:83], v65 offset:32
    ds_read_b64_tr_b16 v[76:77], v255 offset:12288
    s_waitcnt lgkmcnt(12)
    ds_read_b64_tr_b16 v[78:79], v255 offset:14336
    ds_read_b64_tr_b16 v[224:225], v254 offset:16384
    v_mfma_f32_16x16x32_bf16 v[212:215], v[228:231], v[128:131], 0
    ds_read_b64_tr_b16 v[226:227], v254 offset:18432
    s_waitcnt lgkmcnt(13)
    ds_read_b64_tr_b16 v[228:229], v255 offset:16384
    v_mfma_f32_16x16x32_bf16 v[208:211], v[232:235], v[132:135], v[208:211]
    ds_read_b64_tr_b16 v[230:231], v255 offset:18432
    s_waitcnt lgkmcnt(13)
    ds_read_b64_tr_b16 v[232:233], v254 offset:20480
    v_mul_f32 v192, v250, v192
    v_mfma_f32_16x16x32_bf16 v[212:215], v[236:239], v[132:135], v[212:215]
    ds_read_b64_tr_b16 v[234:235], v254 offset:22528
    v_mul_f32 v193, v250, v193
    s_waitcnt lgkmcnt(13)
    ds_read_b64_tr_b16 v[236:237], v255 offset:20480
    v_mul_f32 v194, v250, v194
    v_mfma_f32_16x16x32_bf16 v[208:211], v[240:243], v[136:139], v[208:211]
    ds_read_b64_tr_b16 v[238:239], v255 offset:22528
    v_mul_f32 v195, v250, v195
    s_waitcnt lgkmcnt(13)
    ds_read_b64_tr_b16 v[240:241], v254 offset:24576
    v_mul_f32 v196, v250, v196
    v_mfma_f32_16x16x32_bf16 v[212:215], v[244:247], v[136:139], v[212:215]
    ds_read_b64_tr_b16 v[242:243], v254 offset:26624
    v_mul_f32 v197, v250, v197
    s_waitcnt lgkmcnt(13)
    ds_read_b64_tr_b16 v[244:245], v255 offset:24576
    v_mul_f32 v198, v250, v198
    v_mfma_f32_16x16x32_bf16 v[208:211], v[72:75], v[140:143], v[208:211]
    ds_read_b64_tr_b16 v[246:247], v255 offset:26624
    v_mul_f32 v199, v250, v199
    s_waitcnt lgkmcnt(12)
    ds_read_b64_tr_b16 v[72:73], v254 offset:28672
    v_cvt_pk_bf16_f32 v16, v192, v193
    v_mfma_f32_16x16x32_bf16 v[212:215], v[76:79], v[140:143], v[212:215]
    ds_read_b64_tr_b16 v[74:75], v254 offset:30720
    v_cvt_pk_bf16_f32 v17, v194, v195
    s_waitcnt lgkmcnt(12)
    ds_read_b64_tr_b16 v[76:77], v255 offset:28672
    ds_read_b64_tr_b16 v[78:79], v255 offset:30720
    v_mfma_f32_16x16x32_bf16 v[208:211], v[224:227], v[144:147], v[208:211]
    v_cvt_pk_bf16_f32 v18, v196, v197
    v_cvt_pk_bf16_f32 v19, v198, v199
    s_waitcnt lgkmcnt(12)
    buffer_store_dwordx4 v[16:19], v248, s[40:43], s64 offen offset:0 sc0 sc1
    v_mfma_f32_16x16x32_bf16 v[212:215], v[228:231], v[144:147], v[212:215]
    s_cmp_lt_u32 s54, 2
    s_waitcnt lgkmcnt(10)
    s_waitcnt lgkmcnt(0)
    s_cbranch_scc1 LA_lw1
    s_barrier
LA_lr1:
    v_mfma_f32_16x16x32_bf16 v[208:211], v[232:235], v[148:151], v[208:211]
    ds_read_b64_tr_b16 v[224:225], v252 offset:32768
    ds_read_b64_tr_b16 v[226:227], v252 offset:34816
    v_mfma_f32_16x16x32_bf16 v[212:215], v[236:239], v[148:151], v[212:215]
    ds_read_b64_tr_b16 v[228:229], v253 offset:32768
    ds_read_b64_tr_b16 v[230:231], v253 offset:34816
    v_mfma_f32_16x16x32_bf16 v[208:211], v[240:243], v[152:155], v[208:211]
    ds_read_b64_tr_b16 v[232:233], v252 offset:36864
    ds_read_b64_tr_b16 v[234:235], v252 offset:38912
    v_mfma_f32_16x16x32_bf16 v[212:215], v[244:247], v[152:155], v[212:215]
    ds_read_b64_tr_b16 v[236:237], v253 offset:36864
    ds_read_b64_tr_b16 v[238:239], v253 offset:38912
    v_mfma_f32_16x16x32_bf16 v[208:211], v[72:75], v[156:159], v[208:211]
    ds_read_b64_tr_b16 v[240:241], v252 offset:40960
    ds_read_b64_tr_b16 v[242:243], v252 offset:43008
    v_mfma_f32_16x16x32_bf16 v[212:215], v[76:79], v[156:159], v[212:215]
    s_waitcnt vmcnt(4)
    buffer_atomic_add v66, v249, s[40:43], s51 offen sc1
    s_waitcnt lgkmcnt(8)
    ds_read_b64_tr_b16 v[244:245], v253 offset:40960
    ds_read_b64_tr_b16 v[246:247], v253 offset:43008
    v_mfma_f32_16x16x32_bf16 v[192:195], v[224:227], v[128:131], 0
    s_lshl_b32 s63, s59, 15
    s_waitcnt lgkmcnt(8)
    ds_read_b64_tr_b16 v[72:73], v252 offset:45056
    v_mfma_f32_16x16x32_bf16 v[196:199], v[228:231], v[128:131], 0
    s_add_u32 s63, s63, s58
    ds_read_b64_tr_b16 v[74:75], v252 offset:47104
    s_waitcnt lgkmcnt(8)
    ds_read_b64_tr_b16 v[76:77], v253 offset:45056
    v_mul_f32 v208, v250, v208
    v_mfma_f32_16x16x32_bf16 v[192:195], v[232:235], v[132:135], v[192:195]
    s_add_u32 s59, s59, 1
    ds_read_b64_tr_b16 v[78:79], v253 offset:47104
    v_mul_f32 v209, v250, v209
    s_waitcnt lgkmcnt(8)
    ds_read_b64_tr_b16 v[224:225], v252 offset:49152
    v_mul_f32 v210, v250, v210
    v_mfma_f32_16x16x32_bf16 v[196:199], v[236:239], v[132:135], v[196:199]
    s_cmp_eq_u32 s59, 7
    ds_read_b64_tr_b16 v[226:227], v252 offset:51200
    v_mul_f32 v211, v250, v211
    s_waitcnt lgkmcnt(8)
    ds_read_b64_tr_b16 v[228:229], v253 offset:49152
    v_mul_f32 v212, v250, v212
    v_mfma_f32_16x16x32_bf16 v[192:195], v[240:243], v[136:139], v[192:195]
    s_cselect_b32 s59, 0, s59
    ds_read_b64_tr_b16 v[230:231], v253 offset:51200
    v_mul_f32 v213, v250, v213
    s_waitcnt lgkmcnt(8)
    ds_read_b64_tr_b16 v[232:233], v252 offset:53248
    v_mul_f32 v214, v250, v214
    v_mfma_f32_16x16x32_bf16 v[196:199], v[244:247], v[136:139], v[196:199]
    s_mul_i32 s51, s56, 1024
    ds_read_b64_tr_b16 v[234:235], v252 offset:55296
    v_mul_f32 v215, v250, v215
    s_waitcnt lgkmcnt(8)
    ds_read_b64_tr_b16 v[236:237], v253 offset:53248
    v_cvt_pk_bf16_f32 v24, v208, v209
    v_mfma_f32_16x16x32_bf16 v[192:195], v[72:75], v[140:143], v[192:195]
    s_add_u32 s51, s51, s57
    ds_read_b64_tr_b16 v[238:239], v253 offset:55296
    v_cvt_pk_bf16_f32 v25, v210, v211
    s_waitcnt lgkmcnt(8)
    ds_read_b64_tr_b16 v[240:241], v252 offset:57344
    v_cvt_pk_bf16_f32 v26, v212, v213
    v_mfma_f32_16x16x32_bf16 v[196:199], v[76:79], v[140:143], v[196:199]
    s_add_u32 s56, s56, 1
    ds_read_b64_tr_b16 v[242:243], v252 offset:59392
    v_cvt_pk_bf16_f32 v27, v214, v215
    s_waitcnt lgkmcnt(8)
    ds_read_b64_tr_b16 v[244:245], v253 offset:57344
    buffer_store_dwordx4 v[24:27], v248, s[40:43], s64 offen offset:1024 sc0 sc1
    v_mfma_f32_16x16x32_bf16 v[192:195], v[224:227], v[144:147], v[192:195]
    s_cmp_eq_u32 s56, 7
    ds_read_b64_tr_b16 v[246:247], v253 offset:59392
    s_waitcnt lgkmcnt(8)
    ds_read_b64_tr_b16 v[72:73], v252 offset:61440
    v_mfma_f32_16x16x32_bf16 v[196:199], v[228:231], v[144:147], v[196:199]
    s_cselect_b32 s56, 0, s56
    ds_read_b64_tr_b16 v[74:75], v252 offset:63488
    s_waitcnt lgkmcnt(8)
    ds_read_b64_tr_b16 v[76:77], v253 offset:61440
    v_mfma_f32_16x16x32_bf16 v[192:195], v[232:235], v[148:151], v[192:195]
    ds_read_b64_tr_b16 v[78:79], v253 offset:63488
    s_waitcnt lgkmcnt(8)
    ds_read_b64_tr_b16 v[224:225], v254 offset:32768
    v_mfma_f32_16x16x32_bf16 v[196:199], v[236:239], v[148:151], v[196:199]
    ds_read_b64_tr_b16 v[226:227], v254 offset:34816
    s_waitcnt lgkmcnt(8)
    ds_read_b64_tr_b16 v[228:229], v255 offset:32768
    v_mfma_f32_16x16x32_bf16 v[192:195], v[240:243], v[152:155], v[192:195]
    ds_read_b64_tr_b16 v[230:231], v255 offset:34816
    s_waitcnt lgkmcnt(8)
    ds_read_b64_tr_b16 v[232:233], v254 offset:36864
    v_mfma_f32_16x16x32_bf16 v[196:199], v[244:247], v[152:155], v[196:199]
    ds_read_b64_tr_b16 v[234:235], v254 offset:38912
    s_waitcnt lgkmcnt(8)
    ds_read_b64_tr_b16 v[236:237], v255 offset:36864
    v_mfma_f32_16x16x32_bf16 v[192:195], v[72:75], v[156:159], v[192:195]
    ds_read_b64_tr_b16 v[238:239], v255 offset:38912
    ds_read_b64_tr_b16 v[240:241], v254 offset:40960
    s_waitcnt lgkmcnt(9)
    ds_read_b64_tr_b16 v[242:243], v254 offset:43008
    ds_read_b64_tr_b16 v[244:245], v255 offset:40960
    v_mfma_f32_16x16x32_bf16 v[196:199], v[76:79], v[156:159], v[196:199]
    ds_read_b64_tr_b16 v[246:247], v255 offset:43008
    s_waitcnt lgkmcnt(10)
    ds_read_b64_tr_b16 v[72:73], v254 offset:45056
    ds_read_b64_tr_b16 v[74:75], v254 offset:47104
    v_mfma_f32_16x16x32_bf16 v[208:211], v[224:227], v[128:131], 0
    ds_read_b64_tr_b16 v[76:77], v255 offset:45056
    s_waitcnt lgkmcnt(11)
    ds_read_b64_tr_b16 v[78:79], v255 offset:47104
    ds_read_b64_tr_b16 v[224:225], v254 offset:49152
    v_mfma_f32_16x16x32_bf16 v[212:215], v[228:231], v[128:131], 0
    ds_read_b64_tr_b16 v[226:227], v254 offset:51200
    s_waitcnt lgkmcnt(12)
    ds_read_b64_tr_b16 v[228:229], v255 offset:49152
    v_mfma_f32_16x16x32_bf16 v[208:211], v[232:235], v[132:135], v[208:211]
    ds_read_b64_tr_b16 v[230:231], v255 offset:51200
    s_waitcnt lgkmcnt(12)
    ds_read_b64_tr_b16 v[232:233], v254 offset:53248
    v_mul_f32 v192, v250, v192
    v_mfma_f32_16x16x32_bf16 v[212:215], v[236:239], v[132:135], v[212:215]
    ds_read_b64_tr_b16 v[234:235], v254 offset:55296
    v_mul_f32 v193, v250, v193
    s_waitcnt lgkmcnt(12)
    ds_read_b64_tr_b16 v[236:237], v255 offset:53248
    v_mul_f32 v194, v250, v194
    v_mfma_f32_16x16x32_bf16 v[208:211], v[240:243], v[136:139], v[208:211]
    ds_read_b64_tr_b16 v[238:239], v255 offset:55296
    v_mul_f32 v195, v250, v195
    s_waitcnt lgkmcnt(12)
    ds_read_b64_tr_b16 v[240:241], v254 offset:57344
    v_mul_f32 v196, v250, v196
    v_mfma_f32_16x16x32_bf16 v[212:215], v[244:247], v[136:139], v[212:215]
    ds_read_b64_tr_b16 v[242:243], v254 offset:59392
    v_mul_f32 v197, v250, v197
    s_waitcnt lgkmcnt(12)
    ds_read_b64_tr_b16 v[244:245], v255 offset:57344
    v_mul_f32 v198, v250, v198
    v_mfma_f32_16x16x32_bf16 v[208:211], v[72:75], v[140:143], v[208:211]
    ds_read_b64_tr_b16 v[246:247], v255 offset:59392
    v_mul_f32 v199, v250, v199
    s_waitcnt lgkmcnt(12)
    ds_read_b64_tr_b16 v[72:73], v254 offset:61440
    v_cvt_pk_bf16_f32 v0, v192, v193
    v_mfma_f32_16x16x32_bf16 v[212:215], v[76:79], v[140:143], v[212:215]
    ds_read_b64_tr_b16 v[74:75], v254 offset:63488
    v_cvt_pk_bf16_f32 v1, v194, v195
    s_waitcnt lgkmcnt(12)
    ds_read_b64_tr_b16 v[76:77], v255 offset:61440
    ds_read_b64_tr_b16 v[78:79], v255 offset:63488
    v_mfma_f32_16x16x32_bf16 v[208:211], v[224:227], v[144:147], v[208:211]
    v_cvt_pk_bf16_f32 v2, v196, v197
    v_cvt_pk_bf16_f32 v3, v198, v199
    s_waitcnt lgkmcnt(12)
    v_add_u32 v252, s55, v252
    v_add_u32 v253, s55, v253
    v_mfma_f32_16x16x32_bf16 v[212:215], v[228:231], v[144:147], v[212:215]
    s_cmp_eq_u32 s54, 3
    v_add_u32 v254, s55, v254
    v_add_u32 v255, s55, v255
    s_waitcnt lgkmcnt(10)
    buffer_store_dwordx4 v[0:3], v248, s[40:43], s63 offen offset:0 sc0 sc1
    s_cbranch_scc1 LA_b21
LA_b2r1:
    v_mfma_f32_16x16x32_bf16 v[208:211], v[232:235], v[148:151], v[208:211]
    ds_read_b64_tr_b16 v[224:225], v252 offset:0
    s_waitcnt lgkmcnt(9)
    ds_read_b64_tr_b16 v[226:227], v252 offset:2048
    v_mfma_f32_16x16x32_bf16 v[212:215], v[236:239], v[148:151], v[212:215]
    s_sub_u32 s55, 0, s55
    ds_read_b64_tr_b16 v[228:229], v253 offset:0
    s_waitcnt lgkmcnt(9)
    ds_read_b64_tr_b16 v[230:231], v253 offset:2048
    v_mfma_f32_16x16x32_bf16 v[208:211], v[240:243], v[152:155], v[208:211]
    s_sub_u32 s54, s54, 1
    ds_read_b64_tr_b16 v[232:233], v252 offset:4096
    s_waitcnt lgkmcnt(9)
    ds_read_b64_tr_b16 v[234:235], v252 offset:6144
    v_mfma_f32_16x16x32_bf16 v[212:215], v[244:247], v[152:155], v[212:215]
    s_cmp_lg_u32 s54, 0
    ds_read_b64_tr_b16 v[236:237], v253 offset:4096
    s_waitcnt lgkmcnt(9)
    ds_read_b64_tr_b16 v[238:239], v253 offset:6144
    v_mfma_f32_16x16x32_bf16 v[208:211], v[72:75], v[156:159], v[208:211]
    ds_read_b64_tr_b16 v[240:241], v252 offset:8192
    s_waitcnt lgkmcnt(9)
    ds_read_b64_tr_b16 v[242:243], v252 offset:10240
    v_mfma_f32_16x16x32_bf16 v[212:215], v[76:79], v[156:159], v[212:215]
    s_waitcnt vmcnt(4)
    buffer_atomic_add v66, v249, s[40:43], s51 offen sc1
    s_waitcnt lgkmcnt(8)
    ds_read_b64_tr_b16 v[244:245], v253 offset:8192
    ds_read_b64_tr_b16 v[246:247], v253 offset:10240
    s_cbranch_scc1 LA_op1
    s_nop 1
    s_add_u32 s52, s3, s88
    s_add_u32 s52, s52, 236800
    v_mov_b32 v84, 1
    buffer_atomic_add v84, v249, s[40:43], s52 offen sc0 sc1
    s_nop 1
    v_pk_mul_f32 v[208:209], v[208:209], v[250:251] op_sel:[0,0] op_sel_hi:[1,0]
    v_pk_mul_f32 v[210:211], v[210:211], v[250:251] op_sel:[0,0] op_sel_hi:[1,0]
    v_pk_mul_f32 v[212:213], v[212:213], v[250:251] op_sel:[0,0] op_sel_hi:[1,0]
    v_pk_mul_f32 v[214:215], v[214:215], v[250:251] op_sel:[0,0] op_sel_hi:[1,0]
    v_cvt_pk_bf16_f32 v8, v208, v209
    v_cvt_pk_bf16_f32 v9, v210, v211
    v_cvt_pk_bf16_f32 v10, v212, v213
    v_cvt_pk_bf16_f32 v11, v214, v215
    buffer_store_dwordx4 v[8:11], v248, s[40:43], s63 offen offset:1024 sc0 sc1
    s_mul_i32 s51, s56, 1024
    s_add_u32 s51, s51, s57
    s_add_u32 s56, s56, 1
    s_cmp_eq_u32 s56, 7
    s_cselect_b32 s56, 0, s56
    s_waitcnt vmcnt(3)
    buffer_atomic_add v66, v249, s[40:43], s51 offen sc1
    s_mul_i32 s51, s56, 1024
    s_add_u32 s51, s51, s57
    s_add_u32 s56, s56, 1
    s_cmp_eq_u32 s56, 7
    s_cselect_b32 s56, 0, s56
    s_waitcnt vmcnt(1)
    buffer_atomic_add v66, v249, s[40:43], s51 offen sc1
    s_waitcnt vmcnt(0) lgkmcnt(0)
    v_readfirstlane_b32 s54, v84
    s_mov_b64 exec, -1
    v_mbcnt_lo_u32_b32 v0, -1, 0
    v_mbcnt_hi_u32_b32 v0, -1, v0
    s_add_u32 s54, s54, 42
    s_cmp_lt_u32 s54, 98
    s_cbranch_scc1 LA_rsetup
    s_endpgm
LA_lw21:
    ds_read_b128 v[80:83], v65 offset:32
    s_waitcnt lgkmcnt(0)
LA_lw1:
    v_min3_u32 v80, v80, v81, v82
    v_min_u32 v80, v80, v83
    v_cmp_eq_u32 vcc, 0, v80
    s_cbranch_vccnz LA_lw21
    s_branch LA_lr1
LA_b21:
    s_waitcnt lgkmcnt(0)
    s_barrier
    s_branch LA_b2r1
LA_endoftext:
LA_redo2:
    s_waitcnt vmcnt(0) lgkmcnt(0)
    s_barrier
    s_add_u32 s97, s97, 1
    s_branch LA_crestart
LA_gen2:
    v_mbcnt_lo_u32_b32 v254, -1, 0
    v_mbcnt_hi_u32_b32 v254, -1, v254
    s_lshl_b32 s50, s44, 9
    s_add_u32 s50, s50, 256
    v_lshl_add_u32 v254, v254, 3, s50
    ds_read_b64 v[252:253], v254
    s_waitcnt lgkmcnt(0)
    v_mov_b32 v254, 0xff800000
    v_mov_b32 v255, 0xff800000
    s_cmp_eq_u32 s97, 2
    s_cbranch_scc1 LA_gen22
    v_mov_b64 v[252:253], 0
LA_gen22:
    v_mfma_f32_16x16x32_bf16 v[208:211], v[224:227], v[128:131], 0
    v_mfma_f32_16x16x32_bf16 v[216:219], v[224:227], v[160:163], 0
    s_waitcnt lgkmcnt(3)
    ds_read_b128 v[224:227], v248 offset:34112
    v_mfma_f32_16x16x32_bf16 v[208:211], v[228:231], v[132:135], v[208:211]
    v_mfma_f32_16x16x32_bf16 v[216:219], v[228:231], v[164:167], v[216:219]
    s_waitcnt lgkmcnt(3)
    ds_read_b128 v[228:231], v248 offset:34176
    v_mfma_f32_16x16x32_bf16 v[208:211], v[232:235], v[136:139], v[208:211]
    v_max_f32 v254, v254, v192
    v_add_f32 v192, v252, v192
    v_exp_f32 v192, v192
    v_mfma_f32_16x16x32_bf16 v[216:219], v[232:235], v[168:171], v[216:219]
    s_waitcnt lgkmcnt(3)
    ds_read_b128 v[232:235], v248 offset:34240
    v_max_f32 v254, v254, v193
    v_add_f32 v193, v252, v193
    v_exp_f32 v193, v193
    v_mfma_f32_16x16x32_bf16 v[208:211], v[236:239], v[140:143], v[208:211]
    v_add_f32 v250, v250, v192
    v_max_f32 v254, v254, v194
    v_add_f32 v194, v252, v194
    v_mfma_f32_16x16x32_bf16 v[216:219], v[236:239], v[172:175], v[216:219]
    s_waitcnt lgkmcnt(3)
    ds_read_b128 v[236:239], v248 offset:34304
    v_exp_f32 v194, v194
    v_add_f32 v250, v250, v193
    v_cvt_pk_bf16_f32 v192, v192, v193
    v_mfma_f32_16x16x32_bf16 v[208:211], v[240:243], v[144:147], v[208:211]
    v_max_f32 v254, v254, v195
    v_add_f32 v195, v252, v195
    v_exp_f32 v195, v195
    v_mfma_f32_16x16x32_bf16 v[216:219], v[240:243], v[176:179], v[216:219]
    s_waitcnt lgkmcnt(3)
    ds_read_b128 v[240:243], v248 offset:34368
    v_add_f32 v250, v250, v194
    v_max_f32 v255, v255, v200
    v_add_f32 v200, v253, v200
    v_mfma_f32_16x16x32_bf16 v[208:211], v[224:227], v[148:151], v[208:211]
    v_exp_f32 v200, v200
    v_add_f32 v250, v250, v195
    v_cvt_pk_bf16_f32 v193, v194, v195
    v_mfma_f32_16x16x32_bf16 v[216:219], v[224:227], v[180:183], v[216:219]
    s_waitcnt lgkmcnt(3)
    ds_read_b128 v[224:227], v248 offset:34432
    v_max_f32 v255, v255, v201
    v_add_f32 v201, v253, v201
    v_exp_f32 v201, v201
    v_mfma_f32_16x16x32_bf16 v[208:211], v[228:231], v[152:155], v[208:211]
    v_add_f32 v251, v251, v200
    v_max_f32 v255, v255, v202
    v_add_f32 v202, v253, v202
    v_mfma_f32_16x16x32_bf16 v[216:219], v[228:231], v[184:187], v[216:219]
    s_waitcnt lgkmcnt(3)
    ds_read_b128 v[228:231], v248 offset:34496
    v_exp_f32 v202, v202
    v_add_f32 v251, v251, v201
    v_cvt_pk_bf16_f32 v200, v200, v201
    v_mfma_f32_16x16x32_bf16 v[208:211], v[232:235], v[156:159], v[208:211]
    v_max_f32 v255, v255, v203
    v_add_f32 v203, v253, v203
    v_exp_f32 v203, v203
    v_mfma_f32_16x16x32_bf16 v[216:219], v[232:235], v[188:191], v[216:219]
    s_waitcnt lgkmcnt(3)
    ds_read_b128 v[232:235], v248 offset:34560
    v_add_f32 v251, v251, v202
    v_max_f32 v254, v254, v196
    v_add_f32 v196, v252, v196
    v_mfma_f32_16x16x32_bf16 v[212:215], v[236:239], v[128:131], 0
    v_exp_f32 v196, v196
    v_add_f32 v251, v251, v203
    v_cvt_pk_bf16_f32 v201, v202, v203
    v_mfma_f32_16x16x32_bf16 v[220:223], v[236:239], v[160:163], 0
    s_waitcnt lgkmcnt(3)
    ds_read_b128 v[236:239], v248 offset:34624
    ds_read_b64_tr_b16 v[244:245], v249 offset:50976
    v_max_f32 v254, v254, v197
    v_add_f32 v197, v252, v197
    v_exp_f32 v197, v197
    v_mfma_f32_16x16x32_bf16 v[212:215], v[240:243], v[132:135], v[212:215]
    v_add_f32 v250, v250, v196
    v_max_f32 v254, v254, v198
    v_add_f32 v198, v252, v198
    v_mfma_f32_16x16x32_bf16 v[220:223], v[240:243], v[164:167], v[220:223]
    s_waitcnt lgkmcnt(4)
    ds_read_b128 v[240:243], v248 offset:34688
    ds_read_b64_tr_b16 v[246:247], v249 offset:51488
    v_exp_f32 v198, v198
    v_add_f32 v250, v250, v197
    v_cvt_pk_bf16_f32 v194, v196, v197
    v_mfma_f32_16x16x32_bf16 v[212:215], v[224:227], v[136:139], v[212:215]
    v_max_f32 v254, v254, v199
    v_add_f32 v199, v252, v199
    v_exp_f32 v199, v199
    v_mfma_f32_16x16x32_bf16 v[220:223], v[224:227], v[168:171], v[220:223]
    s_waitcnt lgkmcnt(5)
    ds_read_b128 v[224:227], v248 offset:34752
    v_add_f32 v250, v250, v198
    v_max_f32 v255, v255, v204
    v_add_f32 v204, v253, v204
    v_mfma_f32_16x16x32_bf16 v[212:215], v[228:231], v[140:143], v[212:215]
    v_exp_f32 v204, v204
    v_add_f32 v250, v250, v199
    v_cvt_pk_bf16_f32 v195, v198, v199
    v_mfma_f32_16x16x32_bf16 v[220:223], v[228:231], v[172:175], v[220:223]
    s_waitcnt lgkmcnt(5)
    ds_read_b64_tr_b16 v[228:229], v249 offset:50688
    ds_read_b64_tr_b16 v[230:231], v249 offset:51200
    v_max_f32 v255, v255, v205
    v_add_f32 v205, v253, v205
    v_exp_f32 v205, v205
    v_mfma_f32_16x16x32_bf16 v[212:215], v[232:235], v[144:147], v[212:215]
    v_add_f32 v251, v251, v204
    v_max_f32 v255, v255, v206
    v_add_f32 v206, v253, v206
    v_mfma_f32_16x16x32_bf16 v[220:223], v[232:235], v[176:179], v[220:223]
    s_waitcnt lgkmcnt(6)
    ds_read_b64_tr_b16 v[232:233], v249 offset:50720
    ds_read_b64_tr_b16 v[234:235], v249 offset:51232
    v_exp_f32 v206, v206
    v_add_f32 v251, v251, v205
    v_cvt_pk_bf16_f32 v202, v204, v205
    v_mfma_f32_16x16x32_bf16 v[212:215], v[236:239], v[148:151], v[212:215]
    v_max_f32 v255, v255, v207
    v_add_f32 v207, v253, v207
    v_exp_f32 v207, v207
    v_mfma_f32_16x16x32_bf16 v[220:223], v[236:239], v[180:183], v[220:223]
    s_waitcnt lgkmcnt(6)
    ds_read_b64_tr_b16 v[236:237], v249 offset:50752
    ds_read_b64_tr_b16 v[238:239], v249 offset:51264
    v_add_f32 v251, v251, v206
    v_add_f32 v251, v251, v207
    v_cvt_pk_bf16_f32 v203, v206, v207
    v_mfma_f32_16x16x32_bf16 v[212:215], v[240:243], v[152:155], v[212:215]
    v_max_f32 v254, v254, v208
    v_add_f32 v208, v252, v208
    v_exp_f32 v208, v208
    v_mfma_f32_16x16x32_bf16 v[220:223], v[240:243], v[184:187], v[220:223]
    s_waitcnt lgkmcnt(6)
    ds_read_b64_tr_b16 v[240:241], v249 offset:50784
    ds_read_b64_tr_b16 v[242:243], v249 offset:51296
    v_mfma_f32_16x16x32_bf16 v[212:215], v[224:227], v[156:159], v[212:215]
    v_add_f32 v250, v250, v208
    v_mfma_f32_16x16x32_bf16 v[220:223], v[224:227], v[188:191], v[220:223]
    s_waitcnt lgkmcnt(6)
    ds_read_b64_tr_b16 v[224:225], v249 offset:50816
    ds_read_b64_tr_b16 v[226:227], v249 offset:51328
    v_mfma_f32_16x16x32_bf16 v[0:3], v[228:231], v[192:195], 0
    v_max_f32 v254, v254, v209
    v_add_f32 v209, v252, v209
    v_exp_f32 v209, v209
    v_mfma_f32_16x16x32_bf16 v[64:67], v[228:231], v[200:203], 0
    s_waitcnt lgkmcnt(6)
    ds_read_b64_tr_b16 v[228:229], v249 offset:50848
    ds_read_b64_tr_b16 v[230:231], v249 offset:51360
    v_mfma_f32_16x16x32_bf16 v[4:7], v[232:235], v[192:195], 0
    v_add_f32 v250, v250, v209
    v_cvt_pk_bf16_f32 v208, v208, v209
    v_mfma_f32_16x16x32_bf16 v[68:71], v[232:235], v[200:203], 0
    s_waitcnt lgkmcnt(6)
    ds_read_b64_tr_b16 v[232:233], v249 offset:50880
    ds_read_b64_tr_b16 v[234:235], v249 offset:51392
    v_mfma_f32_16x16x32_bf16 v[8:11], v[236:239], v[192:195], 0
    v_max_f32 v254, v254, v210
    v_add_f32 v210, v252, v210
    v_exp_f32 v210, v210
    v_mfma_f32_16x16x32_bf16 v[72:75], v[236:239], v[200:203], 0
    s_waitcnt lgkmcnt(6)
    ds_read_b64_tr_b16 v[236:237], v249 offset:50912
    ds_read_b64_tr_b16 v[238:239], v249 offset:51424
    v_mfma_f32_16x16x32_bf16 v[12:15], v[240:243], v[192:195], 0
    v_add_f32 v250, v250, v210
    v_mfma_f32_16x16x32_bf16 v[76:79], v[240:243], v[200:203], 0
    s_waitcnt lgkmcnt(6)
    ds_read_b64_tr_b16 v[240:241], v249 offset:50944
    ds_read_b64_tr_b16 v[242:243], v249 offset:51456
    v_mfma_f32_16x16x32_bf16 v[16:19], v[224:227], v[192:195], 0
    s_mov_b32 s54, 15
    v_max_f32 v254, v254, v211
    v_add_f32 v211, v252, v211
    v_exp_f32 v211, v211
    v_mfma_f32_16x16x32_bf16 v[80:83], v[224:227], v[200:203], 0
    s_waitcnt lgkmcnt(6)
    ds_read_b64_tr_b16 v[224:225], v249 offset:51008
    ds_read_b64_tr_b16 v[226:227], v249 offset:51520
    v_mfma_f32_16x16x32_bf16 v[20:23], v[228:231], v[192:195], 0
    s_mov_b32 s55, 67584
    v_add_f32 v250, v250, v211
    v_cvt_pk_bf16_f32 v209, v210, v211
    v_mfma_f32_16x16x32_bf16 v[84:87], v[228:231], v[200:203], 0
    s_waitcnt lgkmcnt(6)
    ds_read_b64_tr_b16 v[228:229], v249 offset:51040
    ds_read_b64_tr_b16 v[230:231], v249 offset:51552
    v_mfma_f32_16x16x32_bf16 v[24:27], v[232:235], v[192:195], 0
    v_max_f32 v255, v255, v216
    v_add_f32 v216, v253, v216
    v_exp_f32 v216, v216
    v_mfma_f32_16x16x32_bf16 v[88:91], v[232:235], v[200:203], 0
    s_waitcnt lgkmcnt(6)
    ds_read_b64_tr_b16 v[232:233], v249 offset:51072
    ds_read_b64_tr_b16 v[234:235], v249 offset:51584
    v_mfma_f32_16x16x32_bf16 v[28:31], v[236:239], v[192:195], 0
    v_add_f32 v251, v251, v216
    v_mfma_f32_16x16x32_bf16 v[92:95], v[236:239], v[200:203], 0
    s_waitcnt lgkmcnt(6)
    ds_read_b64_tr_b16 v[236:237], v249 offset:51104
    ds_read_b64_tr_b16 v[238:239], v249 offset:51616
    v_mfma_f32_16x16x32_bf16 v[32:35], v[240:243], v[192:195], 0
    v_max_f32 v255, v255, v217
    v_add_f32 v217, v253, v217
    v_exp_f32 v217, v217
    v_mfma_f32_16x16x32_bf16 v[96:99], v[240:243], v[200:203], 0
    ds_read_b64_tr_b16 v[240:241], v249 offset:51136
    ds_read_b64_tr_b16 v[242:243], v249 offset:51648
    v_mfma_f32_16x16x32_bf16 v[36:39], v[244:247], v[192:195], 0
    v_add_f32 v251, v251, v217
    v_cvt_pk_bf16_f32 v216, v216, v217
    v_mfma_f32_16x16x32_bf16 v[100:103], v[244:247], v[200:203], 0
    s_waitcnt lgkmcnt(8)
    ds_read_b64_tr_b16 v[244:245], v249 offset:51168
    ds_read_b64_tr_b16 v[246:247], v249 offset:51680
    v_mfma_f32_16x16x32_bf16 v[40:43], v[224:227], v[192:195], 0
    v_max_f32 v255, v255, v218
    v_add_f32 v218, v253, v218
    v_exp_f32 v218, v218
    v_mfma_f32_16x16x32_bf16 v[104:107], v[224:227], v[200:203], 0
    s_waitcnt lgkmcnt(8)
    v_add_u32 v248, 4294899712, v248
    v_add_u32 v249, 4294899712, v249
    v_mfma_f32_16x16x32_bf16 v[44:47], v[228:231], v[192:195], 0
    s_waitcnt lgkmcnt(0)
    v_add_f32 v251, v251, v218
    v_mfma_f32_16x16x32_bf16 v[108:111], v[228:231], v[200:203], 0
    s_barrier
    ds_read_b128 v[224:227], v248 offset:0
    v_mfma_f32_16x16x32_bf16 v[48:51], v[232:235], v[192:195], 0
    v_max_f32 v255, v255, v219
    v_add_f32 v219, v253, v219
    v_exp_f32 v219, v219
    v_mfma_f32_16x16x32_bf16 v[112:115], v[232:235], v[200:203], 0
    ds_read_b128 v[228:231], v248 offset:64
    v_mfma_f32_16x16x32_bf16 v[52:55], v[236:239], v[192:195], 0
    v_add_f32 v251, v251, v219
    v_cvt_pk_bf16_f32 v217, v218, v219
    v_mfma_f32_16x16x32_bf16 v[116:119], v[236:239], v[200:203], 0
    ds_read_b128 v[232:235], v248 offset:128
    v_mfma_f32_16x16x32_bf16 v[56:59], v[240:243], v[192:195], 0
    v_max_f32 v254, v254, v212
    v_add_f32 v212, v252, v212
    v_exp_f32 v212, v212
    v_mfma_f32_16x16x32_bf16 v[120:123], v[240:243], v[200:203], 0
    ds_read_b128 v[236:239], v248 offset:192
    v_mfma_f32_16x16x32_bf16 v[60:63], v[244:247], v[192:195], 0
    v_add_f32 v250, v250, v212
    v_mfma_f32_16x16x32_bf16 v[124:127], v[244:247], v[200:203], 0
    s_waitcnt lgkmcnt(3)
    ds_read_b128 v[240:243], v248 offset:256
    .p2align 3
LA_main2g:
    v_mfma_f32_16x16x32_bf16 v[192:195], v[224:227], v[128:131], 0
    v_max_f32 v254, v254, v213
    v_add_f32 v213, v252, v213
    v_exp_f32 v213, v213
    v_mfma_f32_16x16x32_bf16 v[200:203], v[224:227], v[160:163], 0
    s_waitcnt lgkmcnt(3)
    ds_read_b128 v[224:227], v248 offset:320
    v_mfma_f32_16x16x32_bf16 v[192:195], v[228:231], v[132:135], v[192:195]
    v_add_f32 v250, v250, v213
    v_cvt_pk_bf16_f32 v210, v212, v213
    v_mfma_f32_16x16x32_bf16 v[200:203], v[228:231], v[164:167], v[200:203]
    s_waitcnt lgkmcnt(3)
    ds_read_b128 v[228:231], v248 offset:384
    v_mfma_f32_16x16x32_bf16 v[192:195], v[232:235], v[136:139], v[192:195]
    v_max_f32 v254, v254, v214
    v_add_f32 v214, v252, v214
    v_exp_f32 v214, v214
    v_mfma_f32_16x16x32_bf16 v[200:203], v[232:235], v[168:171], v[200:203]
    s_waitcnt lgkmcnt(3)
    ds_read_b128 v[232:235], v248 offset:448
    v_mfma_f32_16x16x32_bf16 v[192:195], v[236:239], v[140:143], v[192:195]
    v_add_f32 v250, v250, v214
    v_mfma_f32_16x16x32_bf16 v[200:203], v[236:239], v[172:175], v[200:203]
    s_waitcnt lgkmcnt(3)
    ds_read_b128 v[236:239], v248 offset:512
    v_mfma_f32_16x16x32_bf16 v[192:195], v[240:243], v[144:147], v[192:195]
    v_max_f32 v254, v254, v215
    v_add_f32 v215, v252, v215
    v_exp_f32 v215, v215
    v_mfma_f32_16x16x32_bf16 v[200:203], v[240:243], v[176:179], v[200:203]
    s_waitcnt lgkmcnt(3)
    ds_read_b128 v[240:243], v248 offset:576
    v_mfma_f32_16x16x32_bf16 v[192:195], v[224:227], v[148:151], v[192:195]
    v_add_f32 v250, v250, v215
    v_cvt_pk_bf16_f32 v211, v214, v215
    v_mfma_f32_16x16x32_bf16 v[200:203], v[224:227], v[180:183], v[200:203]
    s_waitcnt lgkmcnt(3)
    ds_read_b128 v[224:227], v248 offset:640
    v_mfma_f32_16x16x32_bf16 v[192:195], v[228:231], v[152:155], v[192:195]
    v_max_f32 v255, v255, v220
    v_add_f32 v220, v253, v220
    v_exp_f32 v220, v220
    v_mfma_f32_16x16x32_bf16 v[200:203], v[228:231], v[184:187], v[200:203]
    s_waitcnt lgkmcnt(3)
    ds_read_b128 v[228:231], v248 offset:704
    v_mfma_f32_16x16x32_bf16 v[192:195], v[232:235], v[156:159], v[192:195]
    v_add_f32 v251, v251, v220
    v_mfma_f32_16x16x32_bf16 v[200:203], v[232:235], v[188:191], v[200:203]
    s_waitcnt lgkmcnt(3)
    ds_read_b128 v[232:235], v248 offset:768
    v_mfma_f32_16x16x32_bf16 v[196:199], v[236:239], v[128:131], 0
    v_max_f32 v255, v255, v221
    v_add_f32 v221, v253, v221
    v_exp_f32 v221, v221
    v_mfma_f32_16x16x32_bf16 v[204:207], v[236:239], v[160:163], 0
    s_waitcnt lgkmcnt(3)
    ds_read_b128 v[236:239], v248 offset:832
    ds_read_b64_tr_b16 v[244:245], v249 offset:17184
    v_mfma_f32_16x16x32_bf16 v[196:199], v[240:243], v[132:135], v[196:199]
    v_add_f32 v251, v251, v221
    v_cvt_pk_bf16_f32 v218, v220, v221
    v_mfma_f32_16x16x32_bf16 v[204:207], v[240:243], v[164:167], v[204:207]
    s_waitcnt lgkmcnt(4)
    ds_read_b128 v[240:243], v248 offset:896
    ds_read_b64_tr_b16 v[246:247], v249 offset:17696
    v_mfma_f32_16x16x32_bf16 v[196:199], v[224:227], v[136:139], v[196:199]
    v_max_f32 v255, v255, v222
    v_add_f32 v222, v253, v222
    v_exp_f32 v222, v222
    v_mfma_f32_16x16x32_bf16 v[204:207], v[224:227], v[168:171], v[204:207]
    s_waitcnt lgkmcnt(5)
    ds_read_b128 v[224:227], v248 offset:960
    v_mfma_f32_16x16x32_bf16 v[196:199], v[228:231], v[140:143], v[196:199]
    v_add_f32 v251, v251, v222
    v_mfma_f32_16x16x32_bf16 v[204:207], v[228:231], v[172:175], v[204:207]
    s_waitcnt lgkmcnt(5)
    ds_read_b64_tr_b16 v[228:229], v249 offset:16896
    ds_read_b64_tr_b16 v[230:231], v249 offset:17408
    v_mfma_f32_16x16x32_bf16 v[196:199], v[232:235], v[144:147], v[196:199]
    v_max_f32 v255, v255, v223
    v_add_f32 v223, v253, v223
    v_exp_f32 v223, v223
    v_mfma_f32_16x16x32_bf16 v[204:207], v[232:235], v[176:179], v[204:207]
    s_waitcnt lgkmcnt(6)
    ds_read_b64_tr_b16 v[232:233], v249 offset:16928
    ds_read_b64_tr_b16 v[234:235], v249 offset:17440
    v_mfma_f32_16x16x32_bf16 v[196:199], v[236:239], v[148:151], v[196:199]
    v_add_f32 v251, v251, v223
    v_cvt_pk_bf16_f32 v219, v222, v223
    v_mfma_f32_16x16x32_bf16 v[204:207], v[236:239], v[180:183], v[204:207]
    s_waitcnt lgkmcnt(6)
    ds_read_b64_tr_b16 v[236:237], v249 offset:16960
    ds_read_b64_tr_b16 v[238:239], v249 offset:17472
    v_mfma_f32_16x16x32_bf16 v[196:199], v[240:243], v[152:155], v[196:199]
    v_max_f32 v254, v254, v192
    v_add_f32 v192, v252, v192
    v_exp_f32 v192, v192
    v_mfma_f32_16x16x32_bf16 v[204:207], v[240:243], v[184:187], v[204:207]
    s_waitcnt lgkmcnt(6)
    ds_read_b64_tr_b16 v[240:241], v249 offset:16992
    ds_read_b64_tr_b16 v[242:243], v249 offset:17504
    v_mfma_f32_16x16x32_bf16 v[196:199], v[224:227], v[156:159], v[196:199]
    v_add_f32 v250, v250, v192
    v_mfma_f32_16x16x32_bf16 v[204:207], v[224:227], v[188:191], v[204:207]
    s_waitcnt lgkmcnt(6)
    ds_read_b64_tr_b16 v[224:225], v249 offset:17024
    ds_read_b64_tr_b16 v[226:227], v249 offset:17536
    v_mfma_f32_16x16x32_bf16 v[0:3], v[228:231], v[208:211], v[0:3]
    v_max_f32 v254, v254, v193
    v_add_f32 v193, v252, v193
    v_exp_f32 v193, v193
    v_mfma_f32_16x16x32_bf16 v[64:67], v[228:231], v[216:219], v[64:67]
    s_waitcnt lgkmcnt(6)
    ds_read_b64_tr_b16 v[228:229], v249 offset:17056
    ds_read_b64_tr_b16 v[230:231], v249 offset:17568
    v_mfma_f32_16x16x32_bf16 v[4:7], v[232:235], v[208:211], v[4:7]
    v_add_f32 v250, v250, v193
    v_cvt_pk_bf16_f32 v192, v192, v193
    v_mfma_f32_16x16x32_bf16 v[68:71], v[232:235], v[216:219], v[68:71]
    s_waitcnt lgkmcnt(6)
    ds_read_b64_tr_b16 v[232:233], v249 offset:17088
    ds_read_b64_tr_b16 v[234:235], v249 offset:17600
    v_mfma_f32_16x16x32_bf16 v[8:11], v[236:239], v[208:211], v[8:11]
    v_max_f32 v254, v254, v194
    v_add_f32 v194, v252, v194
    v_exp_f32 v194, v194
    v_mfma_f32_16x16x32_bf16 v[72:75], v[236:239], v[216:219], v[72:75]
    s_waitcnt lgkmcnt(6)
    ds_read_b64_tr_b16 v[236:237], v249 offset:17120
    ds_read_b64_tr_b16 v[238:239], v249 offset:17632
    v_mfma_f32_16x16x32_bf16 v[12:15], v[240:243], v[208:211], v[12:15]
    v_add_f32 v250, v250, v194
    v_mfma_f32_16x16x32_bf16 v[76:79], v[240:243], v[216:219], v[76:79]
    s_waitcnt lgkmcnt(6)
    ds_read_b64_tr_b16 v[240:241], v249 offset:17152
    ds_read_b64_tr_b16 v[242:243], v249 offset:17664
    v_mfma_f32_16x16x32_bf16 v[16:19], v[224:227], v[208:211], v[16:19]
    v_max_f32 v254, v254, v195
    v_add_f32 v195, v252, v195
    v_exp_f32 v195, v195
    v_mfma_f32_16x16x32_bf16 v[80:83], v[224:227], v[216:219], v[80:83]
    s_waitcnt lgkmcnt(6)
    ds_read_b64_tr_b16 v[224:225], v249 offset:17216
    ds_read_b64_tr_b16 v[226:227], v249 offset:17728
    v_mfma_f32_16x16x32_bf16 v[20:23], v[228:231], v[208:211], v[20:23]
    v_add_f32 v250, v250, v195
    v_cvt_pk_bf16_f32 v193, v194, v195
    v_mfma_f32_16x16x32_bf16 v[84:87], v[228:231], v[216:219], v[84:87]
    s_waitcnt lgkmcnt(6)
    ds_read_b64_tr_b16 v[228:229], v249 offset:17248
    ds_read_b64_tr_b16 v[230:231], v249 offset:17760
    v_mfma_f32_16x16x32_bf16 v[24:27], v[232:235], v[208:211], v[24:27]
    v_max_f32 v255, v255, v200
    v_add_f32 v200, v253, v200
    v_exp_f32 v200, v200
    v_mfma_f32_16x16x32_bf16 v[88:91], v[232:235], v[216:219], v[88:91]
    s_waitcnt lgkmcnt(6)
    ds_read_b64_tr_b16 v[232:233], v249 offset:17280
    ds_read_b64_tr_b16 v[234:235], v249 offset:17792
    v_mfma_f32_16x16x32_bf16 v[28:31], v[236:239], v[208:211], v[28:31]
    v_add_f32 v251, v251, v200
    v_mfma_f32_16x16x32_bf16 v[92:95], v[236:239], v[216:219], v[92:95]
    s_waitcnt lgkmcnt(6)
    ds_read_b64_tr_b16 v[236:237], v249 offset:17312
    ds_read_b64_tr_b16 v[238:239], v249 offset:17824
    v_mfma_f32_16x16x32_bf16 v[32:35], v[240:243], v[208:211], v[32:35]
    v_max_f32 v255, v255, v201
    v_add_f32 v201, v253, v201
    v_exp_f32 v201, v201
    v_mfma_f32_16x16x32_bf16 v[96:99], v[240:243], v[216:219], v[96:99]
    ds_read_b64_tr_b16 v[240:241], v249 offset:17344
    ds_read_b64_tr_b16 v[242:243], v249 offset:17856
    v_mfma_f32_16x16x32_bf16 v[36:39], v[244:247], v[208:211], v[36:39]
    v_add_f32 v251, v251, v201
    v_cvt_pk_bf16_f32 v200, v200, v201
    v_mfma_f32_16x16x32_bf16 v[100:103], v[244:247], v[216:219], v[100:103]
    s_waitcnt lgkmcnt(8)
    ds_read_b64_tr_b16 v[244:245], v249 offset:17376
    ds_read_b64_tr_b16 v[246:247], v249 offset:17888
    v_mfma_f32_16x16x32_bf16 v[40:43], v[224:227], v[208:211], v[40:43]
    v_max_f32 v255, v255, v202
    v_add_f32 v202, v253, v202
    v_exp_f32 v202, v202
    v_mfma_f32_16x16x32_bf16 v[104:107], v[224:227], v[216:219], v[104:107]
    s_waitcnt lgkmcnt(8)
    v_mfma_f32_16x16x32_bf16 v[44:47], v[228:231], v[208:211], v[44:47]
    s_waitcnt lgkmcnt(0)
    v_add_f32 v251, v251, v202
    v_mfma_f32_16x16x32_bf16 v[108:111], v[228:231], v[216:219], v[108:111]
    s_barrier
    ds_read_b128 v[224:227], v248 offset:33792
    v_mfma_f32_16x16x32_bf16 v[48:51], v[232:235], v[208:211], v[48:51]
    v_max_f32 v255, v255, v203
    v_add_f32 v203, v253, v203
    v_exp_f32 v203, v203
    v_mfma_f32_16x16x32_bf16 v[112:115], v[232:235], v[216:219], v[112:115]
    ds_read_b128 v[228:231], v248 offset:33856
    v_mfma_f32_16x16x32_bf16 v[52:55], v[236:239], v[208:211], v[52:55]
    v_add_f32 v251, v251, v203
    v_cvt_pk_bf16_f32 v201, v202, v203
    v_mfma_f32_16x16x32_bf16 v[116:119], v[236:239], v[216:219], v[116:119]
    ds_read_b128 v[232:235], v248 offset:33920
    v_mfma_f32_16x16x32_bf16 v[56:59], v[240:243], v[208:211], v[56:59]
    v_max_f32 v254, v254, v196
    v_add_f32 v196, v252, v196
    v_exp_f32 v196, v196
    v_mfma_f32_16x16x32_bf16 v[120:123], v[240:243], v[216:219], v[120:123]
    ds_read_b128 v[236:239], v248 offset:33984
    v_mfma_f32_16x16x32_bf16 v[60:63], v[244:247], v[208:211], v[60:63]
    v_add_f32 v250, v250, v196
    v_mfma_f32_16x16x32_bf16 v[124:127], v[244:247], v[216:219], v[124:127]
    s_waitcnt lgkmcnt(3)
    ds_read_b128 v[240:243], v248 offset:34048
    v_mfma_f32_16x16x32_bf16 v[208:211], v[224:227], v[128:131], 0
    v_max_f32 v254, v254, v197
    v_add_f32 v197, v252, v197
    v_exp_f32 v197, v197
    v_mfma_f32_16x16x32_bf16 v[216:219], v[224:227], v[160:163], 0
    s_waitcnt lgkmcnt(3)
    ds_read_b128 v[224:227], v248 offset:34112
    v_mfma_f32_16x16x32_bf16 v[208:211], v[228:231], v[132:135], v[208:211]
    v_add_f32 v250, v250, v197
    v_cvt_pk_bf16_f32 v194, v196, v197
    v_mfma_f32_16x16x32_bf16 v[216:219], v[228:231], v[164:167], v[216:219]
    s_waitcnt lgkmcnt(3)
    ds_read_b128 v[228:231], v248 offset:34176
    v_mfma_f32_16x16x32_bf16 v[208:211], v[232:235], v[136:139], v[208:211]
    v_max_f32 v254, v254, v198
    v_add_f32 v198, v252, v198
    v_exp_f32 v198, v198
    v_mfma_f32_16x16x32_bf16 v[216:219], v[232:235], v[168:171], v[216:219]
    s_waitcnt lgkmcnt(3)
    ds_read_b128 v[232:235], v248 offset:34240
    v_mfma_f32_16x16x32_bf16 v[208:211], v[236:239], v[140:143], v[208:211]
    v_add_f32 v250, v250, v198
    v_mfma_f32_16x16x32_bf16 v[216:219], v[236:239], v[172:175], v[216:219]
    s_waitcnt lgkmcnt(3)
    ds_read_b128 v[236:239], v248 offset:34304
    v_mfma_f32_16x16x32_bf16 v[208:211], v[240:243], v[144:147], v[208:211]
    v_max_f32 v254, v254, v199
    v_add_f32 v199, v252, v199
    v_exp_f32 v199, v199
    v_mfma_f32_16x16x32_bf16 v[216:219], v[240:243], v[176:179], v[216:219]
    s_waitcnt lgkmcnt(3)
    ds_read_b128 v[240:243], v248 offset:34368
    v_mfma_f32_16x16x32_bf16 v[208:211], v[224:227], v[148:151], v[208:211]
    v_add_f32 v250, v250, v199
    v_cvt_pk_bf16_f32 v195, v198, v199
    v_mfma_f32_16x16x32_bf16 v[216:219], v[224:227], v[180:183], v[216:219]
    s_waitcnt lgkmcnt(3)
    ds_read_b128 v[224:227], v248 offset:34432
    v_mfma_f32_16x16x32_bf16 v[208:211], v[228:231], v[152:155], v[208:211]
    v_max_f32 v255, v255, v204
    v_add_f32 v204, v253, v204
    v_exp_f32 v204, v204
    v_mfma_f32_16x16x32_bf16 v[216:219], v[228:231], v[184:187], v[216:219]
    s_waitcnt lgkmcnt(3)
    ds_read_b128 v[228:231], v248 offset:34496
    v_mfma_f32_16x16x32_bf16 v[208:211], v[232:235], v[156:159], v[208:211]
    v_add_f32 v251, v251, v204
    v_mfma_f32_16x16x32_bf16 v[216:219], v[232:235], v[188:191], v[216:219]
    s_waitcnt lgkmcnt(3)
    ds_read_b128 v[232:235], v248 offset:34560
    v_mfma_f32_16x16x32_bf16 v[212:215], v[236:239], v[128:131], 0
    v_max_f32 v255, v255, v205
    v_add_f32 v205, v253, v205
    v_exp_f32 v205, v205
    v_mfma_f32_16x16x32_bf16 v[220:223], v[236:239], v[160:163], 0
    s_waitcnt lgkmcnt(3)
    ds_read_b128 v[236:239], v248 offset:34624
    ds_read_b64_tr_b16 v[244:245], v249 offset:50976
    v_mfma_f32_16x16x32_bf16 v[212:215], v[240:243], v[132:135], v[212:215]
    v_add_f32 v251, v251, v205
    v_cvt_pk_bf16_f32 v202, v204, v205
    v_mfma_f32_16x16x32_bf16 v[220:223], v[240:243], v[164:167], v[220:223]
    s_waitcnt lgkmcnt(4)
    ds_read_b128 v[240:243], v248 offset:34688
    ds_read_b64_tr_b16 v[246:247], v249 offset:51488
    v_mfma_f32_16x16x32_bf16 v[212:215], v[224:227], v[136:139], v[212:215]
    v_max_f32 v255, v255, v206
    v_add_f32 v206, v253, v206
    v_exp_f32 v206, v206
    v_mfma_f32_16x16x32_bf16 v[220:223], v[224:227], v[168:171], v[220:223]
    s_waitcnt lgkmcnt(5)
    ds_read_b128 v[224:227], v248 offset:34752
    v_mfma_f32_16x16x32_bf16 v[212:215], v[228:231], v[140:143], v[212:215]
    v_add_f32 v251, v251, v206
    v_mfma_f32_16x16x32_bf16 v[220:223], v[228:231], v[172:175], v[220:223]
    s_waitcnt lgkmcnt(5)
    ds_read_b64_tr_b16 v[228:229], v249 offset:50688
    ds_read_b64_tr_b16 v[230:231], v249 offset:51200
    v_mfma_f32_16x16x32_bf16 v[212:215], v[232:235], v[144:147], v[212:215]
    v_max_f32 v255, v255, v207
    v_add_f32 v207, v253, v207
    v_exp_f32 v207, v207
    v_mfma_f32_16x16x32_bf16 v[220:223], v[232:235], v[176:179], v[220:223]
    s_waitcnt lgkmcnt(6)
    ds_read_b64_tr_b16 v[232:233], v249 offset:50720
    ds_read_b64_tr_b16 v[234:235], v249 offset:51232
    v_mfma_f32_16x16x32_bf16 v[212:215], v[236:239], v[148:151], v[212:215]
    v_add_f32 v251, v251, v207
    v_cvt_pk_bf16_f32 v203, v206, v207
    v_mfma_f32_16x16x32_bf16 v[220:223], v[236:239], v[180:183], v[220:223]
    s_waitcnt lgkmcnt(6)
    ds_read_b64_tr_b16 v[236:237], v249 offset:50752
    ds_read_b64_tr_b16 v[238:239], v249 offset:51264
    v_mfma_f32_16x16x32_bf16 v[212:215], v[240:243], v[152:155], v[212:215]
    v_max_f32 v254, v254, v208
    v_add_f32 v208, v252, v208
    v_exp_f32 v208, v208
    v_mfma_f32_16x16x32_bf16 v[220:223], v[240:243], v[184:187], v[220:223]
    s_waitcnt lgkmcnt(6)
    ds_read_b64_tr_b16 v[240:241], v249 offset:50784
    ds_read_b64_tr_b16 v[242:243], v249 offset:51296
    v_mfma_f32_16x16x32_bf16 v[212:215], v[224:227], v[156:159], v[212:215]
    v_add_f32 v250, v250, v208
    v_mfma_f32_16x16x32_bf16 v[220:223], v[224:227], v[188:191], v[220:223]
    s_waitcnt lgkmcnt(6)
    ds_read_b64_tr_b16 v[224:225], v249 offset:50816
    ds_read_b64_tr_b16 v[226:227], v249 offset:51328
    v_mfma_f32_16x16x32_bf16 v[0:3], v[228:231], v[192:195], v[0:3]
    v_max_f32 v254, v254, v209
    v_add_f32 v209, v252, v209
    v_exp_f32 v209, v209
    v_mfma_f32_16x16x32_bf16 v[64:67], v[228:231], v[200:203], v[64:67]
    s_waitcnt lgkmcnt(6)
    ds_read_b64_tr_b16 v[228:229], v249 offset:50848
    ds_read_b64_tr_b16 v[230:231], v249 offset:51360
    v_mfma_f32_16x16x32_bf16 v[4:7], v[232:235], v[192:195], v[4:7]
    v_add_f32 v250, v250, v209
    v_cvt_pk_bf16_f32 v208, v208, v209
    v_mfma_f32_16x16x32_bf16 v[68:71], v[232:235], v[200:203], v[68:71]
    s_waitcnt lgkmcnt(6)
    ds_read_b64_tr_b16 v[232:233], v249 offset:50880
    ds_read_b64_tr_b16 v[234:235], v249 offset:51392
    v_mfma_f32_16x16x32_bf16 v[8:11], v[236:239], v[192:195], v[8:11]
    v_max_f32 v254, v254, v210
    v_add_f32 v210, v252, v210
    v_exp_f32 v210, v210
    v_mfma_f32_16x16x32_bf16 v[72:75], v[236:239], v[200:203], v[72:75]
    s_waitcnt lgkmcnt(6)
    ds_read_b64_tr_b16 v[236:237], v249 offset:50912
    ds_read_b64_tr_b16 v[238:239], v249 offset:51424
    v_mfma_f32_16x16x32_bf16 v[12:15], v[240:243], v[192:195], v[12:15]
    v_add_f32 v250, v250, v210
    v_mfma_f32_16x16x32_bf16 v[76:79], v[240:243], v[200:203], v[76:79]
    s_waitcnt lgkmcnt(6)
    ds_read_b64_tr_b16 v[240:241], v249 offset:50944
    ds_read_b64_tr_b16 v[242:243], v249 offset:51456
    v_mfma_f32_16x16x32_bf16 v[16:19], v[224:227], v[192:195], v[16:19]
    v_max_f32 v254, v254, v211
    v_add_f32 v211, v252, v211
    v_exp_f32 v211, v211
    v_mfma_f32_16x16x32_bf16 v[80:83], v[224:227], v[200:203], v[80:83]
    s_waitcnt lgkmcnt(6)
    ds_read_b64_tr_b16 v[224:225], v249 offset:51008
    ds_read_b64_tr_b16 v[226:227], v249 offset:51520
    v_mfma_f32_16x16x32_bf16 v[20:23], v[228:231], v[192:195], v[20:23]
    v_add_f32 v250, v250, v211
    v_cvt_pk_bf16_f32 v209, v210, v211
    v_mfma_f32_16x16x32_bf16 v[84:87], v[228:231], v[200:203], v[84:87]
    s_waitcnt lgkmcnt(6)
    ds_read_b64_tr_b16 v[228:229], v249 offset:51040
    ds_read_b64_tr_b16 v[230:231], v249 offset:51552
    v_mfma_f32_16x16x32_bf16 v[24:27], v[232:235], v[192:195], v[24:27]
    v_max_f32 v255, v255, v216
    v_add_f32 v216, v253, v216
    v_exp_f32 v216, v216
    v_mfma_f32_16x16x32_bf16 v[88:91], v[232:235], v[200:203], v[88:91]
    s_waitcnt lgkmcnt(6)
    ds_read_b64_tr_b16 v[232:233], v249 offset:51072
    ds_read_b64_tr_b16 v[234:235], v249 offset:51584
    v_mfma_f32_16x16x32_bf16 v[28:31], v[236:239], v[192:195], v[28:31]
    v_add_f32 v251, v251, v216
    v_mfma_f32_16x16x32_bf16 v[92:95], v[236:239], v[200:203], v[92:95]
    s_waitcnt lgkmcnt(6)
    ds_read_b64_tr_b16 v[236:237], v249 offset:51104
    ds_read_b64_tr_b16 v[238:239], v249 offset:51616
    v_mfma_f32_16x16x32_bf16 v[32:35], v[240:243], v[192:195], v[32:35]
    v_max_f32 v255, v255, v217
    v_add_f32 v217, v253, v217
    v_exp_f32 v217, v217
    v_mfma_f32_16x16x32_bf16 v[96:99], v[240:243], v[200:203], v[96:99]
    ds_read_b64_tr_b16 v[240:241], v249 offset:51136
    ds_read_b64_tr_b16 v[242:243], v249 offset:51648
    v_mfma_f32_16x16x32_bf16 v[36:39], v[244:247], v[192:195], v[36:39]
    v_add_f32 v251, v251, v217
    v_cvt_pk_bf16_f32 v216, v216, v217
    v_mfma_f32_16x16x32_bf16 v[100:103], v[244:247], v[200:203], v[100:103]
    s_waitcnt lgkmcnt(8)
    ds_read_b64_tr_b16 v[244:245], v249 offset:51168
    ds_read_b64_tr_b16 v[246:247], v249 offset:51680
    v_mfma_f32_16x16x32_bf16 v[40:43], v[224:227], v[192:195], v[40:43]
    v_max_f32 v255, v255, v218
    v_add_f32 v218, v253, v218
    v_exp_f32 v218, v218
    v_mfma_f32_16x16x32_bf16 v[104:107], v[224:227], v[200:203], v[104:107]
    s_waitcnt lgkmcnt(8)
    v_add_u32 v248, s55, v248
    v_add_u32 v249, s55, v249
    v_mfma_f32_16x16x32_bf16 v[44:47], v[228:231], v[192:195], v[44:47]
    s_waitcnt lgkmcnt(0)
    v_add_f32 v251, v251, v218
    v_mfma_f32_16x16x32_bf16 v[108:111], v[228:231], v[200:203], v[108:111]
    s_barrier
    ds_read_b128 v[224:227], v248 offset:0
    v_mfma_f32_16x16x32_bf16 v[48:51], v[232:235], v[192:195], v[48:51]
    s_sub_u32 s55, 0, s55
    v_max_f32 v255, v255, v219
    v_add_f32 v219, v253, v219
    v_exp_f32 v219, v219
    v_mfma_f32_16x16x32_bf16 v[112:115], v[232:235], v[200:203], v[112:115]
    ds_read_b128 v[228:231], v248 offset:64
    v_mfma_f32_16x16x32_bf16 v[52:55], v[236:239], v[192:195], v[52:55]
    s_sub_u32 s54, s54, 1
    v_add_f32 v251, v251, v219
    v_cvt_pk_bf16_f32 v217, v218, v219
    v_mfma_f32_16x16x32_bf16 v[116:119], v[236:239], v[200:203], v[116:119]
    ds_read_b128 v[232:235], v248 offset:128
    v_mfma_f32_16x16x32_bf16 v[56:59], v[240:243], v[192:195], v[56:59]
    s_cmp_lg_u32 s54, 0
    v_max_f32 v254, v254, v212
    v_add_f32 v212, v252, v212
    v_exp_f32 v212, v212
    v_mfma_f32_16x16x32_bf16 v[120:123], v[240:243], v[200:203], v[120:123]
    ds_read_b128 v[236:239], v248 offset:192
    v_mfma_f32_16x16x32_bf16 v[60:63], v[244:247], v[192:195], v[60:63]
    v_add_f32 v250, v250, v212
    v_mfma_f32_16x16x32_bf16 v[124:127], v[244:247], v[200:203], v[124:127]
    s_waitcnt lgkmcnt(3)
    ds_read_b128 v[240:243], v248 offset:256
    s_cbranch_scc1 LA_main2g
    ds_read_b64_tr_b16 v[224:225], v249 offset:16896
    ds_read_b64_tr_b16 v[226:227], v249 offset:17408
    ds_read_b64_tr_b16 v[228:229], v249 offset:16928
    ds_read_b64_tr_b16 v[230:231], v249 offset:17440
    ds_read_b64_tr_b16 v[232:233], v249 offset:16960
    ds_read_b64_tr_b16 v[234:235], v249 offset:17472
    ds_read_b64_tr_b16 v[236:237], v249 offset:16992
    ds_read_b64_tr_b16 v[238:239], v249 offset:17504
    ds_read_b64_tr_b16 v[240:241], v249 offset:17024
    ds_read_b64_tr_b16 v[242:243], v249 offset:17536
    v_max_f32 v254, v254, v213
    v_add_f32 v213, v252, v213
    v_exp_f32 v213, v213
    v_max_f32 v254, v254, v214
    v_add_f32 v214, v252, v214
    v_exp_f32 v214, v214
    v_max_f32 v254, v254, v215
    v_add_f32 v215, v252, v215
    v_exp_f32 v215, v215
    v_max_f32 v255, v255, v220
    v_add_f32 v220, v253, v220
    v_exp_f32 v220, v220
    v_max_f32 v255, v255, v221
    v_add_f32 v221, v253, v221
    v_exp_f32 v221, v221
    v_max_f32 v255, v255, v222
    v_add_f32 v222, v253, v222
    v_exp_f32 v222, v222
    v_max_f32 v255, v255, v223
    v_add_f32 v223, v253, v223
    v_exp_f32 v223, v223
    v_mbcnt_lo_u32_b32 v194, -1, 0
    v_add_f32 v250, v250, v213
    v_cvt_pk_bf16_f32 v210, v212, v213
    v_add_f32 v250, v250, v214
    v_add_f32 v250, v250, v215
    v_cvt_pk_bf16_f32 v211, v214, v215
    v_add_f32 v251, v251, v220
    v_add_f32 v251, v251, v221
    v_cvt_pk_bf16_f32 v218, v220, v221
    v_add_f32 v251, v251, v222
    v_add_f32 v251, v251, v223
    v_cvt_pk_bf16_f32 v219, v222, v223
    v_mov_b32 v200, v254
    v_mov_b32 v201, v255
    s_nop 1
    v_permlane32_swap_b32 v200, v254
    v_permlane32_swap_b32 v201, v255
    v_max_f32 v254, v254, v200
    v_max_f32 v255, v255, v201
    v_mov_b32 v200, v254
    v_mov_b32 v201, v255
    s_nop 1
    v_permlane16_swap_b32 v200, v254
    v_permlane16_swap_b32 v201, v255
    v_max_f32 v254, v254, v200
    v_max_f32 v255, v255, v201
    v_sub_f32 v254, 0, v254
    v_sub_f32 v255, 0, v255
    v_mbcnt_hi_u32_b32 v200, -1, v194
    s_lshl_b32 s50, s44, 9
    s_add_u32 s50, s50, 256
    v_lshl_add_u32 v200, v200, 3, s50
    ds_write_b64 v200, v[254:255]
    s_waitcnt lgkmcnt(0)
    v_mbcnt_lo_u32_b32 v255, -1, 0
    v_mbcnt_hi_u32_b32 v255, -1, v255
    v_lshrrev_b32 v252, 2, v255
    v_lshlrev_b32 v252, 7, v252
    v_bfe_u32 v253, v255, 3, 2
    v_lshl_add_u32 v252, v253, 5, v252
    v_and_b32 v253, 3, v255
    v_lshl_add_u32 v252, v253, 3, v252
    v_add_u32 v252, 97280, v252
    v_xor_b32 v253, 32, v252
    v_xor_b32 v254, 64, v252
    v_xor_b32 v255, 0x60, v252
    s_branch LA_join2
LA_redo1:
    s_waitcnt vmcnt(0) lgkmcnt(0)
    s_barrier
    s_add_u32 s97, s97, 1
    s_branch LA_crestart
LA_gen1:
    v_mbcnt_lo_u32_b32 v254, -1, 0
    v_mbcnt_hi_u32_b32 v254, -1, v254
    s_lshl_b32 s50, s44, 9
    s_add_u32 s50, s50, 256
    v_lshl_add_u32 v254, v254, 3, s50
    ds_read_b64 v[252:253], v254
    s_waitcnt lgkmcnt(0)
    v_mov_b32 v254, 0xff800000
    v_mov_b32 v255, 0xff800000
    s_cmp_eq_u32 s97, 2
    s_cbranch_scc1 LA_gen21
    v_mov_b64 v[252:253], 0
LA_gen21:
    v_mfma_f32_16x16x32_bf16 v[208:211], v[224:227], v[128:131], 0
    s_waitcnt lgkmcnt(3)
    ds_read_b128 v[224:227], v248 offset:34112
    v_mfma_f32_16x16x32_bf16 v[208:211], v[228:231], v[132:135], v[208:211]
    s_waitcnt lgkmcnt(3)
    ds_read_b128 v[228:231], v248 offset:34176
    v_mfma_f32_16x16x32_bf16 v[208:211], v[232:235], v[136:139], v[208:211]
    s_waitcnt lgkmcnt(3)
    ds_read_b128 v[232:235], v248 offset:34240
    v_mfma_f32_16x16x32_bf16 v[208:211], v[236:239], v[140:143], v[208:211]
    s_waitcnt lgkmcnt(3)
    ds_read_b128 v[236:239], v248 offset:34304
    v_mfma_f32_16x16x32_bf16 v[208:211], v[240:243], v[144:147], v[208:211]
    v_max_f32 v254, v254, v192
    v_add_f32 v192, v252, v192
    s_waitcnt lgkmcnt(3)
    ds_read_b128 v[240:243], v248 offset:34368
    v_exp_f32 v192, v192
    v_max_f32 v254, v254, v193
    v_mfma_f32_16x16x32_bf16 v[208:211], v[224:227], v[148:151], v[208:211]
    v_add_f32 v193, v252, v193
    v_exp_f32 v193, v193
    s_nop 0
    s_waitcnt lgkmcnt(3)
    ds_read_b128 v[224:227], v248 offset:34432
    v_add_f32 v250, v250, v192
    v_max_f32 v254, v254, v194
    v_mfma_f32_16x16x32_bf16 v[208:211], v[228:231], v[152:155], v[208:211]
    v_add_f32 v194, v252, v194
    v_exp_f32 v194, v194
    s_nop 0
    s_waitcnt lgkmcnt(3)
    ds_read_b128 v[228:231], v248 offset:34496
    v_add_f32 v250, v250, v193
    v_cvt_pk_bf16_f32 v192, v192, v193
    v_mfma_f32_16x16x32_bf16 v[208:211], v[232:235], v[156:159], v[208:211]
    v_max_f32 v254, v254, v195
    v_add_f32 v195, v252, v195
    s_waitcnt lgkmcnt(3)
    ds_read_b128 v[232:235], v248 offset:34560
    v_exp_f32 v195, v195
    v_add_f32 v250, v250, v194
    v_mfma_f32_16x16x32_bf16 v[212:215], v[236:239], v[128:131], 0
    v_add_f32 v250, v250, v195
    v_cvt_pk_bf16_f32 v193, v194, v195
    s_waitcnt lgkmcnt(3)
    ds_read_b128 v[236:239], v248 offset:34624
    ds_read_b64_tr_b16 v[244:245], v249 offset:50976
    v_max_f32 v254, v254, v196
    v_add_f32 v196, v252, v196
    v_mfma_f32_16x16x32_bf16 v[212:215], v[240:243], v[132:135], v[212:215]
    v_exp_f32 v196, v196
    v_max_f32 v254, v254, v197
    s_waitcnt lgkmcnt(4)
    ds_read_b128 v[240:243], v248 offset:34688
    ds_read_b64_tr_b16 v[246:247], v249 offset:51488
    v_add_f32 v197, v252, v197
    v_exp_f32 v197, v197
    v_mfma_f32_16x16x32_bf16 v[212:215], v[224:227], v[136:139], v[212:215]
    v_add_f32 v250, v250, v196
    v_max_f32 v254, v254, v198
    s_waitcnt lgkmcnt(5)
    ds_read_b128 v[224:227], v248 offset:34752
    v_add_f32 v198, v252, v198
    v_exp_f32 v198, v198
    v_mfma_f32_16x16x32_bf16 v[212:215], v[228:231], v[140:143], v[212:215]
    v_add_f32 v250, v250, v197
    v_cvt_pk_bf16_f32 v194, v196, v197
    s_waitcnt lgkmcnt(5)
    ds_read_b64_tr_b16 v[228:229], v249 offset:50688
    ds_read_b64_tr_b16 v[230:231], v249 offset:51200
    v_max_f32 v254, v254, v199
    v_add_f32 v199, v252, v199
    v_mfma_f32_16x16x32_bf16 v[212:215], v[232:235], v[144:147], v[212:215]
    v_exp_f32 v199, v199
    v_add_f32 v250, v250, v198
    s_waitcnt lgkmcnt(6)
    ds_read_b64_tr_b16 v[232:233], v249 offset:50720
    ds_read_b64_tr_b16 v[234:235], v249 offset:51232
    v_add_f32 v250, v250, v199
    v_cvt_pk_bf16_f32 v195, v198, v199
    v_mfma_f32_16x16x32_bf16 v[212:215], v[236:239], v[148:151], v[212:215]
    s_waitcnt lgkmcnt(6)
    ds_read_b64_tr_b16 v[236:237], v249 offset:50752
    ds_read_b64_tr_b16 v[238:239], v249 offset:51264
    v_mfma_f32_16x16x32_bf16 v[212:215], v[240:243], v[152:155], v[212:215]
    v_max_f32 v254, v254, v208
    v_add_f32 v208, v252, v208
    v_exp_f32 v208, v208
    s_nop 0
    s_waitcnt lgkmcnt(6)
    ds_read_b64_tr_b16 v[240:241], v249 offset:50784
    ds_read_b64_tr_b16 v[242:243], v249 offset:51296
    v_mfma_f32_16x16x32_bf16 v[212:215], v[224:227], v[156:159], v[212:215]
    v_add_f32 v250, v250, v208
    s_waitcnt lgkmcnt(6)
    ds_read_b64_tr_b16 v[224:225], v249 offset:50816
    ds_read_b64_tr_b16 v[226:227], v249 offset:51328
    v_mfma_f32_16x16x32_bf16 v[0:3], v[228:231], v[192:195], 0
    v_max_f32 v254, v254, v209
    v_add_f32 v209, v252, v209
    v_exp_f32 v209, v209
    s_nop 0
    s_waitcnt lgkmcnt(6)
    ds_read_b64_tr_b16 v[228:229], v249 offset:50848
    ds_read_b64_tr_b16 v[230:231], v249 offset:51360
    v_mfma_f32_16x16x32_bf16 v[4:7], v[232:235], v[192:195], 0
    v_add_f32 v250, v250, v209
    v_cvt_pk_bf16_f32 v208, v208, v209
    s_waitcnt lgkmcnt(6)
    ds_read_b64_tr_b16 v[232:233], v249 offset:50880
    ds_read_b64_tr_b16 v[234:235], v249 offset:51392
    v_mfma_f32_16x16x32_bf16 v[8:11], v[236:239], v[192:195], 0
    v_max_f32 v254, v254, v210
    v_add_f32 v210, v252, v210
    v_exp_f32 v210, v210
    s_nop 0
    s_waitcnt lgkmcnt(6)
    ds_read_b64_tr_b16 v[236:237], v249 offset:50912
    ds_read_b64_tr_b16 v[238:239], v249 offset:51424
    v_mfma_f32_16x16x32_bf16 v[12:15], v[240:243], v[192:195], 0
    v_add_f32 v250, v250, v210
    s_waitcnt lgkmcnt(6)
    ds_read_b64_tr_b16 v[240:241], v249 offset:50944
    ds_read_b64_tr_b16 v[242:243], v249 offset:51456
    v_mfma_f32_16x16x32_bf16 v[16:19], v[224:227], v[192:195], 0
    s_mov_b32 s54, 15
    v_max_f32 v254, v254, v211
    v_add_f32 v211, v252, v211
    v_exp_f32 v211, v211
    s_nop 0
    s_waitcnt lgkmcnt(6)
    ds_read_b64_tr_b16 v[224:225], v249 offset:51008
    ds_read_b64_tr_b16 v[226:227], v249 offset:51520
    v_mfma_f32_16x16x32_bf16 v[20:23], v[228:231], v[192:195], 0
    s_mov_b32 s55, 67584
    v_add_f32 v250, v250, v211
    v_cvt_pk_bf16_f32 v209, v210, v211
    s_waitcnt lgkmcnt(6)
    ds_read_b64_tr_b16 v[228:229], v249 offset:51040
    ds_read_b64_tr_b16 v[230:231], v249 offset:51552
    v_mfma_f32_16x16x32_bf16 v[24:27], v[232:235], v[192:195], 0
    s_waitcnt lgkmcnt(6)
    ds_read_b64_tr_b16 v[232:233], v249 offset:51072
    ds_read_b64_tr_b16 v[234:235], v249 offset:51584
    v_mfma_f32_16x16x32_bf16 v[28:31], v[236:239], v[192:195], 0
    s_waitcnt lgkmcnt(6)
    ds_read_b64_tr_b16 v[236:237], v249 offset:51104
    ds_read_b64_tr_b16 v[238:239], v249 offset:51616
    v_mfma_f32_16x16x32_bf16 v[32:35], v[240:243], v[192:195], 0
    ds_read_b64_tr_b16 v[240:241], v249 offset:51136
    ds_read_b64_tr_b16 v[242:243], v249 offset:51648
    v_mfma_f32_16x16x32_bf16 v[36:39], v[244:247], v[192:195], 0
    s_waitcnt lgkmcnt(8)
    ds_read_b64_tr_b16 v[244:245], v249 offset:51168
    ds_read_b64_tr_b16 v[246:247], v249 offset:51680
    v_mfma_f32_16x16x32_bf16 v[40:43], v[224:227], v[192:195], 0
    s_waitcnt lgkmcnt(8)
    v_add_u32 v248, 4294899712, v248
    v_add_u32 v249, 4294899712, v249
    v_mfma_f32_16x16x32_bf16 v[44:47], v[228:231], v[192:195], 0
    s_waitcnt lgkmcnt(6)
    s_waitcnt lgkmcnt(0)
    s_barrier
    v_mfma_f32_16x16x32_bf16 v[48:51], v[232:235], v[192:195], 0
    ds_read_b128 v[224:227], v248 offset:0
    ds_read_b128 v[228:231], v248 offset:64
    v_mfma_f32_16x16x32_bf16 v[52:55], v[236:239], v[192:195], 0
    ds_read_b128 v[232:235], v248 offset:128
    ds_read_b128 v[236:239], v248 offset:192
    v_mfma_f32_16x16x32_bf16 v[56:59], v[240:243], v[192:195], 0
    v_max_f32 v254, v254, v212
    v_add_f32 v212, v252, v212
    v_exp_f32 v212, v212
    s_nop 0
    ds_read_b128 v[240:243], v248 offset:256
    v_mfma_f32_16x16x32_bf16 v[60:63], v[244:247], v[192:195], 0
    v_add_f32 v250, v250, v212
    s_waitcnt lgkmcnt(4)
    .p2align 3
LA_main1g:
    v_mfma_f32_16x16x32_bf16 v[192:195], v[224:227], v[128:131], 0
    v_max_f32 v254, v254, v213
    v_add_f32 v213, v252, v213
    v_exp_f32 v213, v213
    s_nop 0
    s_waitcnt lgkmcnt(3)
    ds_read_b128 v[224:227], v248 offset:320
    v_mfma_f32_16x16x32_bf16 v[192:195], v[228:231], v[132:135], v[192:195]
    v_add_f32 v250, v250, v213
    v_cvt_pk_bf16_f32 v210, v212, v213
    s_waitcnt lgkmcnt(3)
    ds_read_b128 v[228:231], v248 offset:384
    v_mfma_f32_16x16x32_bf16 v[192:195], v[232:235], v[136:139], v[192:195]
    v_max_f32 v254, v254, v214
    v_add_f32 v214, v252, v214
    v_exp_f32 v214, v214
    s_nop 0
    s_waitcnt lgkmcnt(3)
    ds_read_b128 v[232:235], v248 offset:448
    v_mfma_f32_16x16x32_bf16 v[192:195], v[236:239], v[140:143], v[192:195]
    v_add_f32 v250, v250, v214
    s_waitcnt lgkmcnt(3)
    ds_read_b128 v[236:239], v248 offset:512
    v_mfma_f32_16x16x32_bf16 v[192:195], v[240:243], v[144:147], v[192:195]
    v_max_f32 v254, v254, v215
    v_add_f32 v215, v252, v215
    v_exp_f32 v215, v215
    s_nop 0
    s_waitcnt lgkmcnt(3)
    ds_read_b128 v[240:243], v248 offset:576
    v_mfma_f32_16x16x32_bf16 v[192:195], v[224:227], v[148:151], v[192:195]
    v_add_f32 v250, v250, v215
    v_cvt_pk_bf16_f32 v211, v214, v215
    s_waitcnt lgkmcnt(3)
    ds_read_b128 v[224:227], v248 offset:640
    v_mfma_f32_16x16x32_bf16 v[192:195], v[228:231], v[152:155], v[192:195]
    s_waitcnt lgkmcnt(3)
    ds_read_b128 v[228:231], v248 offset:704
    v_mfma_f32_16x16x32_bf16 v[192:195], v[232:235], v[156:159], v[192:195]
    s_waitcnt lgkmcnt(3)
    ds_read_b128 v[232:235], v248 offset:768
    v_mfma_f32_16x16x32_bf16 v[196:199], v[236:239], v[128:131], 0
    s_waitcnt lgkmcnt(3)
    ds_read_b128 v[236:239], v248 offset:832
    ds_read_b64_tr_b16 v[244:245], v249 offset:17184
    v_mfma_f32_16x16x32_bf16 v[196:199], v[240:243], v[132:135], v[196:199]
    s_waitcnt lgkmcnt(4)
    ds_read_b128 v[240:243], v248 offset:896
    ds_read_b64_tr_b16 v[246:247], v249 offset:17696
    v_mfma_f32_16x16x32_bf16 v[196:199], v[224:227], v[136:139], v[196:199]
    s_waitcnt lgkmcnt(5)
    ds_read_b128 v[224:227], v248 offset:960
    v_mfma_f32_16x16x32_bf16 v[196:199], v[228:231], v[140:143], v[196:199]
    s_waitcnt lgkmcnt(5)
    ds_read_b64_tr_b16 v[228:229], v249 offset:16896
    ds_read_b64_tr_b16 v[230:231], v249 offset:17408
    v_mfma_f32_16x16x32_bf16 v[196:199], v[232:235], v[144:147], v[196:199]
    s_waitcnt lgkmcnt(6)
    ds_read_b64_tr_b16 v[232:233], v249 offset:16928
    ds_read_b64_tr_b16 v[234:235], v249 offset:17440
    v_mfma_f32_16x16x32_bf16 v[196:199], v[236:239], v[148:151], v[196:199]
    s_waitcnt lgkmcnt(6)
    ds_read_b64_tr_b16 v[236:237], v249 offset:16960
    ds_read_b64_tr_b16 v[238:239], v249 offset:17472
    v_mfma_f32_16x16x32_bf16 v[196:199], v[240:243], v[152:155], v[196:199]
    v_max_f32 v254, v254, v192
    v_add_f32 v192, v252, v192
    v_exp_f32 v192, v192
    s_nop 0
    s_waitcnt lgkmcnt(6)
    ds_read_b64_tr_b16 v[240:241], v249 offset:16992
    ds_read_b64_tr_b16 v[242:243], v249 offset:17504
    v_mfma_f32_16x16x32_bf16 v[196:199], v[224:227], v[156:159], v[196:199]
    v_add_f32 v250, v250, v192
    s_waitcnt lgkmcnt(6)
    ds_read_b64_tr_b16 v[224:225], v249 offset:17024
    ds_read_b64_tr_b16 v[226:227], v249 offset:17536
    v_mfma_f32_16x16x32_bf16 v[0:3], v[228:231], v[208:211], v[0:3]
    v_max_f32 v254, v254, v193
    v_add_f32 v193, v252, v193
    v_exp_f32 v193, v193
    s_nop 0
    s_waitcnt lgkmcnt(6)
    ds_read_b64_tr_b16 v[228:229], v249 offset:17056
    ds_read_b64_tr_b16 v[230:231], v249 offset:17568
    v_mfma_f32_16x16x32_bf16 v[4:7], v[232:235], v[208:211], v[4:7]
    v_add_f32 v250, v250, v193
    v_cvt_pk_bf16_f32 v192, v192, v193
    s_waitcnt lgkmcnt(6)
    ds_read_b64_tr_b16 v[232:233], v249 offset:17088
    ds_read_b64_tr_b16 v[234:235], v249 offset:17600
    v_mfma_f32_16x16x32_bf16 v[8:11], v[236:239], v[208:211], v[8:11]
    v_max_f32 v254, v254, v194
    v_add_f32 v194, v252, v194
    v_exp_f32 v194, v194
    s_nop 0
    s_waitcnt lgkmcnt(6)
    ds_read_b64_tr_b16 v[236:237], v249 offset:17120
    ds_read_b64_tr_b16 v[238:239], v249 offset:17632
    v_mfma_f32_16x16x32_bf16 v[12:15], v[240:243], v[208:211], v[12:15]
    v_add_f32 v250, v250, v194
    s_waitcnt lgkmcnt(6)
    ds_read_b64_tr_b16 v[240:241], v249 offset:17152
    ds_read_b64_tr_b16 v[242:243], v249 offset:17664
    v_mfma_f32_16x16x32_bf16 v[16:19], v[224:227], v[208:211], v[16:19]
    v_max_f32 v254, v254, v195
    v_add_f32 v195, v252, v195
    v_exp_f32 v195, v195
    s_nop 0
    s_waitcnt lgkmcnt(6)
    ds_read_b64_tr_b16 v[224:225], v249 offset:17216
    ds_read_b64_tr_b16 v[226:227], v249 offset:17728
    v_mfma_f32_16x16x32_bf16 v[20:23], v[228:231], v[208:211], v[20:23]
    v_add_f32 v250, v250, v195
    v_cvt_pk_bf16_f32 v193, v194, v195
    s_waitcnt lgkmcnt(6)
    ds_read_b64_tr_b16 v[228:229], v249 offset:17248
    ds_read_b64_tr_b16 v[230:231], v249 offset:17760
    v_mfma_f32_16x16x32_bf16 v[24:27], v[232:235], v[208:211], v[24:27]
    s_waitcnt lgkmcnt(6)
    ds_read_b64_tr_b16 v[232:233], v249 offset:17280
    ds_read_b64_tr_b16 v[234:235], v249 offset:17792
    v_mfma_f32_16x16x32_bf16 v[28:31], v[236:239], v[208:211], v[28:31]
    s_waitcnt lgkmcnt(6)
    ds_read_b64_tr_b16 v[236:237], v249 offset:17312
    ds_read_b64_tr_b16 v[238:239], v249 offset:17824
    v_mfma_f32_16x16x32_bf16 v[32:35], v[240:243], v[208:211], v[32:35]
    ds_read_b64_tr_b16 v[240:241], v249 offset:17344
    ds_read_b64_tr_b16 v[242:243], v249 offset:17856
    v_mfma_f32_16x16x32_bf16 v[36:39], v[244:247], v[208:211], v[36:39]
    s_waitcnt lgkmcnt(8)
    ds_read_b64_tr_b16 v[244:245], v249 offset:17376
    ds_read_b64_tr_b16 v[246:247], v249 offset:17888
    v_mfma_f32_16x16x32_bf16 v[40:43], v[224:227], v[208:211], v[40:43]
    s_waitcnt lgkmcnt(8)
    v_mfma_f32_16x16x32_bf16 v[44:47], v[228:231], v[208:211], v[44:47]
    s_waitcnt lgkmcnt(6)
    s_waitcnt lgkmcnt(0)
    s_barrier
    v_mfma_f32_16x16x32_bf16 v[48:51], v[232:235], v[208:211], v[48:51]
    ds_read_b128 v[224:227], v248 offset:33792
    ds_read_b128 v[228:231], v248 offset:33856
    v_mfma_f32_16x16x32_bf16 v[52:55], v[236:239], v[208:211], v[52:55]
    ds_read_b128 v[232:235], v248 offset:33920
    ds_read_b128 v[236:239], v248 offset:33984
    v_mfma_f32_16x16x32_bf16 v[56:59], v[240:243], v[208:211], v[56:59]
    v_max_f32 v254, v254, v196
    v_add_f32 v196, v252, v196
    v_exp_f32 v196, v196
    s_nop 0
    ds_read_b128 v[240:243], v248 offset:34048
    v_mfma_f32_16x16x32_bf16 v[60:63], v[244:247], v[208:211], v[60:63]
    v_add_f32 v250, v250, v196
    s_waitcnt lgkmcnt(4)
    v_mfma_f32_16x16x32_bf16 v[208:211], v[224:227], v[128:131], 0
    v_max_f32 v254, v254, v197
    v_add_f32 v197, v252, v197
    v_exp_f32 v197, v197
    s_nop 0
    s_waitcnt lgkmcnt(3)
    ds_read_b128 v[224:227], v248 offset:34112
    v_mfma_f32_16x16x32_bf16 v[208:211], v[228:231], v[132:135], v[208:211]
    v_add_f32 v250, v250, v197
    v_cvt_pk_bf16_f32 v194, v196, v197
    s_waitcnt lgkmcnt(3)
    ds_read_b128 v[228:231], v248 offset:34176
    v_mfma_f32_16x16x32_bf16 v[208:211], v[232:235], v[136:139], v[208:211]
    v_max_f32 v254, v254, v198
    v_add_f32 v198, v252, v198
    v_exp_f32 v198, v198
    s_nop 0
    s_waitcnt lgkmcnt(3)
    ds_read_b128 v[232:235], v248 offset:34240
    v_mfma_f32_16x16x32_bf16 v[208:211], v[236:239], v[140:143], v[208:211]
    v_add_f32 v250, v250, v198
    s_waitcnt lgkmcnt(3)
    ds_read_b128 v[236:239], v248 offset:34304
    v_mfma_f32_16x16x32_bf16 v[208:211], v[240:243], v[144:147], v[208:211]
    v_max_f32 v254, v254, v199
    v_add_f32 v199, v252, v199
    v_exp_f32 v199, v199
    s_nop 0
    s_waitcnt lgkmcnt(3)
    ds_read_b128 v[240:243], v248 offset:34368
    v_mfma_f32_16x16x32_bf16 v[208:211], v[224:227], v[148:151], v[208:211]
    v_add_f32 v250, v250, v199
    v_cvt_pk_bf16_f32 v195, v198, v199
    s_waitcnt lgkmcnt(3)
    ds_read_b128 v[224:227], v248 offset:34432
    v_mfma_f32_16x16x32_bf16 v[208:211], v[228:231], v[152:155], v[208:211]
    s_waitcnt lgkmcnt(3)
    ds_read_b128 v[228:231], v248 offset:34496
    v_mfma_f32_16x16x32_bf16 v[208:211], v[232:235], v[156:159], v[208:211]
    s_waitcnt lgkmcnt(3)
    ds_read_b128 v[232:235], v248 offset:34560
    v_mfma_f32_16x16x32_bf16 v[212:215], v[236:239], v[128:131], 0
    s_waitcnt lgkmcnt(3)
    ds_read_b128 v[236:239], v248 offset:34624
    ds_read_b64_tr_b16 v[244:245], v249 offset:50976
    v_mfma_f32_16x16x32_bf16 v[212:215], v[240:243], v[132:135], v[212:215]
    s_waitcnt lgkmcnt(4)
    ds_read_b128 v[240:243], v248 offset:34688
    ds_read_b64_tr_b16 v[246:247], v249 offset:51488
    v_mfma_f32_16x16x32_bf16 v[212:215], v[224:227], v[136:139], v[212:215]
    s_waitcnt lgkmcnt(5)
    ds_read_b128 v[224:227], v248 offset:34752
    v_mfma_f32_16x16x32_bf16 v[212:215], v[228:231], v[140:143], v[212:215]
    s_waitcnt lgkmcnt(5)
    ds_read_b64_tr_b16 v[228:229], v249 offset:50688
    ds_read_b64_tr_b16 v[230:231], v249 offset:51200
    v_mfma_f32_16x16x32_bf16 v[212:215], v[232:235], v[144:147], v[212:215]
    s_waitcnt lgkmcnt(6)
    ds_read_b64_tr_b16 v[232:233], v249 offset:50720
    ds_read_b64_tr_b16 v[234:235], v249 offset:51232
    v_mfma_f32_16x16x32_bf16 v[212:215], v[236:239], v[148:151], v[212:215]
    s_waitcnt lgkmcnt(6)
    ds_read_b64_tr_b16 v[236:237], v249 offset:50752
    ds_read_b64_tr_b16 v[238:239], v249 offset:51264
    v_mfma_f32_16x16x32_bf16 v[212:215], v[240:243], v[152:155], v[212:215]
    v_max_f32 v254, v254, v208
    v_add_f32 v208, v252, v208
    v_exp_f32 v208, v208
    s_nop 0
    s_waitcnt lgkmcnt(6)
    ds_read_b64_tr_b16 v[240:241], v249 offset:50784
    ds_read_b64_tr_b16 v[242:243], v249 offset:51296
    v_mfma_f32_16x16x32_bf16 v[212:215], v[224:227], v[156:159], v[212:215]
    v_add_f32 v250, v250, v208
    s_waitcnt lgkmcnt(6)
    ds_read_b64_tr_b16 v[224:225], v249 offset:50816
    ds_read_b64_tr_b16 v[226:227], v249 offset:51328
    v_mfma_f32_16x16x32_bf16 v[0:3], v[228:231], v[192:195], v[0:3]
    v_max_f32 v254, v254, v209
    v_add_f32 v209, v252, v209
    v_exp_f32 v209, v209
    s_nop 0
    s_waitcnt lgkmcnt(6)
    ds_read_b64_tr_b16 v[228:229], v249 offset:50848
    ds_read_b64_tr_b16 v[230:231], v249 offset:51360
    v_mfma_f32_16x16x32_bf16 v[4:7], v[232:235], v[192:195], v[4:7]
    v_add_f32 v250, v250, v209
    v_cvt_pk_bf16_f32 v208, v208, v209
    s_waitcnt lgkmcnt(6)
    ds_read_b64_tr_b16 v[232:233], v249 offset:50880
    ds_read_b64_tr_b16 v[234:235], v249 offset:51392
    v_mfma_f32_16x16x32_bf16 v[8:11], v[236:239], v[192:195], v[8:11]
    v_max_f32 v254, v254, v210
    v_add_f32 v210, v252, v210
    v_exp_f32 v210, v210
    s_nop 0
    s_waitcnt lgkmcnt(6)
    ds_read_b64_tr_b16 v[236:237], v249 offset:50912
    ds_read_b64_tr_b16 v[238:239], v249 offset:51424
    v_mfma_f32_16x16x32_bf16 v[12:15], v[240:243], v[192:195], v[12:15]
    v_add_f32 v250, v250, v210
    s_waitcnt lgkmcnt(6)
    ds_read_b64_tr_b16 v[240:241], v249 offset:50944
    ds_read_b64_tr_b16 v[242:243], v249 offset:51456
    v_mfma_f32_16x16x32_bf16 v[16:19], v[224:227], v[192:195], v[16:19]
    v_max_f32 v254, v254, v211
    v_add_f32 v211, v252, v211
    v_exp_f32 v211, v211
    s_nop 0
    s_waitcnt lgkmcnt(6)
    ds_read_b64_tr_b16 v[224:225], v249 offset:51008
    ds_read_b64_tr_b16 v[226:227], v249 offset:51520
    v_mfma_f32_16x16x32_bf16 v[20:23], v[228:231], v[192:195], v[20:23]
    v_add_f32 v250, v250, v211
    v_cvt_pk_bf16_f32 v209, v210, v211
    s_waitcnt lgkmcnt(6)
    ds_read_b64_tr_b16 v[228:229], v249 offset:51040
    ds_read_b64_tr_b16 v[230:231], v249 offset:51552
    v_mfma_f32_16x16x32_bf16 v[24:27], v[232:235], v[192:195], v[24:27]
    s_waitcnt lgkmcnt(6)
    ds_read_b64_tr_b16 v[232:233], v249 offset:51072
    ds_read_b64_tr_b16 v[234:235], v249 offset:51584
    v_mfma_f32_16x16x32_bf16 v[28:31], v[236:239], v[192:195], v[28:31]
    s_waitcnt lgkmcnt(6)
    ds_read_b64_tr_b16 v[236:237], v249 offset:51104
    ds_read_b64_tr_b16 v[238:239], v249 offset:51616
    v_mfma_f32_16x16x32_bf16 v[32:35], v[240:243], v[192:195], v[32:35]
    ds_read_b64_tr_b16 v[240:241], v249 offset:51136
    ds_read_b64_tr_b16 v[242:243], v249 offset:51648
    v_mfma_f32_16x16x32_bf16 v[36:39], v[244:247], v[192:195], v[36:39]
    s_waitcnt lgkmcnt(8)
    ds_read_b64_tr_b16 v[244:245], v249 offset:51168
    ds_read_b64_tr_b16 v[246:247], v249 offset:51680
    v_mfma_f32_16x16x32_bf16 v[40:43], v[224:227], v[192:195], v[40:43]
    s_waitcnt lgkmcnt(8)
    v_add_u32 v248, s55, v248
    v_add_u32 v249, s55, v249
    v_mfma_f32_16x16x32_bf16 v[44:47], v[228:231], v[192:195], v[44:47]
    s_waitcnt lgkmcnt(6)
    s_waitcnt lgkmcnt(0)
    s_barrier
    v_mfma_f32_16x16x32_bf16 v[48:51], v[232:235], v[192:195], v[48:51]
    s_sub_u32 s55, 0, s55
    ds_read_b128 v[224:227], v248 offset:0
    ds_read_b128 v[228:231], v248 offset:64
    v_mfma_f32_16x16x32_bf16 v[52:55], v[236:239], v[192:195], v[52:55]
    s_sub_u32 s54, s54, 1
    ds_read_b128 v[232:235], v248 offset:128
    ds_read_b128 v[236:239], v248 offset:192
    v_mfma_f32_16x16x32_bf16 v[56:59], v[240:243], v[192:195], v[56:59]
    s_cmp_lg_u32 s54, 0
    v_max_f32 v254, v254, v212
    v_add_f32 v212, v252, v212
    v_exp_f32 v212, v212
    s_nop 0
    ds_read_b128 v[240:243], v248 offset:256
    v_mfma_f32_16x16x32_bf16 v[60:63], v[244:247], v[192:195], v[60:63]
    v_add_f32 v250, v250, v212
    s_waitcnt lgkmcnt(4)
    s_cbranch_scc1 LA_main1g
    ds_read_b64_tr_b16 v[224:225], v249 offset:16896
    ds_read_b64_tr_b16 v[226:227], v249 offset:17408
    ds_read_b64_tr_b16 v[228:229], v249 offset:16928
    ds_read_b64_tr_b16 v[230:231], v249 offset:17440
    ds_read_b64_tr_b16 v[232:233], v249 offset:16960
    ds_read_b64_tr_b16 v[234:235], v249 offset:17472
    ds_read_b64_tr_b16 v[236:237], v249 offset:16992
    ds_read_b64_tr_b16 v[238:239], v249 offset:17504
    ds_read_b64_tr_b16 v[240:241], v249 offset:17024
    ds_read_b64_tr_b16 v[242:243], v249 offset:17536
    v_max_f32 v254, v254, v213
    v_add_f32 v213, v252, v213
    v_exp_f32 v213, v213
    v_max_f32 v254, v254, v214
    v_add_f32 v214, v252, v214
    v_exp_f32 v214, v214
    v_max_f32 v254, v254, v215
    v_add_f32 v215, v252, v215
    v_exp_f32 v215, v215
    v_mbcnt_lo_u32_b32 v194, -1, 0
    v_add_f32 v250, v250, v213
    v_cvt_pk_bf16_f32 v210, v212, v213
    v_add_f32 v250, v250, v214
    v_add_f32 v250, v250, v215
    v_cvt_pk_bf16_f32 v211, v214, v215
    v_mov_b32 v200, v254
    v_mov_b32 v201, v255
    s_nop 1
    v_permlane32_swap_b32 v200, v254
    v_permlane32_swap_b32 v201, v255
    v_max_f32 v254, v254, v200
    v_max_f32 v255, v255, v201
    v_mov_b32 v200, v254
    v_mov_b32 v201, v255
    s_nop 1
    v_permlane16_swap_b32 v200, v254
    v_permlane16_swap_b32 v201, v255
    v_max_f32 v254, v254, v200
    v_max_f32 v255, v255, v201
    v_sub_f32 v254, 0, v254
    v_sub_f32 v255, 0, v255
    v_mbcnt_hi_u32_b32 v200, -1, v194
    s_lshl_b32 s50, s44, 9
    s_add_u32 s50, s50, 256
    v_lshl_add_u32 v200, v200, 3, s50
    ds_write_b64 v200, v[254:255]
    s_waitcnt lgkmcnt(0)
    v_mbcnt_lo_u32_b32 v255, -1, 0
    v_mbcnt_hi_u32_b32 v255, -1, v255
    v_lshrrev_b32 v252, 2, v255
    v_lshlrev_b32 v252, 7, v252
    v_bfe_u32 v253, v255, 3, 2
    v_lshl_add_u32 v252, v253, 5, v252
    v_and_b32 v253, 3, v255
    v_lshl_add_u32 v252, v253, 3, v252
    v_add_u32 v252, 97280, v252
    v_xor_b32 v253, 32, v252
    v_xor_b32 v254, 64, v252
    v_xor_b32 v255, 0x60, v252
    s_branch LA_join1
.section .rodata,"a"
.p2align 6
.amdhsa_kernel standalone__mha_block_cached__near_ridge_kernel
  .amdhsa_next_free_vgpr 256
  .amdhsa_next_free_sgpr 100
  .amdhsa_accum_offset 256
  .amdhsa_group_segment_fixed_size 0
  .amdhsa_kernarg_size 64
  .amdhsa_user_sgpr_count 2
  .amdhsa_user_sgpr_kernarg_segment_ptr 1
  .amdhsa_system_sgpr_workgroup_id_x 1
.end_amdhsa_kernel
```
